```python
import torch

def _softmax(x, axis=-1):
    return torch.softmax(x, dim=axis)
def _gelu(x):
    return torch.nn.functional.gelu(x, approximate="tanh")
def _silu(x):
    return torch.nn.functional.silu(x)
def _sigmoid(x):
    return torch.sigmoid(x)
def _layernorm(x, axis=-1, eps=1e-5):
    m = x.mean(dim=axis, keepdim=True)
    v = x.var(dim=axis, keepdim=True, unbiased=False)
    return (x - m) / torch.sqrt(v + eps)
def _scatter_add(tgt, idx, src, axis=0):
    return tgt.clone().index_add_(axis, idx, src)
def _segment_sum(src, seg, n):
    out = torch.zeros((n,) + src.shape[1:], dtype=src.dtype)
    return out.index_add_(0, seg, src)
def _pad(x, pw):
    flat = tuple(v for pair in reversed(pw) for v in pair)
    return torch.nn.functional.pad(x, flat)

kernel_name = 'parallel_sum__sliding_local_dilated__dense_activation_gelu__prompt'

def setup_inputs():

    _w = (lambda a: (lambda t: t.to(torch.bfloat16) if t.is_floating_point() else t)(torch.as_tensor(a)))
    def _A_setup():
        B, S, D = 1, 2048, 512
        return {
            "x": _w((lambda *s: torch.randn(*s, dtype=torch.bfloat16) * 0.05)(B, S, D)),
            "wqkv": _w((lambda *s: torch.randn(*s, dtype=torch.bfloat16) * 0.05)(D, 3 * D)),
            "wo": _w((lambda *s: torch.randn(*s, dtype=torch.bfloat16) * 0.05)(D, D)),
        }
    _A_in = _A_setup()

    def _B_setup():
        B, S, D, F = 1, 2048, 512, 1376
        return {
            "x": _w((lambda *s: torch.randn(*s, dtype=torch.bfloat16) * 0.05)(B, S, D)),
            "w1": _w((lambda *s: torch.randn(*s, dtype=torch.bfloat16) * 0.8)(D, F) * (D ** -0.5)),
            "b1": _w((lambda *s: torch.randn(*s, dtype=torch.bfloat16) * 0.8)(F) * 0.01),
            "w2": _w((lambda *s: torch.randn(*s, dtype=torch.bfloat16) * 0.8)(F, D) * (F ** -0.5)),
            "b2": _w((lambda *s: torch.randn(*s, dtype=torch.bfloat16) * 0.8)(D) * 0.01),
        }
    _B_in = _B_setup()

    return {
        "A_x": _A_in["x"],
        "A_wqkv": _A_in["wqkv"],
        "A_wo": _A_in["wo"],
        "B_x": _B_in["x"],
        "B_w1": _B_in["w1"],
        "B_b1": _B_in["b1"],
        "B_w2": _B_in["w2"],
        "B_b2": _B_in["b2"],
    }

def reference(A_x, A_wqkv, A_wo, B_x, B_w1, B_b1, B_w2, B_b2):
    def _A_ref(x, wqkv, wo):
        B, S, D = x.shape
        H = 32; Dh = D // H
        W, dil = 8, 2
        qkv = (lambda x, *d: x.permute(*d))((x @ wqkv).reshape(B, S, 3, H, Dh), 2, 0, 3, 1, 4)
        q, k, v = qkv[0], qkv[1], qkv[2]
        scale = Dh ** -0.5
        pos = torch.arange(S)
        off = torch.arange(W) * dil
        idx = pos[:, None] - off[None, :]
        mask = idx >= 0
        idx_c = torch.where(mask, idx, 0).reshape(-1)
        kg = k[:, :, idx_c, :].reshape(B, H, S, W, Dh)
        vg = v[:, :, idx_c, :].reshape(B, H, S, W, Dh)
        logits = torch.einsum("bhsd,bhswd->bhsw", q, kg) * scale
        logits = torch.where(mask[None, None, :, :], logits, -1e9)
        attn = _softmax(logits, axis=-1)
        o = torch.einsum("bhsw,bhswd->bhsd", attn, vg)
        return (lambda x, *d: x.permute(*d))(o, 0, 2, 1, 3).reshape(B, S, D) @ wo

    def _B_ref(x, w1, b1, w2, b2):
        h = torch.einsum("bsd,df->bsf", x, w1) + b1
        h = _gelu(h)
        return torch.einsum("bsf,fd->bsd", h, w2) + b2

    x = A_x
    xn = _layernorm(x, axis=-1)
    return x + _A_ref(xn, A_wqkv, A_wo) + _B_ref(xn, B_w1, B_b1, B_w2, B_b2)
```

```asm
; @launch grid=(256,1,1) block=(512,1,1) lds=163840
.amdgcn_target "amdgcn-amd-amdhsa--gfx950"
.text
.globl parallel_sum__sliding_local_dilated__dense_activation_gelu__prompt_kernel
.p2align 8
.type parallel_sum__sliding_local_dilated__dense_activation_gelu__prompt_kernel,@function
parallel_sum__sliding_local_dilated__dense_activation_gelu__prompt_kernel:
    s_cmp_ge_u32 s2, 256
    s_cbranch_scc1 L_end
    s_load_dwordx2 s[8:9], s[0:1], 0
    s_load_dwordx2 s[12:13], s[0:1], 8
    s_load_dwordx2 s[44:45], s[0:1], 32
    s_load_dwordx2 s[24:25], s[0:1], 80
    s_load_dwordx2 s[40:41], s[0:1], 72
    s_load_dwordx2 s[16:17], s[0:1], 16
    s_load_dwordx2 s[20:21], s[0:1], 48
    s_load_dwordx2 s[28:29], s[0:1], 64
    s_load_dwordx2 s[32:33], s[0:1], 40
    s_load_dwordx2 s[36:37], s[0:1], 56
    s_bitcmp0_b32 s2, 5
    s_cbranch_scc1 L_A
    v_lshrrev_b32 v1, 6, v0
    v_and_b32 v0, 63, v0
    v_readfirstlane_b32 s3, v1
    s_mov_b32 s10, 2097152
    s_mov_b32 s11, 0x20000
    s_mov_b32 s14, 1572864
    s_mov_b32 s15, 0x20000
    s_mov_b32 s46, 1409024
    s_mov_b32 s47, 0x20000
    s_mov_b32 s26, 268435456
    s_mov_b32 s27, 0x20000
    s_mov_b32 s42, 256
    s_mov_b32 s43, 0x20000
    s_mov_b32 s18, 524288
    s_mov_b32 s19, 0x20000
    s_mov_b32 s22, 1409024
    s_mov_b32 s23, 0x20000
    s_mov_b32 s30, 2097152
    s_mov_b32 s31, 0x20000
    s_mov_b32 s34, 2752
    s_mov_b32 s35, 0x20000
    s_mov_b32 s38, 1024
    s_mov_b32 s39, 0x20000
    s_and_b32 s7, s2, 7
    s_lshr_b32 s70, s2, 3
    s_lshr_b32 s100, s7, 1
    s_lshl_b32 s4, s100, 2
    s_and_b32 s71, s70, 3
    s_add_u32 s4, s4, s71
    s_lshr_b32 s5, s70, 2
    s_and_b32 s5, s7, 1
    s_lshl_b32 s5, s5, 2
    s_lshr_b32 s76, s70, 3
    s_add_u32 s5, s5, s76
    s_add_u32 s6, s71, s5
    s_and_b32 s6, s6, 3
    s_lshl_b32 s67, s7, 1
    s_lshr_b32 s71, s70, 4
    s_add_u32 s67, s67, s71
    s_lshr_b32 s68, s70, 3
    s_and_b32 s68, s68, 1
    s_and_b32 s69, s70, 7
    s_lshr_b32 s76, s70, 3
    s_lshl_b32 s76, s76, 2
    s_lshl_b32 s71, s69, 1
    s_add_u32 s76, s76, s71
    s_and_b32 s48, s3, 3
    s_lshl_b32 s49, s48, 10
    s_mov_b32 s77, 0xffff0000
    s_bfe_u32 s7, s70, 0x10002
    s_cmp_lt_u32 s3, 4
    s_cbranch_scc1 L_cffn
    v_lshrrev_b32 v24, 3, v0
    v_and_b32 v25, 7, v0
    v_lshrrev_b32 v26, 1, v24
    s_and_b32 s71, s48, 1
    s_lshl_b32 s72, s71, 2
    v_or_b32 v27, s72, v26
    v_xor_b32 v27, v27, v25
    v_lshlrev_b32 v27, 4, v27
    s_lshl_b32 s74, s4, 7
    s_lshl_b32 s70, s48, 3
    s_add_u32 s70, s74, s70
    v_add_u32 v28, s70, v24
    v_lshl_add_u32 v1, v28, 10, v27
    s_lshr_b32 s70, s48, 1
    s_lshl_b32 s70, s70, 4
    s_add_u32 s70, s70, s72
    v_and_b32 v28, 3, v24
    v_lshrrev_b32 v29, 2, v24
    v_lshl_add_u32 v28, v29, 3, v28
    v_add_u32 v28, s70, v28
    v_lshrrev_b32 v29, 1, v25
    v_xor_b32 v29, v29, v26
    v_lshlrev_b32 v29, 5, v29
    v_and_b32 v30, 1, v25
    v_lshl_add_u32 v29, v30, 4, v29
    s_mul_i32 s70, s5, 11
    s_and_b32 s70, s70, -2
    s_lshl_b32 s70, s70, 5
    v_mul_u32_u24 v28, 2752, v28
    v_add_u32 v28, v28, v29
    v_add_u32 v2, s70, v28
    s_lshl_b32 s100, s5, 3
    s_add_u32 s100, s100, s74
    s_lshl_b32 s70, s48, 1
    s_add_u32 s100, s100, s70
    s_add_u32 s100, s100, 64
    s_lshl_b32 s70, s100, 10
    v_lshl_add_u32 v5, v0, 4, s70
    v_lshrrev_b32 v34, 5, v0
    v_add_u32 v34, s100, v34
    v_lshlrev_b32 v34, 3, v34
    v_add_u32 v34, 9437184, v34
    s_lshl_b32 s70, s48, 5
    s_add_u32 s70, s70, s74
    s_sub_u32 s71, s74, 48
    v_add_u32 v35, s70, v0
    v_add_u32 v30, s71, v0
    v_cmp_lt_u32 vcc, 31, v0
    s_nop 1
    v_cndmask_b32 v35, v35, v30, vcc
    v_lshlrev_b32 v35, 3, v35
    v_add_u32 v35, 9437184, v35
    s_waitcnt lgkmcnt(0)
    s_xor_b32 s72, s6, 0
    s_and_b32 s72, s72, 7
    s_lshl_b32 s74, s72, 7
    s_mul_i32 s75, s72, 176128
    s_add_u32 m0, s49, 2048
    s_add_u32 s0, s74, 0
    buffer_load_dwordx4 v1, s[8:11], s0 offen lds
    s_add_u32 m0, s49, 55296
    s_nop 0
    buffer_load_dwordx4 v2, s[44:47], s75 offen offset:0 lds
    s_add_u32 m0, s49, 63360
    s_nop 0
    buffer_load_dwordx4 v2, s[44:47], s75 offen offset:128 lds
    s_add_u32 m0, s49, 6144
    s_add_u32 s0, s74, 32768
    buffer_load_dwordx4 v1, s[8:11], s0 offen lds
    s_add_u32 m0, s49, 71424
    s_nop 0
    buffer_load_dwordx4 v2, s[44:47], s75 offen offset:256 lds
    s_add_u32 m0, s49, 10240
    s_add_u32 s0, s74, 65536
    buffer_load_dwordx4 v1, s[8:11], s0 offen lds
    s_add_u32 m0, s49, 59392
    s_add_u32 s1, s75, 88064
    buffer_load_dwordx4 v2, s[44:47], s1 offen offset:0 lds
    s_add_u32 m0, s49, 67456
    s_add_u32 s1, s75, 88064
    buffer_load_dwordx4 v2, s[44:47], s1 offen offset:128 lds
    s_add_u32 m0, s49, 14336
    s_add_u32 s0, s74, 98304
    buffer_load_dwordx4 v1, s[8:11], s0 offen lds
    s_add_u32 m0, s49, 75520
    s_add_u32 s1, s75, 88064
    buffer_load_dwordx4 v2, s[44:47], s1 offen offset:256 lds
    buffer_load_dwordx4 v[16:19], v5, s[8:11], 0 offen offset:0
    buffer_load_dwordx4 v[20:23], v5, s[8:11], 0 offen offset:1024
    s_xor_b32 s72, s6, 1
    s_and_b32 s72, s72, 7
    s_lshl_b32 s74, s72, 7
    s_mul_i32 s75, s72, 176128
    s_add_u32 m0, s49, 20480
    s_add_u32 s0, s74, 0
    buffer_load_dwordx4 v1, s[8:11], s0 offen lds
    s_add_u32 m0, s49, 79872
    s_nop 0
    buffer_load_dwordx4 v2, s[44:47], s75 offen offset:0 lds
    s_add_u32 m0, s49, 87936
    s_nop 0
    buffer_load_dwordx4 v2, s[44:47], s75 offen offset:128 lds
    s_add_u32 m0, s49, 24576
    s_add_u32 s0, s74, 32768
    buffer_load_dwordx4 v1, s[8:11], s0 offen lds
    s_add_u32 m0, s49, 96000
    s_nop 0
    buffer_load_dwordx4 v2, s[44:47], s75 offen offset:256 lds
    s_waitcnt vmcnt(7)
    s_waitcnt lgkmcnt(0)
    s_barrier
    s_add_u32 m0, s49, 28672
    s_add_u32 s0, s74, 65536
    buffer_load_dwordx4 v1, s[8:11], s0 offen lds
    s_add_u32 m0, s49, 83968
    s_add_u32 s1, s75, 88064
    buffer_load_dwordx4 v2, s[44:47], s1 offen offset:0 lds
    s_add_u32 m0, s49, 92032
    s_add_u32 s1, s75, 88064
    buffer_load_dwordx4 v2, s[44:47], s1 offen offset:128 lds
    s_add_u32 m0, s49, 32768
    s_add_u32 s0, s74, 98304
    buffer_load_dwordx4 v1, s[8:11], s0 offen lds
    s_add_u32 m0, s49, 100096
    s_add_u32 s1, s75, 88064
    buffer_load_dwordx4 v2, s[44:47], s1 offen offset:256 lds
    s_xor_b32 s72, s6, 2
    s_and_b32 s72, s72, 7
    s_lshl_b32 s74, s72, 7
    s_mul_i32 s75, s72, 176128
    s_add_u32 m0, s49, 38912
    s_add_u32 s0, s74, 0
    buffer_load_dwordx4 v1, s[8:11], s0 offen lds
    s_add_u32 m0, s49, 104448
    s_nop 0
    buffer_load_dwordx4 v2, s[44:47], s75 offen offset:0 lds
    s_add_u32 m0, s49, 112512
    s_nop 0
    buffer_load_dwordx4 v2, s[44:47], s75 offen offset:128 lds
    s_add_u32 m0, s49, 43008
    s_add_u32 s0, s74, 32768
    buffer_load_dwordx4 v1, s[8:11], s0 offen lds
    s_add_u32 m0, s49, 120576
    s_nop 0
    buffer_load_dwordx4 v2, s[44:47], s75 offen offset:256 lds
    s_waitcnt vmcnt(5)
    s_barrier
    s_add_u32 m0, s49, 47104
    s_add_u32 s0, s74, 65536
    buffer_load_dwordx4 v1, s[8:11], s0 offen lds
    s_add_u32 m0, s49, 108544
    s_add_u32 s1, s75, 88064
    buffer_load_dwordx4 v2, s[44:47], s1 offen offset:0 lds
    s_add_u32 m0, s49, 116608
    s_add_u32 s1, s75, 88064
    buffer_load_dwordx4 v2, s[44:47], s1 offen offset:128 lds
    s_add_u32 m0, s49, 51200
    s_add_u32 s0, s74, 98304
    buffer_load_dwordx4 v1, s[8:11], s0 offen lds
    s_add_u32 m0, s49, 124672
    s_add_u32 s1, s75, 88064
    buffer_load_dwordx4 v2, s[44:47], s1 offen offset:256 lds
    v_and_b32 v33, 15, v0
    v_lshlrev_b32 v33, 4, v33
    s_mul_i32 s7, s5, 352
    v_lshl_add_u32 v15, v0, 4, s7
    s_xor_b32 s72, s6, 3
    s_and_b32 s72, s72, 7
    s_lshl_b32 s74, s72, 7
    s_mul_i32 s75, s72, 176128
    s_add_u32 m0, s49, 2048
    s_add_u32 s0, s74, 0
    buffer_load_dwordx4 v1, s[8:11], s0 offen lds
    s_add_u32 m0, s49, 55296
    s_nop 0
    buffer_load_dwordx4 v2, s[44:47], s75 offen offset:0 lds
    buffer_load_dword v32, v33, s[40:43], 0 offen sc1
    s_add_u32 m0, s49, 63360
    s_nop 0
    buffer_load_dwordx4 v2, s[44:47], s75 offen offset:128 lds
    s_add_u32 m0, s49, 6144
    s_add_u32 s0, s74, 32768
    buffer_load_dwordx4 v1, s[8:11], s0 offen lds
    s_add_u32 m0, s49, 71424
    s_nop 0
    buffer_load_dwordx4 v2, s[44:47], s75 offen offset:256 lds
    s_add_u32 m0, s49, 10240
    s_add_u32 s0, s74, 65536
    buffer_load_dwordx4 v1, s[8:11], s0 offen lds
    s_add_u32 m0, s49, 59392
    s_add_u32 s1, s75, 88064
    buffer_load_dwordx4 v2, s[44:47], s1 offen offset:0 lds
    v_and_b32 v40, s77, v16
    v_lshlrev_b32 v41, 16, v16
    v_add_f32 v26, v40, v41
    v_mul_f32 v27, v40, v40
    v_fmac_f32 v27, v41, v41
    v_and_b32 v40, s77, v17
    v_lshlrev_b32 v41, 16, v17
    v_add_f32 v26, v26, v40
    v_fmac_f32 v27, v40, v40
    v_add_f32 v26, v26, v41
    v_fmac_f32 v27, v41, v41
    v_and_b32 v40, s77, v18
    v_lshlrev_b32 v41, 16, v18
    v_add_f32 v26, v26, v40
    v_fmac_f32 v27, v40, v40
    v_add_f32 v26, v26, v41
    v_fmac_f32 v27, v41, v41
    v_and_b32 v40, s77, v19
    v_lshlrev_b32 v41, 16, v19
    v_add_f32 v26, v26, v40
    v_fmac_f32 v27, v40, v40
    v_add_f32 v26, v26, v41
    v_fmac_f32 v27, v41, v41
    v_and_b32 v40, s77, v20
    v_lshlrev_b32 v41, 16, v20
    v_add_f32 v28, v40, v41
    v_mul_f32 v29, v40, v40
    v_fmac_f32 v29, v41, v41
    v_and_b32 v40, s77, v21
    v_lshlrev_b32 v41, 16, v21
    v_add_f32 v28, v28, v40
    v_fmac_f32 v29, v40, v40
    v_add_f32 v28, v28, v41
    v_fmac_f32 v29, v41, v41
    v_and_b32 v40, s77, v22
    v_lshlrev_b32 v41, 16, v22
    v_add_f32 v28, v28, v40
    v_fmac_f32 v29, v40, v40
    v_add_f32 v28, v28, v41
    s_waitcnt vmcnt(8)
    s_waitcnt lgkmcnt(0)
    s_barrier
    s_add_u32 m0, s49, 67456
    s_add_u32 s1, s75, 88064
    buffer_load_dwordx4 v2, s[44:47], s1 offen offset:128 lds
    s_add_u32 m0, s49, 14336
    s_add_u32 s0, s74, 98304
    buffer_load_dwordx4 v1, s[8:11], s0 offen lds
    s_add_u32 m0, s49, 75520
    s_add_u32 s1, s75, 88064
    buffer_load_dwordx4 v2, s[44:47], s1 offen offset:256 lds
    s_mov_b32 m0, 0
    s_mov_b32 exec_lo, 0x3fffff
    s_mov_b32 exec_hi, 0
    buffer_load_dwordx4 v15, s[32:35], 0 offen lds
    s_mov_b64 exec, -1
    s_xor_b32 s72, s6, 4
    s_and_b32 s72, s72, 7
    s_lshl_b32 s74, s72, 7
    s_mul_i32 s75, s72, 176128
    s_add_u32 m0, s49, 20480
    s_add_u32 s0, s74, 0
    buffer_load_dwordx4 v1, s[8:11], s0 offen lds
    s_add_u32 m0, s49, 79872
    s_nop 0
    buffer_load_dwordx4 v2, s[44:47], s75 offen offset:0 lds
    s_add_u32 m0, s49, 87936
    s_nop 0
    buffer_load_dwordx4 v2, s[44:47], s75 offen offset:128 lds
    s_add_u32 m0, s49, 24576
    s_add_u32 s0, s74, 32768
    buffer_load_dwordx4 v1, s[8:11], s0 offen lds
    s_add_u32 m0, s49, 96000
    s_nop 0
    buffer_load_dwordx4 v2, s[44:47], s75 offen offset:256 lds
    s_add_u32 m0, s49, 28672
    s_add_u32 s0, s74, 65536
    buffer_load_dwordx4 v1, s[8:11], s0 offen lds
    s_add_u32 m0, s49, 83968
    s_add_u32 s1, s75, 88064
    buffer_load_dwordx4 v2, s[44:47], s1 offen offset:0 lds
    v_fmac_f32 v29, v41, v41
    v_and_b32 v40, s77, v23
    v_lshlrev_b32 v41, 16, v23
    v_add_f32 v28, v28, v40
    v_fmac_f32 v29, v40, v40
    v_add_f32 v28, v28, v41
    v_fmac_f32 v29, v41, v41
    s_nop 0
    v_permlane32_swap_b32 v26, v28
    v_permlane32_swap_b32 v27, v29
    v_add_f32 v26, v26, v28
    v_add_f32 v27, v27, v29
    s_nop 1
    v_permlane16_swap_b32 v26, v27
    v_add_f32 v26, v26, v27
    s_nop 1
    v_add_f32_dpp v26, v26, v26 row_ror:8 row_mask:0xf bank_mask:0xf
    s_nop 1
    v_add_f32_dpp v26, v26, v26 row_ror:4 row_mask:0xf bank_mask:0xf
    s_nop 1
    v_add_f32_dpp v26, v26, v26 row_ror:2 row_mask:0xf bank_mask:0xf
    s_nop 1
    v_add_f32_dpp v26, v26, v26 row_ror:1 row_mask:0xf bank_mask:0xf
    v_mov_b32 v27, v26
    s_nop 1
    v_permlane16_swap_b32 v26, v27
    s_mov_b32 s71, 0x3b000000
    v_mul_f32 v26, s71, v26
    v_mul_f32 v40, v26, v26
    v_fma_f32 v27, v27, s71, -v40
    v_max_f32 v27, 0, v27
    v_add_f32 v27, 0x3727c5ac, v27
    v_rsq_f32 v27, v27
    s_nop 0
    v_mul_f32 v26, v26, v27
    v_sub_f32 v26, 0, v26
    v_xor_b32 v24, 0x80000000, v27
    v_mov_b32 v25, v26
    s_waitcnt vmcnt(8)
    s_waitcnt lgkmcnt(0)
    s_barrier
    s_add_u32 m0, s49, 92032
    s_add_u32 s1, s75, 88064
    buffer_load_dwordx4 v2, s[44:47], s1 offen offset:128 lds
    s_add_u32 m0, s49, 32768
    s_add_u32 s0, s74, 98304
    buffer_load_dwordx4 v1, s[8:11], s0 offen lds
    s_add_u32 m0, s49, 100096
    s_add_u32 s1, s75, 88064
    buffer_load_dwordx4 v2, s[44:47], s1 offen offset:256 lds
    s_mov_b32 s70, 0
L_gate_1:
    v_cmp_ne_u32 vcc, 1, v32
    s_nop 1
    s_cmp_lg_u64 vcc, 0
    s_cbranch_scc0 L_gate_ok_2
    buffer_load_dword v32, v33, s[40:43], 0 offen sc1
    s_add_u32 s70, s70, 1
    s_waitcnt vmcnt(0)
    s_cmp_lt_u32 s70, 20000
    s_cbranch_scc1 L_gate_1
L_gate_ok_2:
    s_mov_b32 exec_lo, 1
    s_mov_b32 exec_hi, 1
    buffer_store_dwordx2 v[24:25], v34, s[24:27], 0 offen sc1
    s_mov_b64 exec, -1
    s_xor_b32 s72, s6, 5
    s_and_b32 s72, s72, 7
    s_lshl_b32 s74, s72, 7
    s_mul_i32 s75, s72, 176128
    s_add_u32 m0, s49, 38912
    s_add_u32 s0, s74, 0
    buffer_load_dwordx4 v1, s[8:11], s0 offen lds
    s_add_u32 m0, s49, 104448
    s_nop 0
    buffer_load_dwordx4 v2, s[44:47], s75 offen offset:0 lds
    s_add_u32 m0, s49, 112512
    s_nop 0
    buffer_load_dwordx4 v2, s[44:47], s75 offen offset:128 lds
    s_add_u32 m0, s49, 43008
    s_add_u32 s0, s74, 32768
    buffer_load_dwordx4 v1, s[8:11], s0 offen lds
    s_add_u32 m0, s49, 120576
    s_nop 0
    buffer_load_dwordx4 v2, s[44:47], s75 offen offset:256 lds
    s_add_u32 m0, s49, 47104
    s_add_u32 s0, s74, 65536
    buffer_load_dwordx4 v1, s[8:11], s0 offen lds
    s_add_u32 m0, s49, 108544
    s_add_u32 s1, s75, 88064
    buffer_load_dwordx4 v2, s[44:47], s1 offen offset:0 lds
    v_and_b32 v44, 15, v0
    v_lshrrev_b32 v45, 4, v0
    s_lshl_b32 s7, s48, 1
    s_add_u32 s7, s7, 1
    v_add_u32 v45, s7, v45
    v_lshlrev_b32 v45, 7, v45
    v_cmp_lt_u32 vcc, 31, v0
    s_nop 1
    v_cndmask_b32 v45, v45, 0, vcc
    v_lshl_add_u32 v45, v44, 2, v45
    v_add_u32 v38, 161792, v45
    v_lshrrev_b32 v44, 3, v0
    v_and_b32 v45, 7, v0
    v_and_b32 v46, 2, v44
    v_lshlrev_b32 v46, 1, v46
    v_xor_b32 v45, v45, v46
    v_lshlrev_b32 v45, 4, v45
    v_lshl_add_u32 v45, v44, 10, v45
    s_lshl_b32 s7, s69, 7
    v_add_u32 v4, s7, v45
    s_waitcnt vmcnt(8)
    s_waitcnt lgkmcnt(0)
    s_barrier
    s_add_u32 m0, s49, 116608
    s_add_u32 s1, s75, 88064
    buffer_load_dwordx4 v2, s[44:47], s1 offen offset:128 lds
    s_add_u32 m0, s49, 51200
    s_add_u32 s0, s74, 98304
    buffer_load_dwordx4 v1, s[8:11], s0 offen lds
    s_add_u32 m0, s49, 124672
    s_add_u32 s1, s75, 88064
    buffer_load_dwordx4 v2, s[44:47], s1 offen offset:256 lds
    s_xor_b32 s72, s6, 6
    s_and_b32 s72, s72, 7
    s_lshl_b32 s74, s72, 7
    s_mul_i32 s75, s72, 176128
    s_add_u32 m0, s49, 2048
    s_add_u32 s0, s74, 0
    buffer_load_dwordx4 v1, s[8:11], s0 offen lds
    s_add_u32 m0, s49, 55296
    s_nop 0
    buffer_load_dwordx4 v2, s[44:47], s75 offen offset:0 lds
    s_add_u32 m0, s49, 63360
    s_nop 0
    buffer_load_dwordx4 v2, s[44:47], s75 offen offset:128 lds
    s_add_u32 m0, s49, 6144
    s_add_u32 s0, s74, 32768
    buffer_load_dwordx4 v1, s[8:11], s0 offen lds
    s_add_u32 m0, s49, 71424
    s_nop 0
    buffer_load_dwordx4 v2, s[44:47], s75 offen offset:256 lds
    s_add_u32 m0, s49, 10240
    s_add_u32 s0, s74, 65536
    buffer_load_dwordx4 v1, s[8:11], s0 offen lds
    s_add_u32 m0, s49, 59392
    s_add_u32 s1, s75, 88064
    buffer_load_dwordx4 v2, s[44:47], s1 offen offset:0 lds
    v_lshrrev_b32 v44, 4, v0
    v_bfe_u32 v45, v0, 2, 2
    v_and_b32 v46, 3, v0
    v_and_b32 v47, 1, v44
    v_lshrrev_b32 v48, 1, v46
    v_lshl_add_u32 v47, v47, 1, v48
    v_lshrrev_b32 v48, 1, v45
    v_lshlrev_b32 v48, 2, v48
    v_xor_b32 v47, v47, v48
    v_lshlrev_b32 v47, 4, v47
    v_lshrrev_b32 v44, 1, v44
    v_lshl_add_u32 v47, v44, 10, v47
    v_lshl_add_u32 v47, v45, 7, v47
    v_and_b32 v48, 1, v46
    v_lshl_add_u32 v60, v48, 3, v47
    s_sub_u32 s7, 3, s48
    s_lshl_b32 s7, s7, 11
    s_add_u32 s73, s7, 129024
    v_add_u32 v60, s73, v60
    v_xor_b32 v61, 64, v60
    s_add_u32 s52, s76, 0
    s_and_b32 s52, s52, 7
    s_lshl_b32 s52, s52, 10
    s_add_u32 s53, s76, 1
    s_and_b32 s53, s53, 7
    s_lshl_b32 s53, s53, 10
    s_add_u32 s54, s76, 2
    s_and_b32 s54, s54, 7
    s_lshl_b32 s54, s54, 10
    s_add_u32 s55, s76, 3
    s_and_b32 s55, s55, 7
    s_lshl_b32 s55, s55, 10
    s_add_u32 s56, s76, 4
    s_and_b32 s56, s56, 7
    s_lshl_b32 s56, s56, 10
    s_add_u32 s57, s76, 5
    s_and_b32 s57, s57, 7
    s_lshl_b32 s57, s57, 10
    s_add_u32 s58, s76, 6
    s_and_b32 s58, s58, 7
    s_lshl_b32 s58, s58, 10
    s_add_u32 s59, s76, 7
    s_and_b32 s59, s59, 7
    s_lshl_b32 s59, s59, 10
    s_waitcnt vmcnt(7)
    s_waitcnt lgkmcnt(0)
    s_barrier
    s_add_u32 m0, s49, 67456
    s_add_u32 s1, s75, 88064
    buffer_load_dwordx4 v2, s[44:47], s1 offen offset:128 lds
    s_add_u32 m0, s49, 14336
    s_add_u32 s0, s74, 98304
    buffer_load_dwordx4 v1, s[8:11], s0 offen lds
    s_add_u32 m0, s49, 75520
    s_add_u32 s1, s75, 88064
    buffer_load_dwordx4 v2, s[44:47], s1 offen offset:256 lds
    s_xor_b32 s72, s6, 7
    s_and_b32 s72, s72, 7
    s_lshl_b32 s74, s72, 7
    s_mul_i32 s75, s72, 176128
    s_add_u32 m0, s49, 20480
    s_add_u32 s0, s74, 0
    buffer_load_dwordx4 v1, s[8:11], s0 offen lds
    s_add_u32 m0, s49, 79872
    s_nop 0
    buffer_load_dwordx4 v2, s[44:47], s75 offen offset:0 lds
    s_add_u32 m0, s49, 87936
    s_nop 0
    buffer_load_dwordx4 v2, s[44:47], s75 offen offset:128 lds
    s_add_u32 m0, s49, 24576
    s_add_u32 s0, s74, 32768
    buffer_load_dwordx4 v1, s[8:11], s0 offen lds
    s_add_u32 m0, s49, 96000
    s_nop 0
    buffer_load_dwordx4 v2, s[44:47], s75 offen offset:256 lds
    s_add_u32 m0, s49, 28672
    s_add_u32 s0, s74, 65536
    buffer_load_dwordx4 v1, s[8:11], s0 offen lds
    s_add_u32 m0, s49, 83968
    s_add_u32 s1, s75, 88064
    buffer_load_dwordx4 v2, s[44:47], s1 offen offset:0 lds
    s_mov_b32 s100, s76
    s_sub_u32 s101, s100, 7
    s_min_u32 s100, s101, s100
    s_sub_u32 s101, s100, 7
    s_min_u32 s100, s101, s100
    s_sub_u32 s101, s100, 7
    s_min_u32 s100, s101, s100
    s_sub_u32 s101, s100, 7
    s_min_u32 s100, s101, s100
    s_add_u32 s60, s100, 0
    s_sub_u32 s101, s60, 7
    s_min_u32 s60, s101, s60
    s_add_u32 s60, s60, 8
    s_lshl_b32 s60, s60, 10
    s_add_u32 s61, s100, 1
    s_sub_u32 s101, s61, 7
    s_min_u32 s61, s101, s61
    s_add_u32 s61, s61, 8
    s_lshl_b32 s61, s61, 10
    s_add_u32 s62, s100, 2
    s_sub_u32 s101, s62, 7
    s_min_u32 s62, s101, s62
    s_add_u32 s62, s62, 8
    s_lshl_b32 s62, s62, 10
    s_add_u32 s63, s100, 3
    s_sub_u32 s101, s63, 7
    s_min_u32 s63, s101, s63
    s_add_u32 s63, s63, 8
    s_lshl_b32 s63, s63, 10
    s_add_u32 s64, s100, 4
    s_sub_u32 s101, s64, 7
    s_min_u32 s64, s101, s64
    s_add_u32 s64, s64, 8
    s_lshl_b32 s64, s64, 10
    s_add_u32 s65, s100, 5
    s_sub_u32 s101, s65, 7
    s_min_u32 s65, s101, s65
    s_add_u32 s65, s65, 8
    s_lshl_b32 s65, s65, 10
    s_add_u32 s66, s100, 6
    s_sub_u32 s101, s66, 7
    s_min_u32 s66, s101, s66
    s_add_u32 s66, s66, 8
    s_lshl_b32 s66, s66, 10
    s_waitcnt vmcnt(7)
    s_waitcnt lgkmcnt(0)
    s_barrier
    s_add_u32 m0, s49, 92032
    s_add_u32 s1, s75, 88064
    buffer_load_dwordx4 v2, s[44:47], s1 offen offset:128 lds
    s_add_u32 m0, s49, 32768
    s_add_u32 s0, s74, 98304
    buffer_load_dwordx4 v1, s[8:11], s0 offen lds
    s_add_u32 m0, s49, 100096
    s_add_u32 s1, s75, 88064
    buffer_load_dwordx4 v2, s[44:47], s1 offen offset:256 lds
    buffer_load_dwordx2 v[36:37], v35, s[24:27], 0 offen sc1
    s_cmp_ge_u32 s52, 4096
    s_cselect_b32 s7, 7168, 0
    s_add_u32 s7, s7, s52
    s_lshl_b32 s7, s7, 4
    s_mul_i32 s70, s48, 360448
    s_add_u32 s0, s7, s70
    s_add_u32 s1, s0, 8192
    v_add_u32 v5, s0, v4
    v_add_u32 v6, 8192, v5
    s_add_u32 m0, s73, 0
    s_nop 0
    buffer_load_dwordx4 v5, s[20:23], 0 offen lds
    s_add_u32 m0, s73, 1024
    s_nop 0
    buffer_load_dwordx4 v6, s[20:23], 0 offen lds
    s_cmp_ge_u32 s53, 4096
    s_cselect_b32 s7, 7168, 0
    s_add_u32 s7, s7, s53
    s_lshl_b32 s7, s7, 4
    s_mul_i32 s70, s48, 360448
    s_add_u32 s0, s7, s70
    s_add_u32 s1, s0, 8192
    v_add_u32 v5, s0, v4
    v_add_u32 v6, 8192, v5
    s_add_u32 m0, s73, 8192
    s_nop 0
    buffer_load_dwordx4 v5, s[20:23], 0 offen lds
    s_add_u32 m0, s73, 9216
    s_nop 0
    buffer_load_dwordx4 v6, s[20:23], 0 offen lds
    s_cmp_ge_u32 s54, 4096
    s_cselect_b32 s7, 7168, 0
    s_add_u32 s7, s7, s54
    s_lshl_b32 s7, s7, 4
    s_mul_i32 s70, s48, 360448
    s_add_u32 s0, s7, s70
    s_add_u32 s1, s0, 8192
    v_add_u32 v5, s0, v4
    v_add_u32 v6, 8192, v5
    s_add_u32 m0, s73, 16384
    s_nop 0
    buffer_load_dwordx4 v5, s[20:23], 0 offen lds
    s_add_u32 m0, s73, 17408
    s_nop 0
    buffer_load_dwordx4 v6, s[20:23], 0 offen lds
    s_cmp_ge_u32 s55, 4096
    s_cselect_b32 s7, 7168, 0
    s_add_u32 s7, s7, s55
    s_lshl_b32 s7, s7, 4
    s_mul_i32 s70, s48, 360448
    s_add_u32 s0, s7, s70
    s_add_u32 s1, s0, 8192
    v_add_u32 v5, s0, v4
    v_add_u32 v6, 8192, v5
    s_add_u32 m0, s73, 24576
    s_nop 0
    buffer_load_dwordx4 v5, s[20:23], 0 offen lds
    s_add_u32 m0, s73, 25600
    s_nop 0
    buffer_load_dwordx4 v6, s[20:23], 0 offen lds
    s_lshl_b32 s7, s52, 4
    s_lshl_b32 s70, s48, 17
    s_add_u32 s0, s7, s70
    s_add_u32 s1, s0, 8192
    s_lshl_b32 s7, s49, 1
    v_add_u32 v5, s0, v4
    v_add_u32 v6, 8192, v5
    s_add_u32 m0, s7, 38912
    s_nop 0
    buffer_load_dwordx4 v5, s[16:19], 0 offen lds
    s_add_u32 m0, s7, 39936
    s_nop 0
    buffer_load_dwordx4 v6, s[16:19], 0 offen lds
    s_lshl_b32 s7, s53, 4
    s_lshl_b32 s70, s48, 17
    s_add_u32 s0, s7, s70
    s_add_u32 s1, s0, 8192
    s_lshl_b32 s7, s49, 1
    v_add_u32 v5, s0, v4
    v_add_u32 v6, 8192, v5
    s_add_u32 m0, s7, 47104
    s_nop 0
    buffer_load_dwordx4 v5, s[16:19], 0 offen lds
    s_add_u32 m0, s7, 48128
    s_nop 0
    buffer_load_dwordx4 v6, s[16:19], 0 offen lds
    s_waitcnt vmcnt(13)
    s_waitcnt lgkmcnt(0)
    s_barrier
    s_mov_b32 s78, -1
    s_mov_b32 s79, 0
    s_waitcnt vmcnt(12)
    s_mov_b32 s70, 0
L_stat_3:
    v_cmp_eq_u32 vcc, 0, v36
    s_nop 1
    s_and_b64 vcc, vcc, s[78:79]
    s_cbranch_scc0 L_stat_ok_4
    buffer_load_dwordx2 v[36:37], v35, s[24:27], 0 offen sc1
    s_add_u32 s70, s70, 1
    s_waitcnt vmcnt(0)
    s_cmp_lt_u32 s70, 20000
    s_cbranch_scc1 L_stat_3
L_stat_ok_4:
    v_and_b32 v36, 0x7fffffff, v36
    s_mov_b32 exec_hi, 0
    ds_write2_b32 v38, v36, v37 offset0:0 offset1:16
    s_mov_b64 exec, -1
    s_waitcnt vmcnt(10)
    ds_read_b64_tr_b16 v[136:137], v60 offset:0
    ds_read_b64_tr_b16 v[138:139], v60 offset:512
    ds_read_b64_tr_b16 v[140:141], v61 offset:0
    ds_read_b64_tr_b16 v[142:143], v61 offset:512
    s_waitcnt lgkmcnt(0)
    v_mov_b32 v5, v143
    s_cmp_ge_u32 s56, 4096
    s_cselect_b32 s7, 7168, 0
    s_add_u32 s7, s7, s56
    s_lshl_b32 s7, s7, 4
    s_mul_i32 s70, s48, 360448
    s_add_u32 s0, s7, s70
    s_add_u32 s1, s0, 8192
    v_add_u32 v5, s0, v4
    v_add_u32 v6, 8192, v5
    s_add_u32 m0, s73, 0
    s_nop 0
    buffer_load_dwordx4 v5, s[20:23], 0 offen lds
    s_add_u32 m0, s73, 1024
    s_nop 0
    buffer_load_dwordx4 v6, s[20:23], 0 offen lds
    s_waitcnt vmcnt(10)
    ds_read_b64_tr_b16 v[144:145], v60 offset:8192
    ds_read_b64_tr_b16 v[146:147], v60 offset:8704
    ds_read_b64_tr_b16 v[148:149], v61 offset:8192
    ds_read_b64_tr_b16 v[150:151], v61 offset:8704
    s_waitcnt lgkmcnt(0)
    v_mov_b32 v5, v151
    s_cmp_ge_u32 s57, 4096
    s_cselect_b32 s7, 7168, 0
    s_add_u32 s7, s7, s57
    s_lshl_b32 s7, s7, 4
    s_mul_i32 s70, s48, 360448
    s_add_u32 s0, s7, s70
    s_add_u32 s1, s0, 8192
    v_add_u32 v5, s0, v4
    v_add_u32 v6, 8192, v5
    s_add_u32 m0, s73, 8192
    s_nop 0
    buffer_load_dwordx4 v5, s[20:23], 0 offen lds
    s_add_u32 m0, s73, 9216
    s_nop 0
    buffer_load_dwordx4 v6, s[20:23], 0 offen lds
    s_waitcnt vmcnt(10)
    ds_read_b64_tr_b16 v[152:153], v60 offset:16384
    ds_read_b64_tr_b16 v[154:155], v60 offset:16896
    ds_read_b64_tr_b16 v[156:157], v61 offset:16384
    ds_read_b64_tr_b16 v[158:159], v61 offset:16896
    s_waitcnt lgkmcnt(0)
    v_mov_b32 v5, v159
    s_cmp_ge_u32 s58, 4096
    s_cselect_b32 s7, 7168, 0
    s_add_u32 s7, s7, s58
    s_lshl_b32 s7, s7, 4
    s_mul_i32 s70, s48, 360448
    s_add_u32 s0, s7, s70
    s_add_u32 s1, s0, 8192
    v_add_u32 v5, s0, v4
    v_add_u32 v6, 8192, v5
    s_add_u32 m0, s73, 16384
    s_nop 0
    buffer_load_dwordx4 v5, s[20:23], 0 offen lds
    s_add_u32 m0, s73, 17408
    s_nop 0
    buffer_load_dwordx4 v6, s[20:23], 0 offen lds
    s_waitcnt vmcnt(10)
    ds_read_b64_tr_b16 v[160:161], v60 offset:24576
    ds_read_b64_tr_b16 v[162:163], v60 offset:25088
    ds_read_b64_tr_b16 v[164:165], v61 offset:24576
    ds_read_b64_tr_b16 v[166:167], v61 offset:25088
    s_waitcnt lgkmcnt(0)
    v_mov_b32 v5, v167
    s_cmp_ge_u32 s59, 4096
    s_cselect_b32 s7, 7168, 0
    s_add_u32 s7, s7, s59
    s_lshl_b32 s7, s7, 4
    s_mul_i32 s70, s48, 360448
    s_add_u32 s0, s7, s70
    s_add_u32 s1, s0, 8192
    v_add_u32 v5, s0, v4
    v_add_u32 v6, 8192, v5
    s_add_u32 m0, s73, 24576
    s_nop 0
    buffer_load_dwordx4 v5, s[20:23], 0 offen lds
    s_add_u32 m0, s73, 25600
    s_nop 0
    buffer_load_dwordx4 v6, s[20:23], 0 offen lds
    s_lshl_b32 s7, s54, 4
    s_lshl_b32 s70, s48, 17
    s_add_u32 s0, s7, s70
    s_add_u32 s1, s0, 8192
    s_lshl_b32 s7, s49, 1
    v_add_u32 v5, s0, v4
    v_add_u32 v6, 8192, v5
    s_add_u32 m0, s7, 104448
    s_nop 0
    buffer_load_dwordx4 v5, s[16:19], 0 offen lds
    s_add_u32 m0, s7, 105472
    s_nop 0
    buffer_load_dwordx4 v6, s[16:19], 0 offen lds
    s_lshl_b32 s7, s55, 4
    s_lshl_b32 s70, s48, 17
    s_add_u32 s0, s7, s70
    s_add_u32 s1, s0, 8192
    s_lshl_b32 s7, s49, 1
    v_add_u32 v5, s0, v4
    v_add_u32 v6, 8192, v5
    s_add_u32 m0, s7, 112640
    s_nop 0
    buffer_load_dwordx4 v5, s[16:19], 0 offen lds
    s_add_u32 m0, s7, 113664
    s_nop 0
    buffer_load_dwordx4 v6, s[16:19], 0 offen lds
    s_waitcnt lgkmcnt(0)
    s_barrier
    s_lshl_b32 s7, s48, 2
    s_add_u32 s7, s7, 163648
    v_mov_b32 v72, s7
    s_waitcnt vmcnt(10)
    ds_read_b64_tr_b16 v[168:169], v60 offset:0
    ds_read_b64_tr_b16 v[170:171], v60 offset:512
    ds_read_b64_tr_b16 v[172:173], v61 offset:0
    ds_read_b64_tr_b16 v[174:175], v61 offset:512
    s_waitcnt lgkmcnt(0)
    v_mov_b32 v5, v175
    s_cmp_ge_u32 s60, 12288
    s_cselect_b32 s7, 7168, 0
    s_sub_u32 s7, s7, 4096
    s_add_u32 s7, s7, s60
    s_lshl_b32 s7, s7, 4
    s_mul_i32 s70, s48, 360448
    s_add_u32 s0, s7, s70
    s_add_u32 s1, s0, 8192
    v_add_u32 v5, s0, v4
    v_add_u32 v6, 8192, v5
    s_add_u32 m0, s73, 0
    s_nop 0
    buffer_load_dwordx4 v5, s[20:23], 0 offen lds
    s_add_u32 m0, s73, 1024
    s_nop 0
    buffer_load_dwordx4 v6, s[20:23], 0 offen lds
    s_lshl_b32 s7, s56, 4
    s_lshl_b32 s70, s48, 17
    s_add_u32 s0, s7, s70
    s_add_u32 s1, s0, 8192
    s_lshl_b32 s7, s49, 1
    v_add_u32 v5, s0, v4
    v_add_u32 v6, 8192, v5
    s_add_u32 m0, s7, 120832
    s_nop 0
    buffer_load_dwordx4 v5, s[16:19], 0 offen lds
    s_add_u32 m0, s7, 121856
    s_nop 0
    buffer_load_dwordx4 v6, s[16:19], 0 offen lds
    s_waitcnt vmcnt(12)
    ds_read_b64_tr_b16 v[176:177], v60 offset:8192
    ds_read_b64_tr_b16 v[178:179], v60 offset:8704
    ds_read_b64_tr_b16 v[180:181], v61 offset:8192
    ds_read_b64_tr_b16 v[182:183], v61 offset:8704
    s_waitcnt lgkmcnt(0)
    v_mov_b32 v5, v183
    s_cmp_ge_u32 s61, 12288
    s_cselect_b32 s7, 7168, 0
    s_sub_u32 s7, s7, 4096
    s_add_u32 s7, s7, s61
    s_lshl_b32 s7, s7, 4
    s_mul_i32 s70, s48, 360448
    s_add_u32 s0, s7, s70
    s_add_u32 s1, s0, 8192
    v_add_u32 v5, s0, v4
    v_add_u32 v6, 8192, v5
    s_add_u32 m0, s73, 8192
    s_nop 0
    buffer_load_dwordx4 v5, s[20:23], 0 offen lds
    s_add_u32 m0, s73, 9216
    s_nop 0
    buffer_load_dwordx4 v6, s[20:23], 0 offen lds
    s_lshl_b32 s7, s57, 4
    s_lshl_b32 s70, s48, 17
    s_add_u32 s0, s7, s70
    s_add_u32 s1, s0, 8192
    s_lshl_b32 s7, s49, 1
    v_add_u32 v5, s0, v4
    v_add_u32 v6, 8192, v5
    s_add_u32 m0, s7, 2048
    s_nop 0
    buffer_load_dwordx4 v5, s[16:19], 0 offen lds
    s_add_u32 m0, s7, 3072
    s_nop 0
    buffer_load_dwordx4 v6, s[16:19], 0 offen lds
    s_waitcnt vmcnt(14)
    ds_read_b64_tr_b16 v[184:185], v60 offset:16384
    ds_read_b64_tr_b16 v[186:187], v60 offset:16896
    ds_read_b64_tr_b16 v[188:189], v61 offset:16384
    ds_read_b64_tr_b16 v[190:191], v61 offset:16896
    s_waitcnt lgkmcnt(0)
    v_mov_b32 v5, v191
    s_cmp_ge_u32 s62, 12288
    s_cselect_b32 s7, 7168, 0
    s_sub_u32 s7, s7, 4096
    s_add_u32 s7, s7, s62
    s_lshl_b32 s7, s7, 4
    s_mul_i32 s70, s48, 360448
    s_add_u32 s0, s7, s70
    s_add_u32 s1, s0, 8192
    v_add_u32 v5, s0, v4
    v_add_u32 v6, 8192, v5
    s_add_u32 m0, s73, 16384
    s_nop 0
    buffer_load_dwordx4 v5, s[20:23], 0 offen lds
    s_add_u32 m0, s73, 17408
    s_nop 0
    buffer_load_dwordx4 v6, s[20:23], 0 offen lds
    s_lshl_b32 s7, s58, 4
    s_lshl_b32 s70, s48, 17
    s_add_u32 s0, s7, s70
    s_add_u32 s1, s0, 8192
    s_lshl_b32 s7, s49, 1
    v_add_u32 v5, s0, v4
    v_add_u32 v6, 8192, v5
    s_add_u32 m0, s7, 10240
    s_nop 0
    buffer_load_dwordx4 v5, s[16:19], 0 offen lds
    s_add_u32 m0, s7, 11264
    s_nop 0
    buffer_load_dwordx4 v6, s[16:19], 0 offen lds
    s_waitcnt vmcnt(16)
    ds_read_b64_tr_b16 v[192:193], v60 offset:24576
    ds_read_b64_tr_b16 v[194:195], v60 offset:25088
    ds_read_b64_tr_b16 v[196:197], v61 offset:24576
    ds_read_b64_tr_b16 v[198:199], v61 offset:25088
    s_waitcnt lgkmcnt(0)
    v_mov_b32 v5, v199
    s_cmp_ge_u32 s63, 12288
    s_cselect_b32 s7, 7168, 0
    s_sub_u32 s7, s7, 4096
    s_add_u32 s7, s7, s63
    s_lshl_b32 s7, s7, 4
    s_mul_i32 s70, s48, 360448
    s_add_u32 s0, s7, s70
    s_add_u32 s1, s0, 8192
    v_add_u32 v5, s0, v4
    v_add_u32 v6, 8192, v5
    s_add_u32 m0, s73, 24576
    s_nop 0
    buffer_load_dwordx4 v5, s[20:23], 0 offen lds
    s_add_u32 m0, s73, 25600
    s_nop 0
    buffer_load_dwordx4 v6, s[20:23], 0 offen lds
    s_lshl_b32 s7, s59, 4
    s_lshl_b32 s70, s48, 17
    s_add_u32 s0, s7, s70
    s_add_u32 s1, s0, 8192
    s_lshl_b32 s7, s49, 1
    v_add_u32 v5, s0, v4
    v_add_u32 v6, 8192, v5
    s_add_u32 m0, s7, 55296
    s_nop 0
    buffer_load_dwordx4 v5, s[16:19], 0 offen lds
    s_add_u32 m0, s7, 56320
    s_nop 0
    buffer_load_dwordx4 v6, s[16:19], 0 offen lds
    s_waitcnt vmcnt(14)
    ds_read_b64_tr_b16 v[200:201], v60 offset:0
    ds_read_b64_tr_b16 v[202:203], v60 offset:512
    ds_read_b64_tr_b16 v[204:205], v61 offset:0
    ds_read_b64_tr_b16 v[206:207], v61 offset:512
    s_waitcnt lgkmcnt(0)
    v_mov_b32 v5, v207
    s_cmp_ge_u32 s64, 12288
    s_cselect_b32 s7, 7168, 0
    s_sub_u32 s7, s7, 4096
    s_add_u32 s7, s7, s64
    s_lshl_b32 s7, s7, 4
    s_mul_i32 s70, s48, 360448
    s_add_u32 s0, s7, s70
    s_add_u32 s1, s0, 8192
    v_add_u32 v5, s0, v4
    v_add_u32 v6, 8192, v5
    s_add_u32 m0, s73, 0
    s_nop 0
    buffer_load_dwordx4 v5, s[20:23], 0 offen lds
    s_add_u32 m0, s73, 1024
    s_nop 0
    buffer_load_dwordx4 v6, s[20:23], 0 offen lds
    s_cmp_ge_u32 s60, 11264
    s_cselect_b32 s7, 7168, 0
    s_add_u32 s7, s7, s60
    s_lshl_b32 s7, s7, 4
    s_mul_i32 s70, s48, 360448
    s_add_u32 s0, s7, s70
    s_add_u32 s1, s0, 8192
    s_lshl_b32 s7, s49, 1
    v_add_u32 v5, s0, v4
    v_add_u32 v6, 8192, v5
    s_add_u32 m0, s7, 63488
    s_nop 0
    buffer_load_dwordx4 v5, s[20:23], 0 offen lds
    s_add_u32 m0, s7, 64512
    s_nop 0
    buffer_load_dwordx4 v6, s[20:23], 0 offen lds
    s_waitcnt vmcnt(14)
    ds_read_b64_tr_b16 v[208:209], v60 offset:8192
    ds_read_b64_tr_b16 v[210:211], v60 offset:8704
    ds_read_b64_tr_b16 v[212:213], v61 offset:8192
    ds_read_b64_tr_b16 v[214:215], v61 offset:8704
    s_waitcnt lgkmcnt(0)
    v_mov_b32 v5, v215
    s_cmp_ge_u32 s65, 12288
    s_cselect_b32 s7, 7168, 0
    s_sub_u32 s7, s7, 4096
    s_add_u32 s7, s7, s65
    s_lshl_b32 s7, s7, 4
    s_mul_i32 s70, s48, 360448
    s_add_u32 s0, s7, s70
    s_add_u32 s1, s0, 8192
    v_add_u32 v5, s0, v4
    v_add_u32 v6, 8192, v5
    s_add_u32 m0, s73, 8192
    s_nop 0
    buffer_load_dwordx4 v5, s[20:23], 0 offen lds
    s_add_u32 m0, s73, 9216
    s_nop 0
    buffer_load_dwordx4 v6, s[20:23], 0 offen lds
    v_mov_b32 v73, 1
    ds_write_b32 v72, v73
    s_cmp_ge_u32 s61, 11264
    s_cselect_b32 s7, 7168, 0
    s_add_u32 s7, s7, s61
    s_lshl_b32 s7, s7, 4
    s_mul_i32 s70, s48, 360448
    s_add_u32 s0, s7, s70
    s_add_u32 s1, s0, 8192
    s_lshl_b32 s7, s49, 1
    v_add_u32 v5, s0, v4
    v_add_u32 v6, 8192, v5
    s_add_u32 m0, s7, 71680
    s_nop 0
    buffer_load_dwordx4 v5, s[20:23], 0 offen lds
    s_add_u32 m0, s7, 72704
    s_nop 0
    buffer_load_dwordx4 v6, s[20:23], 0 offen lds
    s_waitcnt vmcnt(14)
    ds_read_b64_tr_b16 v[216:217], v60 offset:16384
    ds_read_b64_tr_b16 v[218:219], v60 offset:16896
    ds_read_b64_tr_b16 v[220:221], v61 offset:16384
    ds_read_b64_tr_b16 v[222:223], v61 offset:16896
    s_waitcnt lgkmcnt(0)
    v_mov_b32 v5, v223
    s_cmp_ge_u32 s66, 12288
    s_cselect_b32 s7, 7168, 0
    s_sub_u32 s7, s7, 4096
    s_add_u32 s7, s7, s66
    s_lshl_b32 s7, s7, 4
    s_mul_i32 s70, s48, 360448
    s_add_u32 s0, s7, s70
    s_add_u32 s1, s0, 8192
    v_add_u32 v5, s0, v4
    v_add_u32 v6, 8192, v5
    s_add_u32 m0, s73, 16384
    s_nop 0
    buffer_load_dwordx4 v5, s[20:23], 0 offen lds
    s_add_u32 m0, s73, 17408
    s_nop 0
    buffer_load_dwordx4 v6, s[20:23], 0 offen lds
    s_cmp_ge_u32 s62, 11264
    s_cselect_b32 s7, 7168, 0
    s_add_u32 s7, s7, s62
    s_lshl_b32 s7, s7, 4
    s_mul_i32 s70, s48, 360448
    s_add_u32 s0, s7, s70
    s_add_u32 s1, s0, 8192
    s_lshl_b32 s7, s49, 1
    v_add_u32 v5, s0, v4
    v_add_u32 v6, 8192, v5
    s_add_u32 m0, s7, 20480
    s_nop 0
    buffer_load_dwordx4 v5, s[20:23], 0 offen lds
    s_add_u32 m0, s7, 21504
    s_nop 0
    buffer_load_dwordx4 v6, s[20:23], 0 offen lds
    s_cmp_ge_u32 s63, 11264
    s_cselect_b32 s7, 7168, 0
    s_add_u32 s7, s7, s63
    s_lshl_b32 s7, s7, 4
    s_mul_i32 s70, s48, 360448
    s_add_u32 s0, s7, s70
    s_add_u32 s1, s0, 8192
    s_lshl_b32 s7, s49, 1
    v_add_u32 v5, s0, v4
    v_add_u32 v6, 8192, v5
    s_add_u32 m0, s7, 28672
    s_nop 0
    buffer_load_dwordx4 v5, s[20:23], 0 offen lds
    s_add_u32 m0, s7, 29696
    s_nop 0
    buffer_load_dwordx4 v6, s[20:23], 0 offen lds
    s_cmp_ge_u32 s64, 11264
    s_cselect_b32 s7, 7168, 0
    s_add_u32 s7, s7, s64
    s_lshl_b32 s7, s7, 4
    s_mul_i32 s70, s48, 360448
    s_add_u32 s0, s7, s70
    s_add_u32 s1, s0, 8192
    s_lshl_b32 s7, s49, 1
    v_add_u32 v5, s0, v4
    v_add_u32 v6, 8192, v5
    s_add_u32 m0, s7, 79872
    s_nop 0
    buffer_load_dwordx4 v5, s[20:23], 0 offen lds
    s_add_u32 m0, s7, 80896
    s_nop 0
    buffer_load_dwordx4 v6, s[20:23], 0 offen lds
    s_cmp_ge_u32 s65, 11264
    s_cselect_b32 s7, 7168, 0
    s_add_u32 s7, s7, s65
    s_lshl_b32 s7, s7, 4
    s_mul_i32 s70, s48, 360448
    s_add_u32 s0, s7, s70
    s_add_u32 s1, s0, 8192
    s_lshl_b32 s7, s49, 1
    v_add_u32 v5, s0, v4
    v_add_u32 v6, 8192, v5
    s_add_u32 m0, s7, 88064
    s_nop 0
    buffer_load_dwordx4 v5, s[20:23], 0 offen lds
    s_add_u32 m0, s7, 89088
    s_nop 0
    buffer_load_dwordx4 v6, s[20:23], 0 offen lds
    s_cmp_ge_u32 s66, 11264
    s_cselect_b32 s7, 7168, 0
    s_add_u32 s7, s7, s66
    s_lshl_b32 s7, s7, 4
    s_mul_i32 s70, s48, 360448
    s_add_u32 s0, s7, s70
    s_add_u32 s1, s0, 8192
    s_lshl_b32 s7, s49, 1
    v_add_u32 v5, s0, v4
    v_add_u32 v6, 8192, v5
    s_add_u32 m0, s7, 96256
    s_nop 0
    buffer_load_dwordx4 v5, s[20:23], 0 offen lds
    s_add_u32 m0, s7, 97280
    s_nop 0
    buffer_load_dwordx4 v6, s[20:23], 0 offen lds
    s_waitcnt vmcnt(22)
    ds_read_b64_tr_b16 v[224:225], v60 offset:24576
    ds_read_b64_tr_b16 v[226:227], v60 offset:25088
    ds_read_b64_tr_b16 v[228:229], v61 offset:24576
    ds_read_b64_tr_b16 v[230:231], v61 offset:25088
    s_waitcnt vmcnt(18)
    ds_read_b64_tr_b16 v[232:233], v60 offset:0
    ds_read_b64_tr_b16 v[234:235], v60 offset:512
    ds_read_b64_tr_b16 v[236:237], v61 offset:0
    ds_read_b64_tr_b16 v[238:239], v61 offset:512
    s_waitcnt vmcnt(14)
    ds_read_b64_tr_b16 v[240:241], v60 offset:8192
    ds_read_b64_tr_b16 v[242:243], v60 offset:8704
    ds_read_b64_tr_b16 v[244:245], v61 offset:8192
    ds_read_b64_tr_b16 v[246:247], v61 offset:8704
    s_waitcnt vmcnt(10)
    ds_read_b64_tr_b16 v[248:249], v60 offset:16384
    ds_read_b64_tr_b16 v[250:251], v60 offset:16896
    ds_read_b64_tr_b16 v[252:253], v61 offset:16384
    ds_read_b64_tr_b16 v[254:255], v61 offset:16896
    v_mov_b32 v73, 2
    ds_write_b32 v72, v73
    s_lshl_b32 s7, s67, 1
    s_add_u32 s7, s7, s68
    s_lshl_b32 s7, s7, 7
    s_lshl_b32 s70, s48, 2
    s_add_u32 s7, s7, s70
    v_add_u32 v3, s7, v0
    s_mov_b32 s50, 15
    s_mov_b32 s72, 1024
    s_mov_b32 s74, 0
    s_mov_b32 s51, 0
    v_lshlrev_b32 v3, 6, v3
    v_add_u32 v3, 8388608, v3
    s_lshl_b32 s7, s67, 2
    s_lshl_b32 s71, s68, 1
    s_add_u32 s7, s7, s71
    s_lshl_b32 s7, s7, 7
    s_mul_i32 s71, s3, 15
    s_add_u32 s7, s7, s71
    s_lshl_b32 s7, s7, 10
    v_lshl_add_u32 v1, v0, 4, s7
    v_add_u32 v2, 0x20000, v1
    s_waitcnt vmcnt(0)
    s_lshl_b32 s7, s48, 2
    s_add_u32 s7, s7, 163648
    v_mov_b32 v16, s7
    v_mov_b32 v17, 3
    ds_write_b32 v16, v17
    s_setprio 0
    s_branch L_poll
L_cffn:
    s_getpc_b64 s[78:79]
L_pcF:
    s_sub_u32 s78, s78, L_pcF-parallel_sum__sliding_local_dilated__dense_activation_gelu__prompt_kernel
    s_subb_u32 s79, s79, 0
    s_bfe_u32 s7, s2, 0x20003
    s_lshr_b32 s0, s2, 6
    s_lshl2_add_u32 s7, s0, s7
    s_mul_i32 s7, s7, 1536
    v_lshl_add_u32 v239, v0, 6, s7
    v_min_u32 v239, L_end-parallel_sum__sliding_local_dilated__dense_activation_gelu__prompt_kernel, v239
    v_and_b32 v224, 15, v0
    v_lshrrev_b32 v225, 4, v0
    v_lshrrev_b32 v226, 1, v224
    v_xor_b32 v226, v226, v225
    v_lshlrev_b32 v226, 4, v226
    v_lshl_add_u32 v1, v224, 7, v226
    v_xor_b32 v2, 64, v1
    s_lshl_b32 s7, s3, 12
    s_add_u32 s7, s7, 2048
    v_add_u32 v1, s7, v1
    v_add_u32 v2, s7, v2
    v_lshrrev_b32 v230, 4, v0
    v_bfe_u32 v231, v0, 2, 2
    v_and_b32 v232, 3, v0
    v_and_b32 v233, 1, v230
    v_lshl_add_u32 v233, v233, 2, v231
    v_lshrrev_b32 v229, 1, v233
    v_lshrrev_b32 v230, 1, v230
    v_lshlrev_b32 v230, 11, v230
    v_lshl_add_u32 v230, v233, 7, v230
    v_lshl_add_u32 v230, v232, 3, v230
    v_add_u32 v228, 55296, v230
    v_mov_b32 v16, 0x3f803f80
    v_mov_b32 v17, 0x3f803f80
    v_mov_b32 v18, 0x3f803f80
    v_mov_b32 v19, 0x3f803f80
    s_cmp_lg_u32 s3, 0
    s_cbranch_scc1 L_nofl_5
    v_lshlrev_b32 v234, 2, v0
    v_and_b32 v234, 124, v234
    v_add_u32 v234, 163648, v234
    v_mov_b32 v235, 0
    ds_write_b32 v234, v235
L_nofl_5:
    s_and_b32 s72, s5, 1
    s_lshr_b32 s73, s5, 1
    s_mul_i32 s73, s73, 15
    s_lshl_b32 s7, s72, 2
    s_add_u32 s73, s73, s7
    s_mov_b32 s100, s3
    s_sub_u32 s101, s100, 3
    s_min_u32 s100, s101, s100
    s_sub_u32 s101, s100, 3
    s_min_u32 s100, s101, s100
    s_sub_u32 s101, s100, 3
    s_min_u32 s100, s101, s100
    s_sub_u32 s101, s100, 3
    s_min_u32 s100, s101, s100
    s_sub_u32 s101, s100, 3
    s_min_u32 s100, s101, s100
    s_sub_u32 s101, s100, 3
    s_min_u32 s100, s101, s100
    s_sub_u32 s101, s100, 3
    s_min_u32 s100, s101, s100
    s_sub_u32 s101, s100, 3
    s_min_u32 s100, s101, s100
    s_sub_u32 s101, s100, 3
    s_min_u32 s100, s101, s100
    s_sub_u32 s101, s100, 3
    s_min_u32 s100, s101, s100
    s_add_u32 s7, s3, 0
    s_and_b32 s7, s7, 3
    s_add_u32 s70, s7, s72
    s_and_b32 s71, s70, 3
    v_xor_b32 v230, s71, v229
    s_lshr_b32 s70, s70, 2
    s_lshl_b32 s70, s70, 13
    v_lshl_add_u32 v230, v230, 5, v228
    v_add_u32 v3, s70, v230
    s_add_u32 s70, s7, 60
    s_add_u32 s70, s70, s73
    s_lshl_b32 s70, s70, 10
    s_or_b32 s52, s70, s7
    s_add_u32 s7, s3, 1
    s_and_b32 s7, s7, 3
    s_add_u32 s70, s7, s72
    s_and_b32 s71, s70, 3
    v_xor_b32 v230, s71, v229
    s_lshr_b32 s70, s70, 2
    s_lshl_b32 s70, s70, 13
    v_lshl_add_u32 v230, v230, 5, v228
    v_add_u32 v4, s70, v230
    s_add_u32 s70, s7, 60
    s_add_u32 s70, s70, s73
    s_lshl_b32 s70, s70, 10
    s_or_b32 s53, s70, s7
    s_add_u32 s7, s3, 2
    s_and_b32 s7, s7, 3
    s_add_u32 s70, s7, s72
    s_and_b32 s71, s70, 3
    v_xor_b32 v230, s71, v229
    s_lshr_b32 s70, s70, 2
    s_lshl_b32 s70, s70, 13
    v_lshl_add_u32 v230, v230, 5, v228
    v_add_u32 v5, s70, v230
    s_add_u32 s70, s7, 60
    s_add_u32 s70, s70, s73
    s_lshl_b32 s70, s70, 10
    s_or_b32 s54, s70, s7
    s_add_u32 s7, s3, 3
    s_and_b32 s7, s7, 3
    s_add_u32 s70, s7, s72
    s_and_b32 s71, s70, 3
    v_xor_b32 v230, s71, v229
    s_lshr_b32 s70, s70, 2
    s_lshl_b32 s70, s70, 13
    v_lshl_add_u32 v230, v230, 5, v228
    v_add_u32 v6, s70, v230
    s_add_u32 s70, s7, 60
    s_add_u32 s70, s70, s73
    s_lshl_b32 s70, s70, 10
    s_or_b32 s55, s70, s7
    s_add_u32 s7, s3, 4
    s_and_b32 s7, s7, 3
    s_add_u32 s7, s7, 4
    s_add_u32 s70, s7, s72
    s_and_b32 s71, s70, 3
    v_xor_b32 v230, s71, v229
    s_lshr_b32 s70, s70, 2
    s_lshl_b32 s70, s70, 13
    v_lshl_add_u32 v230, v230, 5, v228
    v_add_u32 v7, s70, v230
    s_add_u32 s101, s7, s72
    s_cmp_lt_u32 s101, 8
    s_cselect_b32 s70, 64, 0
    s_add_u32 s70, s70, s7
    s_add_u32 s70, s70, s73
    s_lshl_b32 s70, s70, 10
    s_or_b32 s56, s70, s7
    s_add_u32 s7, s3, 5
    s_and_b32 s7, s7, 3
    s_add_u32 s7, s7, 4
    s_add_u32 s70, s7, s72
    s_and_b32 s71, s70, 3
    v_xor_b32 v230, s71, v229
    s_lshr_b32 s70, s70, 2
    s_lshl_b32 s70, s70, 13
    v_lshl_add_u32 v230, v230, 5, v228
    v_add_u32 v8, s70, v230
    s_add_u32 s101, s7, s72
    s_cmp_lt_u32 s101, 8
    s_cselect_b32 s70, 64, 0
    s_add_u32 s70, s70, s7
    s_add_u32 s70, s70, s73
    s_lshl_b32 s70, s70, 10
    s_or_b32 s57, s70, s7
    s_add_u32 s7, s3, 6
    s_and_b32 s7, s7, 3
    s_add_u32 s7, s7, 4
    s_add_u32 s70, s7, s72
    s_and_b32 s71, s70, 3
    v_xor_b32 v230, s71, v229
    s_lshr_b32 s70, s70, 2
    s_lshl_b32 s70, s70, 13
    v_lshl_add_u32 v230, v230, 5, v228
    v_add_u32 v9, s70, v230
    s_add_u32 s101, s7, s72
    s_cmp_lt_u32 s101, 8
    s_cselect_b32 s70, 64, 0
    s_add_u32 s70, s70, s7
    s_add_u32 s70, s70, s73
    s_lshl_b32 s70, s70, 10
    s_or_b32 s58, s70, s7
    s_add_u32 s7, s3, 7
    s_and_b32 s7, s7, 3
    s_add_u32 s7, s7, 4
    s_add_u32 s70, s7, s72
    s_and_b32 s71, s70, 3
    v_xor_b32 v230, s71, v229
    s_lshr_b32 s70, s70, 2
    s_lshl_b32 s70, s70, 13
    v_lshl_add_u32 v230, v230, 5, v228
    v_add_u32 v10, s70, v230
    s_add_u32 s101, s7, s72
    s_cmp_lt_u32 s101, 8
    s_cselect_b32 s70, 64, 0
    s_add_u32 s70, s70, s7
    s_add_u32 s70, s70, s73
    s_lshl_b32 s70, s70, 10
    s_or_b32 s59, s70, s7
    s_add_u32 s7, s100, 0
    s_sub_u32 s101, s7, 3
    s_min_u32 s7, s101, s7
    s_add_u32 s7, s7, 8
    s_add_u32 s70, s7, s72
    s_and_b32 s71, s70, 3
    v_xor_b32 v230, s71, v229
    s_lshr_b32 s70, s70, 2
    s_lshl_b32 s70, s70, 13
    v_lshl_add_u32 v230, v230, 5, v228
    v_add_u32 v11, s70, v230
    s_mov_b32 s70, s7
    s_add_u32 s70, s70, s73
    s_lshl_b32 s70, s70, 10
    s_or_b32 s60, s70, s7
    s_add_u32 s7, s100, 1
    s_sub_u32 s101, s7, 3
    s_min_u32 s7, s101, s7
    s_add_u32 s7, s7, 8
    s_add_u32 s70, s7, s72
    s_and_b32 s71, s70, 3
    v_xor_b32 v230, s71, v229
    s_lshr_b32 s70, s70, 2
    s_lshl_b32 s70, s70, 13
    v_lshl_add_u32 v230, v230, 5, v228
    v_add_u32 v12, s70, v230
    s_mov_b32 s70, s7
    s_add_u32 s70, s70, s73
    s_lshl_b32 s70, s70, 10
    s_or_b32 s61, s70, s7
    s_add_u32 s7, s100, 2
    s_sub_u32 s101, s7, 3
    s_min_u32 s7, s101, s7
    s_add_u32 s7, s7, 8
    s_add_u32 s70, s7, s72
    s_and_b32 s71, s70, 3
    v_xor_b32 v230, s71, v229
    s_lshr_b32 s70, s70, 2
    s_lshl_b32 s70, s70, 13
    v_lshl_add_u32 v230, v230, 5, v228
    v_add_u32 v13, s70, v230
    s_mov_b32 s70, s7
    s_add_u32 s70, s70, s73
    s_lshl_b32 s70, s70, 10
    s_or_b32 s62, s70, s7
    s_lshl_b32 s7, s4, 2
    s_add_u32 s7, s7, s3
    s_lshl_b32 s7, s7, 17
    v_lshl_add_u32 v14, v0, 4, s7
    s_lshl_b32 s7, s4, 1
    s_lshr_b32 s70, s3, 1
    s_add_u32 s7, s7, s70
    s_lshl_b32 s7, s7, 7
    s_lshl_b32 s70, s5, 1
    s_add_u32 s7, s7, s70
    s_and_b32 s70, s3, 1
    s_add_u32 s7, s7, s70
    s_lshl_b32 s7, s7, 6
    s_add_u32 s74, s7, 8388608
    v_mov_b32 v246, 0xc0135761
    v_mov_b32 v248, 0xbdd2d3e8
    v_mov_b32 v250, 1.0
    v_mov_b32 v247, 0xc0135761
    v_mov_b32 v249, 0xbdd2d3e8
    v_mov_b32 v251, 1.0
    v_lshlrev_b32 v15, 3, v225
    s_lshl_b32 s7, s3, 8
    s_add_u32 s7, s7, 161920
    v_lshl_add_u32 v255, v224, 2, s7
    s_mul_i32 s7, s2, 6
    s_lshl_b32 s70, s3, 1
    s_add_u32 s7, s7, s70
    s_lshl_b32 s7, s7, 10
    v_lshl_add_u32 v224, v0, 4, s7
    s_lshl_b32 s7, s2, 11
    v_lshl_add_u32 v225, v0, 4, s7
    s_waitcnt lgkmcnt(0)
    s_cmp_eq_u32 s3, 3
    s_cbranch_scc1 L_pf3_6
    buffer_load_dwordx4 v[228:231], v224, s[20:23], 0 offen
    buffer_load_dwordx4 v[232:235], v224, s[20:23], 0 offen offset:1024
    s_branch L_pfd_7
L_pf3_6:
    buffer_load_dwordx4 v[228:231], v225, s[16:19], 0 offen
    buffer_load_dwordx4 v[232:235], v225, s[16:19], 0 offen offset:1024
L_pfd_7:
    v_lshrrev_b32 v241, 1, v0
    v_and_b32 v242, 1, v0
    v_lshlrev_b32 v242, 6, v242
    s_bfe_u32 s7, s2, 0x20003
    s_lshr_b32 s70, s2, 6
    s_lshl2_add_u32 s7, s70, s7
    s_waitcnt lgkmcnt(0)
    s_barrier
    s_setprio 2
    ds_read_b64_tr_b16 v[128:129], v3 offset:0
    ds_read_b64_tr_b16 v[130:131], v3 offset:1024
    ds_read_b128 v[120:123], v1 offset:0
    ds_read_b128 v[124:127], v1 offset:2048
    ds_read_b64_tr_b16 v[132:133], v4 offset:0
    ds_read_b64_tr_b16 v[134:135], v4 offset:1024
    ds_read_b64_tr_b16 v[136:137], v5 offset:0
    ds_read_b64_tr_b16 v[138:139], v5 offset:1024
    ds_read_b64_tr_b16 v[140:141], v6 offset:0
    ds_read_b64_tr_b16 v[142:143], v6 offset:1024
    ds_read_b64_tr_b16 v[144:145], v7 offset:0
    ds_read_b64_tr_b16 v[146:147], v7 offset:1024
    ds_read_b64_tr_b16 v[148:149], v8 offset:0
    ds_read_b64_tr_b16 v[150:151], v8 offset:1024
    ds_read_b64_tr_b16 v[152:153], v9 offset:0
    ds_read_b64_tr_b16 v[154:155], v9 offset:1024
    ds_read_b64_tr_b16 v[156:157], v10 offset:0
    ds_read_b64_tr_b16 v[158:159], v10 offset:1024
    ds_read_b64_tr_b16 v[160:161], v11 offset:0
    ds_read_b64_tr_b16 v[162:163], v11 offset:1024
    ds_read_b64_tr_b16 v[164:165], v12 offset:0
    ds_read_b64_tr_b16 v[166:167], v12 offset:1024
    ds_read_b64_tr_b16 v[168:169], v13 offset:0
    ds_read_b64_tr_b16 v[170:171], v13 offset:1024
    ds_read_b64_tr_b16 v[180:181], v3 offset:4096
    ds_read_b64_tr_b16 v[182:183], v3 offset:5120
    s_waitcnt lgkmcnt(15)
    v_mfma_f32_16x16x32_bf16 v[20:23], v[128:131], v[120:123], 0
    ds_read_b128 v[172:175], v2 offset:0
    v_mfma_f32_16x16x32_bf16 v[24:27], v[128:131], v[124:127], 0
    ds_read_b128 v[176:179], v2 offset:2048
    v_mfma_f32_16x16x32_bf16 v[108:111], v[128:131], v[16:19], 0
    ds_read_b64_tr_b16 v[184:185], v4 offset:4096
    ds_read_b64_tr_b16 v[186:187], v4 offset:5120
    v_mfma_f32_16x16x32_bf16 v[28:31], v[132:135], v[120:123], 0
    ds_read_b64_tr_b16 v[188:189], v5 offset:4096
    v_mfma_f32_16x16x32_bf16 v[32:35], v[132:135], v[124:127], 0
    ds_read_b64_tr_b16 v[190:191], v5 offset:5120
    v_mfma_f32_16x16x32_bf16 v[36:39], v[136:139], v[120:123], 0
    ds_read_b64_tr_b16 v[192:193], v6 offset:4096
    v_mfma_f32_16x16x32_bf16 v[40:43], v[136:139], v[124:127], 0
    ds_read_b64_tr_b16 v[194:195], v6 offset:5120
    ds_read_b64_tr_b16 v[196:197], v7 offset:4096
    v_mfma_f32_16x16x32_bf16 v[44:47], v[140:143], v[120:123], 0
    ds_read_b64_tr_b16 v[198:199], v7 offset:5120
    v_mfma_f32_16x16x32_bf16 v[48:51], v[140:143], v[124:127], 0
    ds_read_b64_tr_b16 v[200:201], v8 offset:4096
    s_waitcnt lgkmcnt(15)
    v_mfma_f32_16x16x32_bf16 v[52:55], v[144:147], v[120:123], 0
    ds_read_b64_tr_b16 v[202:203], v8 offset:5120
    ds_read_b64_tr_b16 v[204:205], v9 offset:4096
    v_mfma_f32_16x16x32_bf16 v[56:59], v[144:147], v[124:127], 0
    ds_read_b64_tr_b16 v[206:207], v9 offset:5120
    v_mfma_f32_16x16x32_bf16 v[112:115], v[144:147], v[16:19], 0
    ds_read_b64_tr_b16 v[208:209], v10 offset:4096
    v_mfma_f32_16x16x32_bf16 v[60:63], v[148:151], v[120:123], 0
    ds_read_b64_tr_b16 v[210:211], v10 offset:5120
    v_mfma_f32_16x16x32_bf16 v[64:67], v[148:151], v[124:127], 0
    ds_read_b64_tr_b16 v[212:213], v11 offset:4096
    ds_read_b64_tr_b16 v[214:215], v11 offset:5120
    v_mfma_f32_16x16x32_bf16 v[68:71], v[152:155], v[120:123], 0
    ds_read_b64_tr_b16 v[216:217], v12 offset:4096
    v_mfma_f32_16x16x32_bf16 v[72:75], v[152:155], v[124:127], 0
    ds_read_b64_tr_b16 v[218:219], v12 offset:5120
    v_mfma_f32_16x16x32_bf16 v[76:79], v[156:159], v[120:123], 0
    ds_read_b64_tr_b16 v[220:221], v13 offset:4096
    ds_read_b64_tr_b16 v[222:223], v13 offset:5120
    v_mfma_f32_16x16x32_bf16 v[80:83], v[156:159], v[124:127], 0
    v_mfma_f32_16x16x32_bf16 v[84:87], v[160:163], v[120:123], 0
    v_mfma_f32_16x16x32_bf16 v[88:91], v[160:163], v[124:127], 0
    v_mfma_f32_16x16x32_bf16 v[116:119], v[160:163], v[16:19], 0
    v_mfma_f32_16x16x32_bf16 v[92:95], v[164:167], v[120:123], 0
    v_mfma_f32_16x16x32_bf16 v[96:99], v[164:167], v[124:127], 0
    s_waitcnt lgkmcnt(15)
    v_mfma_f32_16x16x32_bf16 v[100:103], v[168:171], v[120:123], 0
    v_mfma_f32_16x16x32_bf16 v[104:107], v[168:171], v[124:127], 0
    v_mfma_f32_16x16x32_bf16 v[20:23], v[180:183], v[172:175], v[20:23]
    v_mfma_f32_16x16x32_bf16 v[24:27], v[180:183], v[176:179], v[24:27]
    v_mfma_f32_16x16x32_bf16 v[108:111], v[180:183], v[16:19], v[108:111]
    v_mfma_f32_16x16x32_bf16 v[28:31], v[184:187], v[172:175], v[28:31]
    v_mfma_f32_16x16x32_bf16 v[32:35], v[184:187], v[176:179], v[32:35]
    s_waitcnt lgkmcnt(0)
    s_barrier
    ds_read_b64_tr_b16 v[128:129], v3 offset:24576
    ds_read_b64_tr_b16 v[130:131], v3 offset:25600
    v_mfma_f32_16x16x32_bf16 v[36:39], v[188:191], v[172:175], v[36:39]
    ds_read_b128 v[120:123], v1 offset:18432
    v_mfma_f32_16x16x32_bf16 v[40:43], v[188:191], v[176:179], v[40:43]
    ds_read_b128 v[124:127], v1 offset:20480
    v_mfma_f32_16x16x32_bf16 v[44:47], v[192:195], v[172:175], v[44:47]
    ds_read_b64_tr_b16 v[132:133], v4 offset:24576
    ds_read_b64_tr_b16 v[134:135], v4 offset:25600
    v_mfma_f32_16x16x32_bf16 v[48:51], v[192:195], v[176:179], v[48:51]
    ds_read_b64_tr_b16 v[136:137], v5 offset:24576
    v_mfma_f32_16x16x32_bf16 v[52:55], v[196:199], v[172:175], v[52:55]
    ds_read_b64_tr_b16 v[138:139], v5 offset:25600
    v_mfma_f32_16x16x32_bf16 v[56:59], v[196:199], v[176:179], v[56:59]
    ds_read_b64_tr_b16 v[140:141], v6 offset:24576
    ds_read_b64_tr_b16 v[142:143], v6 offset:25600
    v_mfma_f32_16x16x32_bf16 v[112:115], v[196:199], v[16:19], v[112:115]
    ds_read_b64_tr_b16 v[144:145], v7 offset:24576
    v_mfma_f32_16x16x32_bf16 v[60:63], v[200:203], v[172:175], v[60:63]
    ds_read_b64_tr_b16 v[146:147], v7 offset:25600
    v_mfma_f32_16x16x32_bf16 v[64:67], v[200:203], v[176:179], v[64:67]
    ds_read_b64_tr_b16 v[148:149], v8 offset:24576
    ds_read_b64_tr_b16 v[150:151], v8 offset:25600
    v_mfma_f32_16x16x32_bf16 v[68:71], v[204:207], v[172:175], v[68:71]
    ds_read_b64_tr_b16 v[152:153], v9 offset:24576
    v_mfma_f32_16x16x32_bf16 v[72:75], v[204:207], v[176:179], v[72:75]
    ds_read_b64_tr_b16 v[154:155], v9 offset:25600
    v_mfma_f32_16x16x32_bf16 v[76:79], v[208:211], v[172:175], v[76:79]
    ds_read_b64_tr_b16 v[156:157], v10 offset:24576
    ds_read_b64_tr_b16 v[158:159], v10 offset:25600
    v_mfma_f32_16x16x32_bf16 v[80:83], v[208:211], v[176:179], v[80:83]
    ds_read_b64_tr_b16 v[160:161], v11 offset:24576
    v_mfma_f32_16x16x32_bf16 v[84:87], v[212:215], v[172:175], v[84:87]
    ds_read_b64_tr_b16 v[162:163], v11 offset:25600
    v_mfma_f32_16x16x32_bf16 v[88:91], v[212:215], v[176:179], v[88:91]
    ds_read_b64_tr_b16 v[164:165], v12 offset:24576
    ds_read_b64_tr_b16 v[166:167], v12 offset:25600
    v_mfma_f32_16x16x32_bf16 v[116:119], v[212:215], v[16:19], v[116:119]
    ds_read_b64_tr_b16 v[168:169], v13 offset:24576
    v_mfma_f32_16x16x32_bf16 v[92:95], v[216:219], v[172:175], v[92:95]
    ds_read_b64_tr_b16 v[170:171], v13 offset:25600
    v_mfma_f32_16x16x32_bf16 v[96:99], v[216:219], v[176:179], v[96:99]
    v_mfma_f32_16x16x32_bf16 v[100:103], v[220:223], v[172:175], v[100:103]
    v_mfma_f32_16x16x32_bf16 v[104:107], v[220:223], v[176:179], v[104:107]
    s_cmp_lg_u32 s3, 0
    s_cbranch_scc1 L_nocp_8
    s_mov_b64 exec, 0xffffff
    global_load_dword v236, v239, s[78:79]
    s_mov_b64 exec, -1
L_nocp_8:
    ds_read_b64_tr_b16 v[180:181], v3 offset:28672
    ds_read_b64_tr_b16 v[182:183], v3 offset:29696
    s_waitcnt lgkmcnt(15)
    v_mfma_f32_16x16x32_bf16 v[20:23], v[128:131], v[120:123], v[20:23]
    ds_read_b128 v[172:175], v2 offset:18432
    v_mfma_f32_16x16x32_bf16 v[24:27], v[128:131], v[124:127], v[24:27]
    ds_read_b128 v[176:179], v2 offset:20480
    v_mfma_f32_16x16x32_bf16 v[108:111], v[128:131], v[16:19], v[108:111]
    ds_read_b64_tr_b16 v[184:185], v4 offset:28672
    ds_read_b64_tr_b16 v[186:187], v4 offset:29696
    v_mfma_f32_16x16x32_bf16 v[28:31], v[132:135], v[120:123], v[28:31]
    ds_read_b64_tr_b16 v[188:189], v5 offset:28672
    v_mfma_f32_16x16x32_bf16 v[32:35], v[132:135], v[124:127], v[32:35]
    ds_read_b64_tr_b16 v[190:191], v5 offset:29696
    v_mfma_f32_16x16x32_bf16 v[36:39], v[136:139], v[120:123], v[36:39]
    ds_read_b64_tr_b16 v[192:193], v6 offset:28672
    v_mfma_f32_16x16x32_bf16 v[40:43], v[136:139], v[124:127], v[40:43]
    ds_read_b64_tr_b16 v[194:195], v6 offset:29696
    ds_read_b64_tr_b16 v[196:197], v7 offset:28672
    v_mfma_f32_16x16x32_bf16 v[44:47], v[140:143], v[120:123], v[44:47]
    ds_read_b64_tr_b16 v[198:199], v7 offset:29696
    v_mfma_f32_16x16x32_bf16 v[48:51], v[140:143], v[124:127], v[48:51]
    ds_read_b64_tr_b16 v[200:201], v8 offset:28672
    s_waitcnt lgkmcnt(15)
    v_mfma_f32_16x16x32_bf16 v[52:55], v[144:147], v[120:123], v[52:55]
    ds_read_b64_tr_b16 v[202:203], v8 offset:29696
    ds_read_b64_tr_b16 v[204:205], v9 offset:28672
    v_mfma_f32_16x16x32_bf16 v[56:59], v[144:147], v[124:127], v[56:59]
    ds_read_b64_tr_b16 v[206:207], v9 offset:29696
    v_mfma_f32_16x16x32_bf16 v[112:115], v[144:147], v[16:19], v[112:115]
    ds_read_b64_tr_b16 v[208:209], v10 offset:28672
    v_mfma_f32_16x16x32_bf16 v[60:63], v[148:151], v[120:123], v[60:63]
    ds_read_b64_tr_b16 v[210:211], v10 offset:29696
    v_mfma_f32_16x16x32_bf16 v[64:67], v[148:151], v[124:127], v[64:67]
    ds_read_b64_tr_b16 v[212:213], v11 offset:28672
    ds_read_b64_tr_b16 v[214:215], v11 offset:29696
    v_mfma_f32_16x16x32_bf16 v[68:71], v[152:155], v[120:123], v[68:71]
    ds_read_b64_tr_b16 v[216:217], v12 offset:28672
    v_mfma_f32_16x16x32_bf16 v[72:75], v[152:155], v[124:127], v[72:75]
    ds_read_b64_tr_b16 v[218:219], v12 offset:29696
    v_mfma_f32_16x16x32_bf16 v[76:79], v[156:159], v[120:123], v[76:79]
    ds_read_b64_tr_b16 v[220:221], v13 offset:28672
    ds_read_b64_tr_b16 v[222:223], v13 offset:29696
    v_mfma_f32_16x16x32_bf16 v[80:83], v[156:159], v[124:127], v[80:83]
    v_mfma_f32_16x16x32_bf16 v[84:87], v[160:163], v[120:123], v[84:87]
    v_mfma_f32_16x16x32_bf16 v[88:91], v[160:163], v[124:127], v[88:91]
    v_mfma_f32_16x16x32_bf16 v[116:119], v[160:163], v[16:19], v[116:119]
    v_mfma_f32_16x16x32_bf16 v[92:95], v[164:167], v[120:123], v[92:95]
    v_mfma_f32_16x16x32_bf16 v[96:99], v[164:167], v[124:127], v[96:99]
    s_waitcnt lgkmcnt(15)
    v_mfma_f32_16x16x32_bf16 v[100:103], v[168:171], v[120:123], v[100:103]
    v_mfma_f32_16x16x32_bf16 v[104:107], v[168:171], v[124:127], v[104:107]
    v_mfma_f32_16x16x32_bf16 v[20:23], v[180:183], v[172:175], v[20:23]
    v_mfma_f32_16x16x32_bf16 v[24:27], v[180:183], v[176:179], v[24:27]
    v_mfma_f32_16x16x32_bf16 v[108:111], v[180:183], v[16:19], v[108:111]
    v_mfma_f32_16x16x32_bf16 v[28:31], v[184:187], v[172:175], v[28:31]
    v_mfma_f32_16x16x32_bf16 v[32:35], v[184:187], v[176:179], v[32:35]
    s_waitcnt lgkmcnt(0)
    s_barrier
    ds_read_b64_tr_b16 v[128:129], v3 offset:49152
    ds_read_b64_tr_b16 v[130:131], v3 offset:50176
    v_mfma_f32_16x16x32_bf16 v[36:39], v[188:191], v[172:175], v[36:39]
    ds_read_b128 v[120:123], v1 offset:36864
    v_mfma_f32_16x16x32_bf16 v[40:43], v[188:191], v[176:179], v[40:43]
    ds_read_b128 v[124:127], v1 offset:38912
    v_mfma_f32_16x16x32_bf16 v[44:47], v[192:195], v[172:175], v[44:47]
    ds_read_b64_tr_b16 v[132:133], v4 offset:49152
    ds_read_b64_tr_b16 v[134:135], v4 offset:50176
    v_mfma_f32_16x16x32_bf16 v[48:51], v[192:195], v[176:179], v[48:51]
    ds_read_b64_tr_b16 v[136:137], v5 offset:49152
    v_mfma_f32_16x16x32_bf16 v[52:55], v[196:199], v[172:175], v[52:55]
    ds_read_b64_tr_b16 v[138:139], v5 offset:50176
    v_mfma_f32_16x16x32_bf16 v[56:59], v[196:199], v[176:179], v[56:59]
    ds_read_b64_tr_b16 v[140:141], v6 offset:49152
    ds_read_b64_tr_b16 v[142:143], v6 offset:50176
    v_mfma_f32_16x16x32_bf16 v[112:115], v[196:199], v[16:19], v[112:115]
    ds_read_b64_tr_b16 v[144:145], v7 offset:49152
    v_mfma_f32_16x16x32_bf16 v[60:63], v[200:203], v[172:175], v[60:63]
    ds_read_b64_tr_b16 v[146:147], v7 offset:50176
    v_mfma_f32_16x16x32_bf16 v[64:67], v[200:203], v[176:179], v[64:67]
    ds_read_b64_tr_b16 v[148:149], v8 offset:49152
    ds_read_b64_tr_b16 v[150:151], v8 offset:50176
    v_mfma_f32_16x16x32_bf16 v[68:71], v[204:207], v[172:175], v[68:71]
    ds_read_b64_tr_b16 v[152:153], v9 offset:49152
    v_mfma_f32_16x16x32_bf16 v[72:75], v[204:207], v[176:179], v[72:75]
    ds_read_b64_tr_b16 v[154:155], v9 offset:50176
    v_mfma_f32_16x16x32_bf16 v[76:79], v[208:211], v[172:175], v[76:79]
    ds_read_b64_tr_b16 v[156:157], v10 offset:49152
    ds_read_b64_tr_b16 v[158:159], v10 offset:50176
    v_mfma_f32_16x16x32_bf16 v[80:83], v[208:211], v[176:179], v[80:83]
    ds_read_b64_tr_b16 v[160:161], v11 offset:49152
    v_mfma_f32_16x16x32_bf16 v[84:87], v[212:215], v[172:175], v[84:87]
    ds_read_b64_tr_b16 v[162:163], v11 offset:50176
    v_mfma_f32_16x16x32_bf16 v[88:91], v[212:215], v[176:179], v[88:91]
    ds_read_b64_tr_b16 v[164:165], v12 offset:49152
    ds_read_b64_tr_b16 v[166:167], v12 offset:50176
    v_mfma_f32_16x16x32_bf16 v[116:119], v[212:215], v[16:19], v[116:119]
    ds_read_b64_tr_b16 v[168:169], v13 offset:49152
    v_mfma_f32_16x16x32_bf16 v[92:95], v[216:219], v[172:175], v[92:95]
    ds_read_b64_tr_b16 v[170:171], v13 offset:50176
    v_mfma_f32_16x16x32_bf16 v[96:99], v[216:219], v[176:179], v[96:99]
    v_mfma_f32_16x16x32_bf16 v[100:103], v[220:223], v[172:175], v[100:103]
    v_mfma_f32_16x16x32_bf16 v[104:107], v[220:223], v[176:179], v[104:107]
    ds_read_b64_tr_b16 v[180:181], v3 offset:53248
    ds_read_b64_tr_b16 v[182:183], v3 offset:54272
    s_waitcnt lgkmcnt(15)
    v_mfma_f32_16x16x32_bf16 v[20:23], v[128:131], v[120:123], v[20:23]
    ds_read_b128 v[172:175], v2 offset:36864
    v_mfma_f32_16x16x32_bf16 v[24:27], v[128:131], v[124:127], v[24:27]
    ds_read_b128 v[176:179], v2 offset:38912
    v_mfma_f32_16x16x32_bf16 v[108:111], v[128:131], v[16:19], v[108:111]
    ds_read_b64_tr_b16 v[184:185], v4 offset:53248
    ds_read_b64_tr_b16 v[186:187], v4 offset:54272
    v_mfma_f32_16x16x32_bf16 v[28:31], v[132:135], v[120:123], v[28:31]
    ds_read_b64_tr_b16 v[188:189], v5 offset:53248
    v_mfma_f32_16x16x32_bf16 v[32:35], v[132:135], v[124:127], v[32:35]
    ds_read_b64_tr_b16 v[190:191], v5 offset:54272
    v_mfma_f32_16x16x32_bf16 v[36:39], v[136:139], v[120:123], v[36:39]
    ds_read_b64_tr_b16 v[192:193], v6 offset:53248
    v_mfma_f32_16x16x32_bf16 v[40:43], v[136:139], v[124:127], v[40:43]
    ds_read_b64_tr_b16 v[194:195], v6 offset:54272
    ds_read_b64_tr_b16 v[196:197], v7 offset:53248
    v_mfma_f32_16x16x32_bf16 v[44:47], v[140:143], v[120:123], v[44:47]
    ds_read_b64_tr_b16 v[198:199], v7 offset:54272
    v_mfma_f32_16x16x32_bf16 v[48:51], v[140:143], v[124:127], v[48:51]
    ds_read_b64_tr_b16 v[200:201], v8 offset:53248
    s_waitcnt lgkmcnt(15)
    v_mfma_f32_16x16x32_bf16 v[52:55], v[144:147], v[120:123], v[52:55]
    ds_read_b64_tr_b16 v[202:203], v8 offset:54272
    ds_read_b64_tr_b16 v[204:205], v9 offset:53248
    v_mfma_f32_16x16x32_bf16 v[56:59], v[144:147], v[124:127], v[56:59]
    ds_read_b64_tr_b16 v[206:207], v9 offset:54272
    v_mfma_f32_16x16x32_bf16 v[112:115], v[144:147], v[16:19], v[112:115]
    ds_read_b64_tr_b16 v[208:209], v10 offset:53248
    v_mfma_f32_16x16x32_bf16 v[60:63], v[148:151], v[120:123], v[60:63]
    ds_read_b64_tr_b16 v[210:211], v10 offset:54272
    v_mfma_f32_16x16x32_bf16 v[64:67], v[148:151], v[124:127], v[64:67]
    ds_read_b64_tr_b16 v[212:213], v11 offset:53248
    ds_read_b64_tr_b16 v[214:215], v11 offset:54272
    v_mfma_f32_16x16x32_bf16 v[68:71], v[152:155], v[120:123], v[68:71]
    ds_read_b64_tr_b16 v[216:217], v12 offset:53248
    v_mfma_f32_16x16x32_bf16 v[72:75], v[152:155], v[124:127], v[72:75]
    ds_read_b64_tr_b16 v[218:219], v12 offset:54272
    v_mfma_f32_16x16x32_bf16 v[76:79], v[156:159], v[120:123], v[76:79]
    ds_read_b64_tr_b16 v[220:221], v13 offset:53248
    ds_read_b64_tr_b16 v[222:223], v13 offset:54272
    v_mfma_f32_16x16x32_bf16 v[80:83], v[156:159], v[124:127], v[80:83]
    v_mfma_f32_16x16x32_bf16 v[84:87], v[160:163], v[120:123], v[84:87]
    v_mfma_f32_16x16x32_bf16 v[88:91], v[160:163], v[124:127], v[88:91]
    v_mfma_f32_16x16x32_bf16 v[116:119], v[160:163], v[16:19], v[116:119]
    v_mfma_f32_16x16x32_bf16 v[92:95], v[164:167], v[120:123], v[92:95]
    v_mfma_f32_16x16x32_bf16 v[96:99], v[164:167], v[124:127], v[96:99]
    s_waitcnt lgkmcnt(15)
    v_mfma_f32_16x16x32_bf16 v[100:103], v[168:171], v[120:123], v[100:103]
    v_mfma_f32_16x16x32_bf16 v[104:107], v[168:171], v[124:127], v[104:107]
    v_mfma_f32_16x16x32_bf16 v[20:23], v[180:183], v[172:175], v[20:23]
    v_mfma_f32_16x16x32_bf16 v[24:27], v[180:183], v[176:179], v[24:27]
    v_mfma_f32_16x16x32_bf16 v[108:111], v[180:183], v[16:19], v[108:111]
    v_mfma_f32_16x16x32_bf16 v[28:31], v[184:187], v[172:175], v[28:31]
    v_mfma_f32_16x16x32_bf16 v[32:35], v[184:187], v[176:179], v[32:35]
    s_waitcnt lgkmcnt(0)
    s_barrier
    ds_read_b64_tr_b16 v[128:129], v3 offset:0
    ds_read_b64_tr_b16 v[130:131], v3 offset:1024
    v_mfma_f32_16x16x32_bf16 v[36:39], v[188:191], v[172:175], v[36:39]
    ds_read_b128 v[120:123], v1 offset:0
    v_mfma_f32_16x16x32_bf16 v[40:43], v[188:191], v[176:179], v[40:43]
    ds_read_b128 v[124:127], v1 offset:2048
    v_mfma_f32_16x16x32_bf16 v[44:47], v[192:195], v[172:175], v[44:47]
    ds_read_b64_tr_b16 v[132:133], v4 offset:0
    ds_read_b64_tr_b16 v[134:135], v4 offset:1024
    v_mfma_f32_16x16x32_bf16 v[48:51], v[192:195], v[176:179], v[48:51]
    ds_read_b64_tr_b16 v[136:137], v5 offset:0
    v_mfma_f32_16x16x32_bf16 v[52:55], v[196:199], v[172:175], v[52:55]
    ds_read_b64_tr_b16 v[138:139], v5 offset:1024
    v_mfma_f32_16x16x32_bf16 v[56:59], v[196:199], v[176:179], v[56:59]
    ds_read_b64_tr_b16 v[140:141], v6 offset:0
    ds_read_b64_tr_b16 v[142:143], v6 offset:1024
    v_mfma_f32_16x16x32_bf16 v[112:115], v[196:199], v[16:19], v[112:115]
    ds_read_b64_tr_b16 v[144:145], v7 offset:0
    v_mfma_f32_16x16x32_bf16 v[60:63], v[200:203], v[172:175], v[60:63]
    ds_read_b64_tr_b16 v[146:147], v7 offset:1024
    v_mfma_f32_16x16x32_bf16 v[64:67], v[200:203], v[176:179], v[64:67]
    ds_read_b64_tr_b16 v[148:149], v8 offset:0
    ds_read_b64_tr_b16 v[150:151], v8 offset:1024
    v_mfma_f32_16x16x32_bf16 v[68:71], v[204:207], v[172:175], v[68:71]
    ds_read_b64_tr_b16 v[152:153], v9 offset:0
    v_mfma_f32_16x16x32_bf16 v[72:75], v[204:207], v[176:179], v[72:75]
    ds_read_b64_tr_b16 v[154:155], v9 offset:1024
    v_mfma_f32_16x16x32_bf16 v[76:79], v[208:211], v[172:175], v[76:79]
    ds_read_b64_tr_b16 v[156:157], v10 offset:0
    ds_read_b64_tr_b16 v[158:159], v10 offset:1024
    v_mfma_f32_16x16x32_bf16 v[80:83], v[208:211], v[176:179], v[80:83]
    ds_read_b64_tr_b16 v[160:161], v11 offset:0
    v_mfma_f32_16x16x32_bf16 v[84:87], v[212:215], v[172:175], v[84:87]
    ds_read_b64_tr_b16 v[162:163], v11 offset:1024
    v_mfma_f32_16x16x32_bf16 v[88:91], v[212:215], v[176:179], v[88:91]
    ds_read_b64_tr_b16 v[164:165], v12 offset:0
    ds_read_b64_tr_b16 v[166:167], v12 offset:1024
    v_mfma_f32_16x16x32_bf16 v[116:119], v[212:215], v[16:19], v[116:119]
    ds_read_b64_tr_b16 v[168:169], v13 offset:0
    v_mfma_f32_16x16x32_bf16 v[92:95], v[216:219], v[172:175], v[92:95]
    ds_read_b64_tr_b16 v[170:171], v13 offset:1024
    v_mfma_f32_16x16x32_bf16 v[96:99], v[216:219], v[176:179], v[96:99]
    v_mfma_f32_16x16x32_bf16 v[100:103], v[220:223], v[172:175], v[100:103]
    v_mfma_f32_16x16x32_bf16 v[104:107], v[220:223], v[176:179], v[104:107]
    ds_read_b64_tr_b16 v[180:181], v3 offset:4096
    ds_read_b64_tr_b16 v[182:183], v3 offset:5120
    s_waitcnt lgkmcnt(15)
    v_mfma_f32_16x16x32_bf16 v[20:23], v[128:131], v[120:123], v[20:23]
    ds_read_b128 v[172:175], v2 offset:0
    v_mfma_f32_16x16x32_bf16 v[24:27], v[128:131], v[124:127], v[24:27]
    ds_read_b128 v[176:179], v2 offset:2048
    v_mfma_f32_16x16x32_bf16 v[108:111], v[128:131], v[16:19], v[108:111]
    ds_read_b64_tr_b16 v[184:185], v4 offset:4096
    ds_read_b64_tr_b16 v[186:187], v4 offset:5120
    v_mfma_f32_16x16x32_bf16 v[28:31], v[132:135], v[120:123], v[28:31]
    ds_read_b64_tr_b16 v[188:189], v5 offset:4096
    v_mfma_f32_16x16x32_bf16 v[32:35], v[132:135], v[124:127], v[32:35]
    ds_read_b64_tr_b16 v[190:191], v5 offset:5120
    v_mfma_f32_16x16x32_bf16 v[36:39], v[136:139], v[120:123], v[36:39]
    ds_read_b64_tr_b16 v[192:193], v6 offset:4096
    v_mfma_f32_16x16x32_bf16 v[40:43], v[136:139], v[124:127], v[40:43]
    ds_read_b64_tr_b16 v[194:195], v6 offset:5120
    ds_read_b64_tr_b16 v[196:197], v7 offset:4096
    v_mfma_f32_16x16x32_bf16 v[44:47], v[140:143], v[120:123], v[44:47]
    ds_read_b64_tr_b16 v[198:199], v7 offset:5120
    v_mfma_f32_16x16x32_bf16 v[48:51], v[140:143], v[124:127], v[48:51]
    ds_read_b64_tr_b16 v[200:201], v8 offset:4096
    s_waitcnt lgkmcnt(15)
    v_mfma_f32_16x16x32_bf16 v[52:55], v[144:147], v[120:123], v[52:55]
    ds_read_b64_tr_b16 v[202:203], v8 offset:5120
    ds_read_b64_tr_b16 v[204:205], v9 offset:4096
    v_mfma_f32_16x16x32_bf16 v[56:59], v[144:147], v[124:127], v[56:59]
    ds_read_b64_tr_b16 v[206:207], v9 offset:5120
    v_mfma_f32_16x16x32_bf16 v[112:115], v[144:147], v[16:19], v[112:115]
    ds_read_b64_tr_b16 v[208:209], v10 offset:4096
    v_mfma_f32_16x16x32_bf16 v[60:63], v[148:151], v[120:123], v[60:63]
    ds_read_b64_tr_b16 v[210:211], v10 offset:5120
    v_mfma_f32_16x16x32_bf16 v[64:67], v[148:151], v[124:127], v[64:67]
    ds_read_b64_tr_b16 v[212:213], v11 offset:4096
    ds_read_b64_tr_b16 v[214:215], v11 offset:5120
    v_mfma_f32_16x16x32_bf16 v[68:71], v[152:155], v[120:123], v[68:71]
    ds_read_b64_tr_b16 v[216:217], v12 offset:4096
    v_mfma_f32_16x16x32_bf16 v[72:75], v[152:155], v[124:127], v[72:75]
    ds_read_b64_tr_b16 v[218:219], v12 offset:5120
    v_mfma_f32_16x16x32_bf16 v[76:79], v[156:159], v[120:123], v[76:79]
    ds_read_b64_tr_b16 v[220:221], v13 offset:4096
    ds_read_b64_tr_b16 v[222:223], v13 offset:5120
    v_mfma_f32_16x16x32_bf16 v[80:83], v[156:159], v[124:127], v[80:83]
    v_mfma_f32_16x16x32_bf16 v[84:87], v[160:163], v[120:123], v[84:87]
    v_mfma_f32_16x16x32_bf16 v[88:91], v[160:163], v[124:127], v[88:91]
    v_mfma_f32_16x16x32_bf16 v[116:119], v[160:163], v[16:19], v[116:119]
    v_mfma_f32_16x16x32_bf16 v[92:95], v[164:167], v[120:123], v[92:95]
    v_mfma_f32_16x16x32_bf16 v[96:99], v[164:167], v[124:127], v[96:99]
    s_waitcnt lgkmcnt(15)
    v_mfma_f32_16x16x32_bf16 v[100:103], v[168:171], v[120:123], v[100:103]
    v_mfma_f32_16x16x32_bf16 v[104:107], v[168:171], v[124:127], v[104:107]
    v_mfma_f32_16x16x32_bf16 v[20:23], v[180:183], v[172:175], v[20:23]
    v_mfma_f32_16x16x32_bf16 v[24:27], v[180:183], v[176:179], v[24:27]
    v_mfma_f32_16x16x32_bf16 v[108:111], v[180:183], v[16:19], v[108:111]
    v_mfma_f32_16x16x32_bf16 v[28:31], v[184:187], v[172:175], v[28:31]
    v_mfma_f32_16x16x32_bf16 v[32:35], v[184:187], v[176:179], v[32:35]
    s_waitcnt lgkmcnt(0)
    s_barrier
    ds_read_b64_tr_b16 v[128:129], v3 offset:24576
    ds_read_b64_tr_b16 v[130:131], v3 offset:25600
    v_mfma_f32_16x16x32_bf16 v[36:39], v[188:191], v[172:175], v[36:39]
    ds_read_b128 v[120:123], v1 offset:18432
    v_mfma_f32_16x16x32_bf16 v[40:43], v[188:191], v[176:179], v[40:43]
    ds_read_b128 v[124:127], v1 offset:20480
    v_mfma_f32_16x16x32_bf16 v[44:47], v[192:195], v[172:175], v[44:47]
    ds_read_b64_tr_b16 v[132:133], v4 offset:24576
    ds_read_b64_tr_b16 v[134:135], v4 offset:25600
    v_mfma_f32_16x16x32_bf16 v[48:51], v[192:195], v[176:179], v[48:51]
    ds_read_b64_tr_b16 v[136:137], v5 offset:24576
    v_mfma_f32_16x16x32_bf16 v[52:55], v[196:199], v[172:175], v[52:55]
    ds_read_b64_tr_b16 v[138:139], v5 offset:25600
    v_mfma_f32_16x16x32_bf16 v[56:59], v[196:199], v[176:179], v[56:59]
    ds_read_b64_tr_b16 v[140:141], v6 offset:24576
    ds_read_b64_tr_b16 v[142:143], v6 offset:25600
    v_mfma_f32_16x16x32_bf16 v[112:115], v[196:199], v[16:19], v[112:115]
    ds_read_b64_tr_b16 v[144:145], v7 offset:24576
    v_mfma_f32_16x16x32_bf16 v[60:63], v[200:203], v[172:175], v[60:63]
    ds_read_b64_tr_b16 v[146:147], v7 offset:25600
    v_mfma_f32_16x16x32_bf16 v[64:67], v[200:203], v[176:179], v[64:67]
    ds_read_b64_tr_b16 v[148:149], v8 offset:24576
    ds_read_b64_tr_b16 v[150:151], v8 offset:25600
    v_mfma_f32_16x16x32_bf16 v[68:71], v[204:207], v[172:175], v[68:71]
    ds_read_b64_tr_b16 v[152:153], v9 offset:24576
    v_mfma_f32_16x16x32_bf16 v[72:75], v[204:207], v[176:179], v[72:75]
    ds_read_b64_tr_b16 v[154:155], v9 offset:25600
    v_mfma_f32_16x16x32_bf16 v[76:79], v[208:211], v[172:175], v[76:79]
    ds_read_b64_tr_b16 v[156:157], v10 offset:24576
    ds_read_b64_tr_b16 v[158:159], v10 offset:25600
    v_mfma_f32_16x16x32_bf16 v[80:83], v[208:211], v[176:179], v[80:83]
    ds_read_b64_tr_b16 v[160:161], v11 offset:24576
    v_mfma_f32_16x16x32_bf16 v[84:87], v[212:215], v[172:175], v[84:87]
    ds_read_b64_tr_b16 v[162:163], v11 offset:25600
    v_mfma_f32_16x16x32_bf16 v[88:91], v[212:215], v[176:179], v[88:91]
    ds_read_b64_tr_b16 v[164:165], v12 offset:24576
    ds_read_b64_tr_b16 v[166:167], v12 offset:25600
    v_mfma_f32_16x16x32_bf16 v[116:119], v[212:215], v[16:19], v[116:119]
    ds_read_b64_tr_b16 v[168:169], v13 offset:24576
    v_mfma_f32_16x16x32_bf16 v[92:95], v[216:219], v[172:175], v[92:95]
    ds_read_b64_tr_b16 v[170:171], v13 offset:25600
    v_mfma_f32_16x16x32_bf16 v[96:99], v[216:219], v[176:179], v[96:99]
    v_mfma_f32_16x16x32_bf16 v[100:103], v[220:223], v[172:175], v[100:103]
    v_mfma_f32_16x16x32_bf16 v[104:107], v[220:223], v[176:179], v[104:107]
    ds_read_b64_tr_b16 v[180:181], v3 offset:28672
    ds_read_b64_tr_b16 v[182:183], v3 offset:29696
    s_waitcnt lgkmcnt(15)
    v_mfma_f32_16x16x32_bf16 v[20:23], v[128:131], v[120:123], v[20:23]
    ds_read_b128 v[172:175], v2 offset:18432
    v_mfma_f32_16x16x32_bf16 v[24:27], v[128:131], v[124:127], v[24:27]
    ds_read_b128 v[176:179], v2 offset:20480
    v_mfma_f32_16x16x32_bf16 v[108:111], v[128:131], v[16:19], v[108:111]
    ds_read_b64_tr_b16 v[184:185], v4 offset:28672
    ds_read_b64_tr_b16 v[186:187], v4 offset:29696
    v_mfma_f32_16x16x32_bf16 v[28:31], v[132:135], v[120:123], v[28:31]
    ds_read_b64_tr_b16 v[188:189], v5 offset:28672
    v_mfma_f32_16x16x32_bf16 v[32:35], v[132:135], v[124:127], v[32:35]
    ds_read_b64_tr_b16 v[190:191], v5 offset:29696
    v_mfma_f32_16x16x32_bf16 v[36:39], v[136:139], v[120:123], v[36:39]
    ds_read_b64_tr_b16 v[192:193], v6 offset:28672
    v_mfma_f32_16x16x32_bf16 v[40:43], v[136:139], v[124:127], v[40:43]
    ds_read_b64_tr_b16 v[194:195], v6 offset:29696
    ds_read_b64_tr_b16 v[196:197], v7 offset:28672
    v_mfma_f32_16x16x32_bf16 v[44:47], v[140:143], v[120:123], v[44:47]
    ds_read_b64_tr_b16 v[198:199], v7 offset:29696
    v_mfma_f32_16x16x32_bf16 v[48:51], v[140:143], v[124:127], v[48:51]
    ds_read_b64_tr_b16 v[200:201], v8 offset:28672
    s_waitcnt lgkmcnt(15)
    v_mfma_f32_16x16x32_bf16 v[52:55], v[144:147], v[120:123], v[52:55]
    ds_read_b64_tr_b16 v[202:203], v8 offset:29696
    ds_read_b64_tr_b16 v[204:205], v9 offset:28672
    v_mfma_f32_16x16x32_bf16 v[56:59], v[144:147], v[124:127], v[56:59]
    ds_read_b64_tr_b16 v[206:207], v9 offset:29696
    v_mfma_f32_16x16x32_bf16 v[112:115], v[144:147], v[16:19], v[112:115]
    ds_read_b64_tr_b16 v[208:209], v10 offset:28672
    v_mfma_f32_16x16x32_bf16 v[60:63], v[148:151], v[120:123], v[60:63]
    ds_read_b64_tr_b16 v[210:211], v10 offset:29696
    v_mfma_f32_16x16x32_bf16 v[64:67], v[148:151], v[124:127], v[64:67]
    ds_read_b64_tr_b16 v[212:213], v11 offset:28672
    ds_read_b64_tr_b16 v[214:215], v11 offset:29696
    v_mfma_f32_16x16x32_bf16 v[68:71], v[152:155], v[120:123], v[68:71]
    ds_read_b64_tr_b16 v[216:217], v12 offset:28672
    v_mfma_f32_16x16x32_bf16 v[72:75], v[152:155], v[124:127], v[72:75]
    ds_read_b64_tr_b16 v[218:219], v12 offset:29696
    v_mfma_f32_16x16x32_bf16 v[76:79], v[156:159], v[120:123], v[76:79]
    ds_read_b64_tr_b16 v[220:221], v13 offset:28672
    ds_read_b64_tr_b16 v[222:223], v13 offset:29696
    v_mfma_f32_16x16x32_bf16 v[80:83], v[156:159], v[124:127], v[80:83]
    v_mfma_f32_16x16x32_bf16 v[84:87], v[160:163], v[120:123], v[84:87]
    v_mfma_f32_16x16x32_bf16 v[88:91], v[160:163], v[124:127], v[88:91]
    v_mfma_f32_16x16x32_bf16 v[116:119], v[160:163], v[16:19], v[116:119]
    v_mfma_f32_16x16x32_bf16 v[92:95], v[164:167], v[120:123], v[92:95]
    v_mfma_f32_16x16x32_bf16 v[96:99], v[164:167], v[124:127], v[96:99]
    s_waitcnt lgkmcnt(15)
    v_mfma_f32_16x16x32_bf16 v[100:103], v[168:171], v[120:123], v[100:103]
    v_mfma_f32_16x16x32_bf16 v[104:107], v[168:171], v[124:127], v[104:107]
    v_mfma_f32_16x16x32_bf16 v[20:23], v[180:183], v[172:175], v[20:23]
    v_mfma_f32_16x16x32_bf16 v[24:27], v[180:183], v[176:179], v[24:27]
    v_mfma_f32_16x16x32_bf16 v[108:111], v[180:183], v[16:19], v[108:111]
    v_mfma_f32_16x16x32_bf16 v[28:31], v[184:187], v[172:175], v[28:31]
    v_mfma_f32_16x16x32_bf16 v[32:35], v[184:187], v[176:179], v[32:35]
    s_waitcnt lgkmcnt(0)
    s_barrier
    ds_read_b64_tr_b16 v[128:129], v3 offset:49152
    ds_read_b64_tr_b16 v[130:131], v3 offset:50176
    v_mfma_f32_16x16x32_bf16 v[36:39], v[188:191], v[172:175], v[36:39]
    ds_read_b128 v[120:123], v1 offset:36864
    v_mfma_f32_16x16x32_bf16 v[40:43], v[188:191], v[176:179], v[40:43]
    ds_read_b128 v[124:127], v1 offset:38912
    v_mfma_f32_16x16x32_bf16 v[44:47], v[192:195], v[172:175], v[44:47]
    ds_read_b64_tr_b16 v[132:133], v4 offset:49152
    ds_read_b64_tr_b16 v[134:135], v4 offset:50176
    v_mfma_f32_16x16x32_bf16 v[48:51], v[192:195], v[176:179], v[48:51]
    ds_read_b64_tr_b16 v[136:137], v5 offset:49152
    v_mfma_f32_16x16x32_bf16 v[52:55], v[196:199], v[172:175], v[52:55]
    ds_read_b64_tr_b16 v[138:139], v5 offset:50176
    v_mfma_f32_16x16x32_bf16 v[56:59], v[196:199], v[176:179], v[56:59]
    ds_read_b64_tr_b16 v[140:141], v6 offset:49152
    ds_read_b64_tr_b16 v[142:143], v6 offset:50176
    v_mfma_f32_16x16x32_bf16 v[112:115], v[196:199], v[16:19], v[112:115]
    ds_read_b64_tr_b16 v[144:145], v7 offset:49152
    v_mfma_f32_16x16x32_bf16 v[60:63], v[200:203], v[172:175], v[60:63]
    ds_read_b64_tr_b16 v[146:147], v7 offset:50176
    v_mfma_f32_16x16x32_bf16 v[64:67], v[200:203], v[176:179], v[64:67]
    ds_read_b64_tr_b16 v[148:149], v8 offset:49152
    ds_read_b64_tr_b16 v[150:151], v8 offset:50176
    v_mfma_f32_16x16x32_bf16 v[68:71], v[204:207], v[172:175], v[68:71]
    ds_read_b64_tr_b16 v[152:153], v9 offset:49152
    v_mfma_f32_16x16x32_bf16 v[72:75], v[204:207], v[176:179], v[72:75]
    ds_read_b64_tr_b16 v[154:155], v9 offset:50176
    v_mfma_f32_16x16x32_bf16 v[76:79], v[208:211], v[172:175], v[76:79]
    ds_read_b64_tr_b16 v[156:157], v10 offset:49152
    ds_read_b64_tr_b16 v[158:159], v10 offset:50176
    v_mfma_f32_16x16x32_bf16 v[80:83], v[208:211], v[176:179], v[80:83]
    ds_read_b64_tr_b16 v[160:161], v11 offset:49152
    v_mfma_f32_16x16x32_bf16 v[84:87], v[212:215], v[172:175], v[84:87]
    ds_read_b64_tr_b16 v[162:163], v11 offset:50176
    v_mfma_f32_16x16x32_bf16 v[88:91], v[212:215], v[176:179], v[88:91]
    ds_read_b64_tr_b16 v[164:165], v12 offset:49152
    ds_read_b64_tr_b16 v[166:167], v12 offset:50176
    v_mfma_f32_16x16x32_bf16 v[116:119], v[212:215], v[16:19], v[116:119]
    ds_read_b64_tr_b16 v[168:169], v13 offset:49152
    v_mfma_f32_16x16x32_bf16 v[92:95], v[216:219], v[172:175], v[92:95]
    ds_read_b64_tr_b16 v[170:171], v13 offset:50176
    v_mfma_f32_16x16x32_bf16 v[96:99], v[216:219], v[176:179], v[96:99]
    v_mfma_f32_16x16x32_bf16 v[100:103], v[220:223], v[172:175], v[100:103]
    v_mfma_f32_16x16x32_bf16 v[104:107], v[220:223], v[176:179], v[104:107]
    ds_read_b64_tr_b16 v[180:181], v3 offset:53248
    ds_read_b64_tr_b16 v[182:183], v3 offset:54272
    s_waitcnt lgkmcnt(15)
    v_mfma_f32_16x16x32_bf16 v[20:23], v[128:131], v[120:123], v[20:23]
    ds_read_b128 v[172:175], v2 offset:36864
    v_mfma_f32_16x16x32_bf16 v[24:27], v[128:131], v[124:127], v[24:27]
    ds_read_b128 v[176:179], v2 offset:38912
    v_mfma_f32_16x16x32_bf16 v[108:111], v[128:131], v[16:19], v[108:111]
    ds_read_b64_tr_b16 v[184:185], v4 offset:53248
    ds_read_b64_tr_b16 v[186:187], v4 offset:54272
    v_mfma_f32_16x16x32_bf16 v[28:31], v[132:135], v[120:123], v[28:31]
    ds_read_b64_tr_b16 v[188:189], v5 offset:53248
    v_mfma_f32_16x16x32_bf16 v[32:35], v[132:135], v[124:127], v[32:35]
    ds_read_b64_tr_b16 v[190:191], v5 offset:54272
    v_mfma_f32_16x16x32_bf16 v[36:39], v[136:139], v[120:123], v[36:39]
    ds_read_b64_tr_b16 v[192:193], v6 offset:53248
    v_mfma_f32_16x16x32_bf16 v[40:43], v[136:139], v[124:127], v[40:43]
    ds_read_b64_tr_b16 v[194:195], v6 offset:54272
    ds_read_b64_tr_b16 v[196:197], v7 offset:53248
    v_mfma_f32_16x16x32_bf16 v[44:47], v[140:143], v[120:123], v[44:47]
    ds_read_b64_tr_b16 v[198:199], v7 offset:54272
    v_mfma_f32_16x16x32_bf16 v[48:51], v[140:143], v[124:127], v[48:51]
    ds_read_b64_tr_b16 v[200:201], v8 offset:53248
    s_waitcnt lgkmcnt(15)
    v_mfma_f32_16x16x32_bf16 v[52:55], v[144:147], v[120:123], v[52:55]
    ds_read_b64_tr_b16 v[202:203], v8 offset:54272
    ds_read_b64_tr_b16 v[204:205], v9 offset:53248
    v_mfma_f32_16x16x32_bf16 v[56:59], v[144:147], v[124:127], v[56:59]
    ds_read_b64_tr_b16 v[206:207], v9 offset:54272
    v_mfma_f32_16x16x32_bf16 v[112:115], v[144:147], v[16:19], v[112:115]
    ds_read_b64_tr_b16 v[208:209], v10 offset:53248
    v_mfma_f32_16x16x32_bf16 v[60:63], v[148:151], v[120:123], v[60:63]
    ds_read_b64_tr_b16 v[210:211], v10 offset:54272
    v_mfma_f32_16x16x32_bf16 v[64:67], v[148:151], v[124:127], v[64:67]
    ds_read_b64_tr_b16 v[212:213], v11 offset:53248
    ds_read_b64_tr_b16 v[214:215], v11 offset:54272
    v_mfma_f32_16x16x32_bf16 v[68:71], v[152:155], v[120:123], v[68:71]
    ds_read_b64_tr_b16 v[216:217], v12 offset:53248
    v_mfma_f32_16x16x32_bf16 v[72:75], v[152:155], v[124:127], v[72:75]
    ds_read_b64_tr_b16 v[218:219], v12 offset:54272
    v_mfma_f32_16x16x32_bf16 v[76:79], v[156:159], v[120:123], v[76:79]
    ds_read_b64_tr_b16 v[220:221], v13 offset:53248
    ds_read_b64_tr_b16 v[222:223], v13 offset:54272
    v_mfma_f32_16x16x32_bf16 v[80:83], v[156:159], v[124:127], v[80:83]
    v_mfma_f32_16x16x32_bf16 v[84:87], v[160:163], v[120:123], v[84:87]
    v_mfma_f32_16x16x32_bf16 v[88:91], v[160:163], v[124:127], v[88:91]
    v_mfma_f32_16x16x32_bf16 v[116:119], v[160:163], v[16:19], v[116:119]
    v_mfma_f32_16x16x32_bf16 v[92:95], v[164:167], v[120:123], v[92:95]
    v_mfma_f32_16x16x32_bf16 v[96:99], v[164:167], v[124:127], v[96:99]
    s_waitcnt lgkmcnt(15)
    v_mfma_f32_16x16x32_bf16 v[100:103], v[168:171], v[120:123], v[100:103]
    v_mfma_f32_16x16x32_bf16 v[104:107], v[168:171], v[124:127], v[104:107]
    v_mfma_f32_16x16x32_bf16 v[20:23], v[180:183], v[172:175], v[20:23]
    v_mfma_f32_16x16x32_bf16 v[24:27], v[180:183], v[176:179], v[24:27]
    v_mfma_f32_16x16x32_bf16 v[108:111], v[180:183], v[16:19], v[108:111]
    v_mfma_f32_16x16x32_bf16 v[28:31], v[184:187], v[172:175], v[28:31]
    v_mfma_f32_16x16x32_bf16 v[32:35], v[184:187], v[176:179], v[32:35]
    s_waitcnt lgkmcnt(0)
    s_barrier
    ds_read_b64_tr_b16 v[128:129], v3 offset:0
    ds_read_b64_tr_b16 v[130:131], v3 offset:1024
    v_mfma_f32_16x16x32_bf16 v[36:39], v[188:191], v[172:175], v[36:39]
    ds_read_b128 v[120:123], v1 offset:0
    v_mfma_f32_16x16x32_bf16 v[40:43], v[188:191], v[176:179], v[40:43]
    ds_read_b128 v[124:127], v1 offset:2048
    v_mfma_f32_16x16x32_bf16 v[44:47], v[192:195], v[172:175], v[44:47]
    ds_read_b64_tr_b16 v[132:133], v4 offset:0
    ds_read_b64_tr_b16 v[134:135], v4 offset:1024
    v_mfma_f32_16x16x32_bf16 v[48:51], v[192:195], v[176:179], v[48:51]
    ds_read_b64_tr_b16 v[136:137], v5 offset:0
    v_mfma_f32_16x16x32_bf16 v[52:55], v[196:199], v[172:175], v[52:55]
    ds_read_b64_tr_b16 v[138:139], v5 offset:1024
    v_mfma_f32_16x16x32_bf16 v[56:59], v[196:199], v[176:179], v[56:59]
    ds_read_b64_tr_b16 v[140:141], v6 offset:0
    ds_read_b64_tr_b16 v[142:143], v6 offset:1024
    v_mfma_f32_16x16x32_bf16 v[112:115], v[196:199], v[16:19], v[112:115]
    ds_read_b64_tr_b16 v[144:145], v7 offset:0
    v_mfma_f32_16x16x32_bf16 v[60:63], v[200:203], v[172:175], v[60:63]
    ds_read_b64_tr_b16 v[146:147], v7 offset:1024
    v_mfma_f32_16x16x32_bf16 v[64:67], v[200:203], v[176:179], v[64:67]
    ds_read_b64_tr_b16 v[148:149], v8 offset:0
    ds_read_b64_tr_b16 v[150:151], v8 offset:1024
    v_mfma_f32_16x16x32_bf16 v[68:71], v[204:207], v[172:175], v[68:71]
    ds_read_b64_tr_b16 v[152:153], v9 offset:0
    v_mfma_f32_16x16x32_bf16 v[72:75], v[204:207], v[176:179], v[72:75]
    ds_read_b64_tr_b16 v[154:155], v9 offset:1024
    v_mfma_f32_16x16x32_bf16 v[76:79], v[208:211], v[172:175], v[76:79]
    ds_read_b64_tr_b16 v[156:157], v10 offset:0
    ds_read_b64_tr_b16 v[158:159], v10 offset:1024
    v_mfma_f32_16x16x32_bf16 v[80:83], v[208:211], v[176:179], v[80:83]
    ds_read_b64_tr_b16 v[160:161], v11 offset:0
    v_mfma_f32_16x16x32_bf16 v[84:87], v[212:215], v[172:175], v[84:87]
    ds_read_b64_tr_b16 v[162:163], v11 offset:1024
    v_mfma_f32_16x16x32_bf16 v[88:91], v[212:215], v[176:179], v[88:91]
    ds_read_b64_tr_b16 v[164:165], v12 offset:0
    ds_read_b64_tr_b16 v[166:167], v12 offset:1024
    v_mfma_f32_16x16x32_bf16 v[116:119], v[212:215], v[16:19], v[116:119]
    ds_read_b64_tr_b16 v[168:169], v13 offset:0
    v_mfma_f32_16x16x32_bf16 v[92:95], v[216:219], v[172:175], v[92:95]
    ds_read_b64_tr_b16 v[170:171], v13 offset:1024
    v_mfma_f32_16x16x32_bf16 v[96:99], v[216:219], v[176:179], v[96:99]
    v_mfma_f32_16x16x32_bf16 v[100:103], v[220:223], v[172:175], v[100:103]
    v_mfma_f32_16x16x32_bf16 v[104:107], v[220:223], v[176:179], v[104:107]
    s_waitcnt vmcnt(0)
    ds_read_b64_tr_b16 v[180:181], v3 offset:4096
    ds_read_b64_tr_b16 v[182:183], v3 offset:5120
    s_waitcnt lgkmcnt(15)
    v_mfma_f32_16x16x32_bf16 v[20:23], v[128:131], v[120:123], v[20:23]
    ds_read_b128 v[172:175], v2 offset:0
    ds_read_b128 v[176:179], v2 offset:2048
    v_mfma_f32_16x16x32_bf16 v[24:27], v[128:131], v[124:127], v[24:27]
    ds_read_b64_tr_b16 v[184:185], v4 offset:4096
    ds_read_b64_tr_b16 v[186:187], v4 offset:5120
    v_mfma_f32_16x16x32_bf16 v[108:111], v[128:131], v[16:19], v[108:111]
    ds_read_b64_tr_b16 v[188:189], v5 offset:4096
    ds_read_b64_tr_b16 v[190:191], v5 offset:5120
    v_mfma_f32_16x16x32_bf16 v[28:31], v[132:135], v[120:123], v[28:31]
    ds_read_b64_tr_b16 v[192:193], v6 offset:4096
    ds_read_b64_tr_b16 v[194:195], v6 offset:5120
    v_mfma_f32_16x16x32_bf16 v[32:35], v[132:135], v[124:127], v[32:35]
    ds_read_b64_tr_b16 v[196:197], v7 offset:4096
    ds_read_b64_tr_b16 v[198:199], v7 offset:5120
    v_mfma_f32_16x16x32_bf16 v[36:39], v[136:139], v[120:123], v[36:39]
    ds_read_b64_tr_b16 v[200:201], v8 offset:4096
    ds_read_b64_tr_b16 v[202:203], v8 offset:5120
    v_mfma_f32_16x16x32_bf16 v[40:43], v[136:139], v[124:127], v[40:43]
    ds_read_b64_tr_b16 v[204:205], v9 offset:4096
    v_mfma_f32_16x16x32_bf16 v[44:47], v[140:143], v[120:123], v[44:47]
    ds_read_b64_tr_b16 v[206:207], v9 offset:5120
    ds_read_b64_tr_b16 v[208:209], v10 offset:4096
    v_mfma_f32_16x16x32_bf16 v[48:51], v[140:143], v[124:127], v[48:51]
    ds_read_b64_tr_b16 v[210:211], v10 offset:5120
    ds_read_b64_tr_b16 v[212:213], v11 offset:4096
    s_waitcnt lgkmcnt(15)
    v_mfma_f32_16x16x32_bf16 v[52:55], v[144:147], v[120:123], v[52:55]
    ds_read_b64_tr_b16 v[214:215], v11 offset:5120
    ds_read_b64_tr_b16 v[216:217], v12 offset:4096
    v_mfma_f32_16x16x32_bf16 v[56:59], v[144:147], v[124:127], v[56:59]
    ds_read_b64_tr_b16 v[218:219], v12 offset:5120
    ds_read_b64_tr_b16 v[220:221], v13 offset:4096
    v_mfma_f32_16x16x32_bf16 v[112:115], v[144:147], v[16:19], v[112:115]
    ds_read_b64_tr_b16 v[222:223], v13 offset:5120
    s_and_b32 s7, s52, 15
    s_lshl_b32 s7, s7, 5
    v_add_u32 v224, s7, v15
    ds_read_b64 v[224:225], v224 offset:0
    v_mfma_f32_16x16x32_bf16 v[60:63], v[148:151], v[120:123], v[60:63]
    s_and_b32 s7, s53, 15
    s_lshl_b32 s7, s7, 5
    v_add_u32 v226, s7, v15
    ds_read_b64 v[226:227], v226 offset:0
    s_and_b32 s7, s54, 15
    s_lshl_b32 s7, s7, 5
    v_add_u32 v228, s7, v15
    ds_read_b64 v[228:229], v228 offset:0
    v_mfma_f32_16x16x32_bf16 v[64:67], v[148:151], v[124:127], v[64:67]
    s_and_b32 s7, s55, 15
    s_lshl_b32 s7, s7, 5
    v_add_u32 v230, s7, v15
    ds_read_b64 v[230:231], v230 offset:0
    v_mfma_f32_16x16x32_bf16 v[68:71], v[152:155], v[120:123], v[68:71]
    s_and_b32 s7, s56, 15
    s_lshl_b32 s7, s7, 5
    v_add_u32 v232, s7, v15
    ds_read_b64 v[232:233], v232 offset:0
    s_and_b32 s7, s57, 15
    s_lshl_b32 s7, s7, 5
    v_add_u32 v234, s7, v15
    ds_read_b64 v[234:235], v234 offset:0
    v_mfma_f32_16x16x32_bf16 v[72:75], v[152:155], v[124:127], v[72:75]
    s_and_b32 s7, s58, 15
    s_lshl_b32 s7, s7, 5
    v_add_u32 v236, s7, v15
    ds_read_b64 v[236:237], v236 offset:0
    s_and_b32 s7, s59, 15
    s_lshl_b32 s7, s7, 5
    v_add_u32 v238, s7, v15
    ds_read_b64 v[238:239], v238 offset:0
    v_mfma_f32_16x16x32_bf16 v[76:79], v[156:159], v[120:123], v[76:79]
    s_and_b32 s7, s60, 15
    s_lshl_b32 s7, s7, 5
    v_add_u32 v240, s7, v15
    ds_read_b64 v[240:241], v240 offset:0
    s_and_b32 s7, s61, 15
    s_lshl_b32 s7, s7, 5
    v_add_u32 v242, s7, v15
    ds_read_b64 v[242:243], v242 offset:0
    v_mfma_f32_16x16x32_bf16 v[80:83], v[156:159], v[124:127], v[80:83]
    s_and_b32 s7, s62, 15
    s_lshl_b32 s7, s7, 5
    v_add_u32 v244, s7, v15
    ds_read_b64 v[244:245], v244 offset:0
    v_mfma_f32_16x16x32_bf16 v[84:87], v[160:163], v[120:123], v[84:87]
    v_mfma_f32_16x16x32_bf16 v[88:91], v[160:163], v[124:127], v[88:91]
    v_mfma_f32_16x16x32_bf16 v[116:119], v[160:163], v[16:19], v[116:119]
    v_mfma_f32_16x16x32_bf16 v[92:95], v[164:167], v[120:123], v[92:95]
    v_mfma_f32_16x16x32_bf16 v[96:99], v[164:167], v[124:127], v[96:99]
    v_mfma_f32_16x16x32_bf16 v[100:103], v[168:171], v[120:123], v[100:103]
    v_mfma_f32_16x16x32_bf16 v[104:107], v[168:171], v[124:127], v[104:107]
    v_mfma_f32_16x16x32_bf16 v[20:23], v[180:183], v[172:175], v[20:23]
    v_mfma_f32_16x16x32_bf16 v[24:27], v[180:183], v[176:179], v[24:27]
    v_mfma_f32_16x16x32_bf16 v[108:111], v[180:183], v[16:19], v[108:111]
    s_waitcnt lgkmcnt(15)
    v_mfma_f32_16x16x32_bf16 v[28:31], v[184:187], v[172:175], v[28:31]
    v_mfma_f32_16x16x32_bf16 v[32:35], v[184:187], v[176:179], v[32:35]
    s_waitcnt lgkmcnt(0)
    s_barrier
    ds_read_b64_tr_b16 v[128:129], v3 offset:24576
    ds_read_b64_tr_b16 v[130:131], v3 offset:25600
    v_mfma_f32_16x16x32_bf16 v[36:39], v[188:191], v[172:175], v[36:39]
    ds_read_b128 v[120:123], v1 offset:18432
    v_mfma_f32_16x16x32_bf16 v[40:43], v[188:191], v[176:179], v[40:43]
    ds_read_b128 v[124:127], v1 offset:20480
    v_mfma_f32_16x16x32_bf16 v[44:47], v[192:195], v[172:175], v[44:47]
    ds_read_b64_tr_b16 v[132:133], v4 offset:24576
    ds_read_b64_tr_b16 v[134:135], v4 offset:25600
    v_mfma_f32_16x16x32_bf16 v[48:51], v[192:195], v[176:179], v[48:51]
    ds_read_b64_tr_b16 v[136:137], v5 offset:24576
    v_mfma_f32_16x16x32_bf16 v[52:55], v[196:199], v[172:175], v[52:55]
    ds_read_b64_tr_b16 v[138:139], v5 offset:25600
    v_mfma_f32_16x16x32_bf16 v[56:59], v[196:199], v[176:179], v[56:59]
    ds_read_b64_tr_b16 v[140:141], v6 offset:24576
    ds_read_b64_tr_b16 v[142:143], v6 offset:25600
    v_mfma_f32_16x16x32_bf16 v[112:115], v[196:199], v[16:19], v[112:115]
    ds_read_b64_tr_b16 v[144:145], v7 offset:24576
    v_mfma_f32_16x16x32_bf16 v[60:63], v[200:203], v[172:175], v[60:63]
    ds_read_b64_tr_b16 v[146:147], v7 offset:25600
    v_mfma_f32_16x16x32_bf16 v[64:67], v[200:203], v[176:179], v[64:67]
    ds_read_b64_tr_b16 v[148:149], v8 offset:24576
    ds_read_b64_tr_b16 v[150:151], v8 offset:25600
    v_mfma_f32_16x16x32_bf16 v[68:71], v[204:207], v[172:175], v[68:71]
    ds_read_b64_tr_b16 v[152:153], v9 offset:24576
    v_mfma_f32_16x16x32_bf16 v[72:75], v[204:207], v[176:179], v[72:75]
    ds_read_b64_tr_b16 v[154:155], v9 offset:25600
    v_mfma_f32_16x16x32_bf16 v[76:79], v[208:211], v[172:175], v[76:79]
    ds_read_b64_tr_b16 v[156:157], v10 offset:24576
    ds_read_b64_tr_b16 v[158:159], v10 offset:25600
    v_mfma_f32_16x16x32_bf16 v[80:83], v[208:211], v[176:179], v[80:83]
    ds_read_b64_tr_b16 v[160:161], v11 offset:24576
    v_mfma_f32_16x16x32_bf16 v[84:87], v[212:215], v[172:175], v[84:87]
    ds_read_b64_tr_b16 v[162:163], v11 offset:25600
    v_mfma_f32_16x16x32_bf16 v[88:91], v[212:215], v[176:179], v[88:91]
    ds_read_b64_tr_b16 v[164:165], v12 offset:24576
    ds_read_b64_tr_b16 v[166:167], v12 offset:25600
    v_mfma_f32_16x16x32_bf16 v[116:119], v[212:215], v[16:19], v[116:119]
    ds_read_b64_tr_b16 v[168:169], v13 offset:24576
    v_mfma_f32_16x16x32_bf16 v[92:95], v[216:219], v[172:175], v[92:95]
    ds_read_b64_tr_b16 v[170:171], v13 offset:25600
    v_mfma_f32_16x16x32_bf16 v[96:99], v[216:219], v[176:179], v[96:99]
    v_mfma_f32_16x16x32_bf16 v[100:103], v[220:223], v[172:175], v[100:103]
    v_mfma_f32_16x16x32_bf16 v[104:107], v[220:223], v[176:179], v[104:107]
    ds_read_b64_tr_b16 v[180:181], v3 offset:28672
    ds_read_b64_tr_b16 v[182:183], v3 offset:29696
    s_waitcnt lgkmcnt(15)
    v_mfma_f32_16x16x32_bf16 v[20:23], v[128:131], v[120:123], v[20:23]
    ds_read_b128 v[172:175], v2 offset:18432
    v_mfma_f32_16x16x32_bf16 v[24:27], v[128:131], v[124:127], v[24:27]
    ds_read_b128 v[176:179], v2 offset:20480
    v_mfma_f32_16x16x32_bf16 v[108:111], v[128:131], v[16:19], v[108:111]
    ds_read_b64_tr_b16 v[196:197], v7 offset:28672
    ds_read_b64_tr_b16 v[198:199], v7 offset:29696
    v_mfma_f32_16x16x32_bf16 v[28:31], v[132:135], v[120:123], v[28:31]
    ds_read_b64_tr_b16 v[212:213], v11 offset:28672
    v_mfma_f32_16x16x32_bf16 v[32:35], v[132:135], v[124:127], v[32:35]
    ds_read_b64_tr_b16 v[214:215], v11 offset:29696
    v_mfma_f32_16x16x32_bf16 v[36:39], v[136:139], v[120:123], v[36:39]
    ds_read_b64_tr_b16 v[184:185], v4 offset:28672
    v_mfma_f32_16x16x32_bf16 v[40:43], v[136:139], v[124:127], v[40:43]
    ds_read_b64_tr_b16 v[186:187], v4 offset:29696
    ds_read_b64_tr_b16 v[188:189], v5 offset:28672
    v_mfma_f32_16x16x32_bf16 v[44:47], v[140:143], v[120:123], v[44:47]
    ds_read_b64_tr_b16 v[190:191], v5 offset:29696
    v_mfma_f32_16x16x32_bf16 v[48:51], v[140:143], v[124:127], v[48:51]
    ds_read_b64_tr_b16 v[192:193], v6 offset:28672
    s_waitcnt lgkmcnt(15)
    v_mfma_f32_16x16x32_bf16 v[52:55], v[144:147], v[120:123], v[52:55]
    ds_read_b64_tr_b16 v[194:195], v6 offset:29696
    ds_read_b64_tr_b16 v[200:201], v8 offset:28672
    v_mfma_f32_16x16x32_bf16 v[56:59], v[144:147], v[124:127], v[56:59]
    ds_read_b64_tr_b16 v[202:203], v8 offset:29696
    v_mfma_f32_16x16x32_bf16 v[112:115], v[144:147], v[16:19], v[112:115]
    ds_read_b64_tr_b16 v[204:205], v9 offset:28672
    v_mfma_f32_16x16x32_bf16 v[60:63], v[148:151], v[120:123], v[60:63]
    ds_read_b64_tr_b16 v[206:207], v9 offset:29696
    v_mfma_f32_16x16x32_bf16 v[64:67], v[148:151], v[124:127], v[64:67]
    ds_read_b64_tr_b16 v[208:209], v10 offset:28672
    ds_read_b64_tr_b16 v[210:211], v10 offset:29696
    v_mfma_f32_16x16x32_bf16 v[68:71], v[152:155], v[120:123], v[68:71]
    ds_read_b64_tr_b16 v[216:217], v12 offset:28672
    v_mfma_f32_16x16x32_bf16 v[72:75], v[152:155], v[124:127], v[72:75]
    ds_read_b64_tr_b16 v[218:219], v12 offset:29696
    v_mfma_f32_16x16x32_bf16 v[76:79], v[156:159], v[120:123], v[76:79]
    ds_read_b64_tr_b16 v[220:221], v13 offset:28672
    ds_read_b64_tr_b16 v[222:223], v13 offset:29696
    v_mfma_f32_16x16x32_bf16 v[80:83], v[156:159], v[124:127], v[80:83]
    v_mfma_f32_16x16x32_bf16 v[84:87], v[160:163], v[120:123], v[84:87]
    v_mfma_f32_16x16x32_bf16 v[88:91], v[160:163], v[124:127], v[88:91]
    v_mfma_f32_16x16x32_bf16 v[116:119], v[160:163], v[16:19], v[116:119]
    v_mfma_f32_16x16x32_bf16 v[92:95], v[164:167], v[120:123], v[92:95]
    v_mfma_f32_16x16x32_bf16 v[96:99], v[164:167], v[124:127], v[96:99]
    s_waitcnt lgkmcnt(15)
    v_mfma_f32_16x16x32_bf16 v[100:103], v[168:171], v[120:123], v[100:103]
    v_mfma_f32_16x16x32_bf16 v[104:107], v[168:171], v[124:127], v[104:107]
    s_and_b32 s7, s52, 15
    s_lshl_b32 s7, s7, 6
    s_add_u32 s7, s7, 162944
    v_lshl_add_u32 v164, v15, 1, s7
    v_mfma_f32_16x16x32_bf16 v[108:111], v[180:183], v[16:19], v[108:111]
    s_and_b32 s7, s56, 15
    s_lshl_b32 s7, s7, 6
    s_add_u32 s7, s7, 162944
    v_lshl_add_u32 v165, v15, 1, s7
    v_mfma_f32_16x16x32_bf16 v[112:115], v[196:199], v[16:19], v[112:115]
    s_and_b32 s7, s60, 15
    s_lshl_b32 s7, s7, 6
    s_add_u32 s7, s7, 162944
    v_lshl_add_u32 v166, v15, 1, s7
    v_mfma_f32_16x16x32_bf16 v[116:119], v[212:215], v[16:19], v[116:119]
    v_mfma_f32_16x16x32_bf16 v[20:23], v[180:183], v[172:175], v[20:23]
    v_mfma_f32_16x16x32_bf16 v[24:27], v[180:183], v[176:179], v[24:27]
    v_mfma_f32_16x16x32_bf16 v[52:55], v[196:199], v[172:175], v[52:55]
    s_mov_b32 exec_lo, 0x00010001
    s_mov_b32 exec_hi, 0x00010001
    ds_write_b128 v164, v[108:111]
    ds_write_b128 v165, v[112:115]
    s_nop 0
    ds_write_b128 v166, v[116:119]
    s_mov_b64 exec, -1
    v_mfma_f32_16x16x32_bf16 v[56:59], v[196:199], v[176:179], v[56:59]
    v_mfma_f32_16x16x32_bf16 v[84:87], v[212:215], v[172:175], v[84:87]
    v_mfma_f32_16x16x32_bf16 v[88:91], v[212:215], v[176:179], v[88:91]
    s_waitcnt lgkmcnt(15)
    v_mfma_f32_16x16x32_bf16 v[28:31], v[184:187], v[172:175], v[28:31]
    s_waitcnt lgkmcnt(0)
    s_barrier
    ds_read_b32 v252, v255
    ds_read_b32 v253, v255 offset:128
    v_mfma_f32_16x16x32_bf16 v[32:35], v[184:187], v[176:179], v[32:35]
    ds_read_b32 v254, v255 offset:64
    v_mfma_f32_16x16x32_bf16 v[36:39], v[188:191], v[172:175], v[36:39]
    ds_read_b32 v255, v255 offset:192
    v_mfma_f32_16x16x32_bf16 v[40:43], v[188:191], v[176:179], v[40:43]
    s_and_b32 s7, s52, 15
    s_lshl_b32 s7, s7, 6
    s_add_u32 s7, s7, 162944
    v_lshl_add_u32 v120, v15, 1, s7
    ds_read_b128 v[120:123], v120
    s_and_b32 s52, s52, -16
    v_mfma_f32_16x16x32_bf16 v[44:47], v[192:195], v[172:175], v[44:47]
    s_and_b32 s7, s53, 15
    s_lshl_b32 s7, s7, 6
    s_add_u32 s7, s7, 162944
    v_lshl_add_u32 v124, v15, 1, s7
    ds_read_b128 v[124:127], v124
    s_and_b32 s53, s53, -16
    s_and_b32 s7, s54, 15
    s_lshl_b32 s7, s7, 6
    s_add_u32 s7, s7, 162944
    v_lshl_add_u32 v128, v15, 1, s7
    ds_read_b128 v[128:131], v128
    s_and_b32 s54, s54, -16
    v_mfma_f32_16x16x32_bf16 v[48:51], v[192:195], v[176:179], v[48:51]
    s_and_b32 s7, s55, 15
    s_lshl_b32 s7, s7, 6
    s_add_u32 s7, s7, 162944
    v_lshl_add_u32 v132, v15, 1, s7
    ds_read_b128 v[132:135], v132
    s_and_b32 s55, s55, -16
    v_mfma_f32_16x16x32_bf16 v[60:63], v[200:203], v[172:175], v[60:63]
    s_and_b32 s7, s56, 15
    s_lshl_b32 s7, s7, 6
    s_add_u32 s7, s7, 162944
    v_lshl_add_u32 v136, v15, 1, s7
    ds_read_b128 v[136:139], v136
    s_and_b32 s56, s56, -16
    v_mfma_f32_16x16x32_bf16 v[64:67], v[200:203], v[176:179], v[64:67]
    s_and_b32 s7, s57, 15
    s_lshl_b32 s7, s7, 6
    s_add_u32 s7, s7, 162944
    v_lshl_add_u32 v140, v15, 1, s7
    ds_read_b128 v[140:143], v140
    s_and_b32 s57, s57, -16
    v_mfma_f32_16x16x32_bf16 v[68:71], v[204:207], v[172:175], v[68:71]
    s_and_b32 s7, s58, 15
    s_lshl_b32 s7, s7, 6
    s_add_u32 s7, s7, 162944
    v_lshl_add_u32 v144, v15, 1, s7
    ds_read_b128 v[144:147], v144
    s_and_b32 s58, s58, -16
    s_and_b32 s7, s59, 15
    s_lshl_b32 s7, s7, 6
    s_add_u32 s7, s7, 162944
    v_lshl_add_u32 v148, v15, 1, s7
    ds_read_b128 v[148:151], v148
    s_and_b32 s59, s59, -16
    v_mfma_f32_16x16x32_bf16 v[72:75], v[204:207], v[176:179], v[72:75]
    s_and_b32 s7, s60, 15
    s_lshl_b32 s7, s7, 6
    s_add_u32 s7, s7, 162944
    v_lshl_add_u32 v152, v15, 1, s7
    ds_read_b128 v[152:155], v152
    s_and_b32 s60, s60, -16
    v_mfma_f32_16x16x32_bf16 v[76:79], v[208:211], v[172:175], v[76:79]
    s_and_b32 s7, s61, 15
    s_lshl_b32 s7, s7, 6
    s_add_u32 s7, s7, 162944
    v_lshl_add_u32 v156, v15, 1, s7
    ds_read_b128 v[156:159], v156
    s_and_b32 s61, s61, -16
    v_mfma_f32_16x16x32_bf16 v[80:83], v[208:211], v[176:179], v[80:83]
    s_and_b32 s7, s62, 15
    s_lshl_b32 s7, s7, 6
    s_add_u32 s7, s7, 162944
    v_lshl_add_u32 v160, v15, 1, s7
    ds_read_b128 v[160:163], v160
    s_and_b32 s62, s62, -16
    v_mfma_f32_16x16x32_bf16 v[92:95], v[216:219], v[172:175], v[92:95]
    v_mfma_f32_16x16x32_bf16 v[96:99], v[216:219], v[176:179], v[96:99]
    v_mfma_f32_16x16x32_bf16 v[100:103], v[220:223], v[172:175], v[100:103]
    v_mfma_f32_16x16x32_bf16 v[104:107], v[220:223], v[176:179], v[104:107]
    v_lshlrev_b32 v172, 16, v224
    v_and_b32 v173, s77, v224
    v_lshlrev_b32 v174, 16, v225
    v_and_b32_e64 v175, s77, v225
    s_waitcnt lgkmcnt(10)
    v_pk_fma_f32 v[176:177], v[254:255], v[120:121], v[172:173] op_sel:[0,0,0] op_sel_hi:[0,1,1]
    v_pk_fma_f32 v[178:179], v[254:255], v[122:123], v[174:175] op_sel:[0,0,0] op_sel_hi:[0,1,1]
    v_pk_fma_f32 v[180:181], v[254:255], v[120:121], v[172:173] op_sel:[1,0,0] op_sel_hi:[1,1,1]
    v_pk_fma_f32 v[182:183], v[254:255], v[122:123], v[174:175] op_sel:[1,0,0] op_sel_hi:[1,1,1]
    v_pk_fma_f32 v[20:21], v[252:253], v[20:21], v[176:177] op_sel:[0,0,0] op_sel_hi:[0,1,1]
    v_pk_fma_f32 v[22:23], v[252:253], v[22:23], v[178:179] op_sel:[0,0,0] op_sel_hi:[0,1,1]
    v_pk_fma_f32 v[24:25], v[252:253], v[24:25], v[180:181] op_sel:[1,0,0] op_sel_hi:[1,1,1]
    v_pk_fma_f32 v[26:27], v[252:253], v[26:27], v[182:183] op_sel:[1,0,0] op_sel_hi:[1,1,1]
    v_pk_mul_f32 v[184:185], v[20:21], v[20:21]
    v_pk_mul_f32 v[186:187], v[22:23], v[22:23]
    v_pk_mul_f32 v[188:189], v[24:25], v[24:25]
    v_pk_mul_f32 v[190:191], v[26:27], v[26:27]
    v_pk_fma_f32 v[184:185], v[184:185], v[248:249], v[246:247]
    v_pk_fma_f32 v[186:187], v[186:187], v[248:249], v[246:247]
    v_pk_fma_f32 v[188:189], v[188:189], v[248:249], v[246:247]
    v_pk_fma_f32 v[190:191], v[190:191], v[248:249], v[246:247]
    v_pk_mul_f32 v[184:185], v[184:185], v[20:21]
    v_pk_mul_f32 v[186:187], v[186:187], v[22:23]
    v_pk_mul_f32 v[188:189], v[188:189], v[24:25]
    v_pk_mul_f32 v[190:191], v[190:191], v[26:27]
    v_exp_f32 v184, v184
    v_exp_f32 v185, v185
    v_exp_f32 v186, v186
    v_exp_f32 v187, v187
    v_exp_f32 v188, v188
    v_exp_f32 v189, v189
    v_exp_f32 v190, v190
    v_exp_f32 v191, v191
    v_pk_add_f32 v[184:185], v[184:185], v[250:251]
    v_pk_add_f32 v[186:187], v[186:187], v[250:251]
    v_pk_add_f32 v[188:189], v[188:189], v[250:251]
    v_pk_add_f32 v[190:191], v[190:191], v[250:251]
    v_rcp_f32 v184, v184
    v_rcp_f32 v185, v185
    v_rcp_f32 v186, v186
    v_rcp_f32 v187, v187
    v_rcp_f32 v188, v188
    v_rcp_f32 v189, v189
    v_rcp_f32 v190, v190
    v_rcp_f32 v191, v191
    v_pk_mul_f32 v[20:21], v[20:21], v[184:185]
    v_pk_mul_f32 v[22:23], v[22:23], v[186:187]
    v_pk_mul_f32 v[24:25], v[24:25], v[188:189]
    v_pk_mul_f32 v[26:27], v[26:27], v[190:191]
    v_cvt_pk_bf16_f32 v20, v20, v21
    v_cvt_pk_bf16_f32 v21, v22, v23
    v_cvt_pk_bf16_f32 v22, v24, v25
    v_cvt_pk_bf16_f32 v23, v26, v27
    s_nop 0
    v_permlane16_swap_b32 v20, v22
    v_permlane16_swap_b32 v21, v23
    buffer_store_dwordx4 v[20:23], v14, s[24:27], s52 offen sc1
    v_lshlrev_b32 v172, 16, v226
    v_and_b32 v173, s77, v226
    v_lshlrev_b32 v174, 16, v227
    v_and_b32 v175, s77, v227
    s_waitcnt lgkmcnt(9)
    v_pk_fma_f32 v[176:177], v[254:255], v[124:125], v[172:173] op_sel:[0,0,0] op_sel_hi:[0,1,1]
    v_pk_fma_f32 v[178:179], v[254:255], v[126:127], v[174:175] op_sel:[0,0,0] op_sel_hi:[0,1,1]
    v_pk_fma_f32 v[180:181], v[254:255], v[124:125], v[172:173] op_sel:[1,0,0] op_sel_hi:[1,1,1]
    v_pk_fma_f32 v[182:183], v[254:255], v[126:127], v[174:175] op_sel:[1,0,0] op_sel_hi:[1,1,1]
    v_pk_fma_f32 v[28:29], v[252:253], v[28:29], v[176:177] op_sel:[0,0,0] op_sel_hi:[0,1,1]
    v_pk_fma_f32 v[30:31], v[252:253], v[30:31], v[178:179] op_sel:[0,0,0] op_sel_hi:[0,1,1]
    v_pk_fma_f32 v[32:33], v[252:253], v[32:33], v[180:181] op_sel:[1,0,0] op_sel_hi:[1,1,1]
    v_pk_fma_f32 v[34:35], v[252:253], v[34:35], v[182:183] op_sel:[1,0,0] op_sel_hi:[1,1,1]
    v_pk_mul_f32 v[184:185], v[28:29], v[28:29]
    v_pk_mul_f32 v[186:187], v[30:31], v[30:31]
    v_pk_mul_f32 v[188:189], v[32:33], v[32:33]
    v_pk_mul_f32 v[190:191], v[34:35], v[34:35]
    v_pk_fma_f32 v[184:185], v[184:185], v[248:249], v[246:247]
    v_pk_fma_f32 v[186:187], v[186:187], v[248:249], v[246:247]
    v_pk_fma_f32 v[188:189], v[188:189], v[248:249], v[246:247]
    v_pk_fma_f32 v[190:191], v[190:191], v[248:249], v[246:247]
    v_pk_mul_f32 v[184:185], v[184:185], v[28:29]
    v_pk_mul_f32 v[186:187], v[186:187], v[30:31]
    v_pk_mul_f32 v[188:189], v[188:189], v[32:33]
    v_pk_mul_f32 v[190:191], v[190:191], v[34:35]
    v_exp_f32 v184, v184
    v_exp_f32 v185, v185
    v_exp_f32 v186, v186
    v_exp_f32 v187, v187
    v_exp_f32 v188, v188
    v_exp_f32 v189, v189
    v_exp_f32 v190, v190
    v_exp_f32 v191, v191
    v_pk_add_f32 v[184:185], v[184:185], v[250:251]
    v_pk_add_f32 v[186:187], v[186:187], v[250:251]
    v_pk_add_f32 v[188:189], v[188:189], v[250:251]
    v_pk_add_f32 v[190:191], v[190:191], v[250:251]
    v_rcp_f32 v184, v184
    v_rcp_f32 v185, v185
    v_rcp_f32 v186, v186
    v_rcp_f32 v187, v187
    v_rcp_f32 v188, v188
    v_rcp_f32 v189, v189
    v_rcp_f32 v190, v190
    v_rcp_f32 v191, v191
    v_pk_mul_f32 v[28:29], v[28:29], v[184:185]
    v_pk_mul_f32 v[30:31], v[30:31], v[186:187]
    v_pk_mul_f32 v[32:33], v[32:33], v[188:189]
    v_pk_mul_f32 v[34:35], v[34:35], v[190:191]
    v_cvt_pk_bf16_f32 v28, v28, v29
    v_cvt_pk_bf16_f32 v29, v30, v31
    v_cvt_pk_bf16_f32 v30, v32, v33
    v_cvt_pk_bf16_f32 v31, v34, v35
    s_nop 0
    v_permlane16_swap_b32 v28, v30
    v_permlane16_swap_b32 v29, v31
    buffer_store_dwordx4 v[28:31], v14, s[24:27], s53 offen sc1
    v_lshlrev_b32 v172, 16, v228
    v_and_b32 v173, s77, v228
    v_lshlrev_b32 v174, 16, v229
    v_and_b32 v175, s77, v229
    s_waitcnt lgkmcnt(8)
    v_pk_fma_f32 v[176:177], v[254:255], v[128:129], v[172:173] op_sel:[0,0,0] op_sel_hi:[0,1,1]
    v_pk_fma_f32 v[178:179], v[254:255], v[130:131], v[174:175] op_sel:[0,0,0] op_sel_hi:[0,1,1]
    v_pk_fma_f32 v[180:181], v[254:255], v[128:129], v[172:173] op_sel:[1,0,0] op_sel_hi:[1,1,1]
    v_pk_fma_f32 v[182:183], v[254:255], v[130:131], v[174:175] op_sel:[1,0,0] op_sel_hi:[1,1,1]
    v_pk_fma_f32 v[36:37], v[252:253], v[36:37], v[176:177] op_sel:[0,0,0] op_sel_hi:[0,1,1]
    v_pk_fma_f32 v[38:39], v[252:253], v[38:39], v[178:179] op_sel:[0,0,0] op_sel_hi:[0,1,1]
    v_pk_fma_f32 v[40:41], v[252:253], v[40:41], v[180:181] op_sel:[1,0,0] op_sel_hi:[1,1,1]
    v_pk_fma_f32 v[42:43], v[252:253], v[42:43], v[182:183] op_sel:[1,0,0] op_sel_hi:[1,1,1]
    v_pk_mul_f32 v[184:185], v[36:37], v[36:37]
    v_pk_mul_f32 v[186:187], v[38:39], v[38:39]
    v_pk_mul_f32 v[188:189], v[40:41], v[40:41]
    v_pk_mul_f32 v[190:191], v[42:43], v[42:43]
    v_pk_fma_f32 v[184:185], v[184:185], v[248:249], v[246:247]
    v_pk_fma_f32 v[186:187], v[186:187], v[248:249], v[246:247]
    v_pk_fma_f32 v[188:189], v[188:189], v[248:249], v[246:247]
    v_pk_fma_f32 v[190:191], v[190:191], v[248:249], v[246:247]
    v_pk_mul_f32 v[184:185], v[184:185], v[36:37]
    v_pk_mul_f32 v[186:187], v[186:187], v[38:39]
    v_pk_mul_f32 v[188:189], v[188:189], v[40:41]
    v_pk_mul_f32 v[190:191], v[190:191], v[42:43]
    v_exp_f32 v184, v184
    v_exp_f32 v185, v185
    v_exp_f32 v186, v186
    v_exp_f32 v187, v187
    v_exp_f32 v188, v188
    v_exp_f32 v189, v189
    v_exp_f32 v190, v190
    v_exp_f32 v191, v191
    v_pk_add_f32 v[184:185], v[184:185], v[250:251]
    v_pk_add_f32 v[186:187], v[186:187], v[250:251]
    v_pk_add_f32 v[188:189], v[188:189], v[250:251]
    v_pk_add_f32 v[190:191], v[190:191], v[250:251]
    v_rcp_f32 v184, v184
    v_rcp_f32 v185, v185
    v_rcp_f32 v186, v186
    v_rcp_f32 v187, v187
    v_rcp_f32 v188, v188
    v_rcp_f32 v189, v189
    v_rcp_f32 v190, v190
    v_rcp_f32 v191, v191
    v_pk_mul_f32 v[36:37], v[36:37], v[184:185]
    v_pk_mul_f32 v[38:39], v[38:39], v[186:187]
    v_pk_mul_f32 v[40:41], v[40:41], v[188:189]
    v_pk_mul_f32 v[42:43], v[42:43], v[190:191]
    v_cvt_pk_bf16_f32 v36, v36, v37
    v_cvt_pk_bf16_f32 v37, v38, v39
    v_cvt_pk_bf16_f32 v38, v40, v41
    v_cvt_pk_bf16_f32 v39, v42, v43
    s_nop 0
    v_permlane16_swap_b32 v36, v38
    v_permlane16_swap_b32 v37, v39
    buffer_store_dwordx4 v[36:39], v14, s[24:27], s54 offen sc1
    v_lshlrev_b32 v172, 16, v230
    v_and_b32 v173, s77, v230
    v_lshlrev_b32 v174, 16, v231
    v_and_b32 v175, s77, v231
    s_waitcnt lgkmcnt(7)
    v_pk_fma_f32 v[176:177], v[254:255], v[132:133], v[172:173] op_sel:[0,0,0] op_sel_hi:[0,1,1]
    v_pk_fma_f32 v[178:179], v[254:255], v[134:135], v[174:175] op_sel:[0,0,0] op_sel_hi:[0,1,1]
    v_pk_fma_f32 v[180:181], v[254:255], v[132:133], v[172:173] op_sel:[1,0,0] op_sel_hi:[1,1,1]
    v_pk_fma_f32 v[182:183], v[254:255], v[134:135], v[174:175] op_sel:[1,0,0] op_sel_hi:[1,1,1]
    v_pk_fma_f32 v[44:45], v[252:253], v[44:45], v[176:177] op_sel:[0,0,0] op_sel_hi:[0,1,1]
    v_pk_fma_f32 v[46:47], v[252:253], v[46:47], v[178:179] op_sel:[0,0,0] op_sel_hi:[0,1,1]
    v_pk_fma_f32 v[48:49], v[252:253], v[48:49], v[180:181] op_sel:[1,0,0] op_sel_hi:[1,1,1]
    v_pk_fma_f32 v[50:51], v[252:253], v[50:51], v[182:183] op_sel:[1,0,0] op_sel_hi:[1,1,1]
    v_pk_mul_f32 v[184:185], v[44:45], v[44:45]
    v_pk_mul_f32 v[186:187], v[46:47], v[46:47]
    v_pk_mul_f32 v[188:189], v[48:49], v[48:49]
    v_pk_mul_f32 v[190:191], v[50:51], v[50:51]
    v_pk_fma_f32 v[184:185], v[184:185], v[248:249], v[246:247]
    v_pk_fma_f32 v[186:187], v[186:187], v[248:249], v[246:247]
    v_pk_fma_f32 v[188:189], v[188:189], v[248:249], v[246:247]
    v_pk_fma_f32 v[190:191], v[190:191], v[248:249], v[246:247]
    v_pk_mul_f32 v[184:185], v[184:185], v[44:45]
    v_pk_mul_f32 v[186:187], v[186:187], v[46:47]
    v_pk_mul_f32 v[188:189], v[188:189], v[48:49]
    v_pk_mul_f32 v[190:191], v[190:191], v[50:51]
    v_exp_f32 v184, v184
    v_exp_f32 v185, v185
    v_exp_f32 v186, v186
    v_exp_f32 v187, v187
    v_exp_f32 v188, v188
    v_exp_f32 v189, v189
    v_exp_f32 v190, v190
    v_exp_f32 v191, v191
    v_pk_add_f32 v[184:185], v[184:185], v[250:251]
    v_pk_add_f32 v[186:187], v[186:187], v[250:251]
    v_pk_add_f32 v[188:189], v[188:189], v[250:251]
    v_pk_add_f32 v[190:191], v[190:191], v[250:251]
    v_rcp_f32 v184, v184
    v_rcp_f32 v185, v185
    v_rcp_f32 v186, v186
    v_rcp_f32 v187, v187
    v_rcp_f32 v188, v188
    v_rcp_f32 v189, v189
    v_rcp_f32 v190, v190
    v_rcp_f32 v191, v191
    v_pk_mul_f32 v[44:45], v[44:45], v[184:185]
    v_pk_mul_f32 v[46:47], v[46:47], v[186:187]
    v_pk_mul_f32 v[48:49], v[48:49], v[188:189]
    v_pk_mul_f32 v[50:51], v[50:51], v[190:191]
    v_cvt_pk_bf16_f32 v44, v44, v45
    v_cvt_pk_bf16_f32 v45, v46, v47
    v_cvt_pk_bf16_f32 v46, v48, v49
    v_cvt_pk_bf16_f32 v47, v50, v51
    s_nop 0
    v_permlane16_swap_b32 v44, v46
    v_permlane16_swap_b32 v45, v47
    buffer_store_dwordx4 v[44:47], v14, s[24:27], s55 offen sc1
    v_lshlrev_b32 v172, 16, v232
    v_and_b32 v173, s77, v232
    v_lshlrev_b32 v174, 16, v233
    v_and_b32 v175, s77, v233
    s_waitcnt lgkmcnt(6)
    v_pk_fma_f32 v[176:177], v[254:255], v[136:137], v[172:173] op_sel:[0,0,0] op_sel_hi:[0,1,1]
    v_pk_fma_f32 v[178:179], v[254:255], v[138:139], v[174:175] op_sel:[0,0,0] op_sel_hi:[0,1,1]
    v_pk_fma_f32 v[180:181], v[254:255], v[136:137], v[172:173] op_sel:[1,0,0] op_sel_hi:[1,1,1]
    v_pk_fma_f32 v[182:183], v[254:255], v[138:139], v[174:175] op_sel:[1,0,0] op_sel_hi:[1,1,1]
    v_pk_fma_f32 v[52:53], v[252:253], v[52:53], v[176:177] op_sel:[0,0,0] op_sel_hi:[0,1,1]
    v_pk_fma_f32 v[54:55], v[252:253], v[54:55], v[178:179] op_sel:[0,0,0] op_sel_hi:[0,1,1]
    v_pk_fma_f32 v[56:57], v[252:253], v[56:57], v[180:181] op_sel:[1,0,0] op_sel_hi:[1,1,1]
    v_pk_fma_f32 v[58:59], v[252:253], v[58:59], v[182:183] op_sel:[1,0,0] op_sel_hi:[1,1,1]
    v_pk_mul_f32 v[184:185], v[52:53], v[52:53]
    v_pk_mul_f32 v[186:187], v[54:55], v[54:55]
    v_pk_mul_f32 v[188:189], v[56:57], v[56:57]
    v_pk_mul_f32 v[190:191], v[58:59], v[58:59]
    v_pk_fma_f32 v[184:185], v[184:185], v[248:249], v[246:247]
    v_pk_fma_f32 v[186:187], v[186:187], v[248:249], v[246:247]
    v_pk_fma_f32 v[188:189], v[188:189], v[248:249], v[246:247]
    v_pk_fma_f32 v[190:191], v[190:191], v[248:249], v[246:247]
    v_pk_mul_f32 v[184:185], v[184:185], v[52:53]
    v_pk_mul_f32 v[186:187], v[186:187], v[54:55]
    v_pk_mul_f32 v[188:189], v[188:189], v[56:57]
    v_pk_mul_f32 v[190:191], v[190:191], v[58:59]
    v_exp_f32 v184, v184
    v_exp_f32 v185, v185
    v_exp_f32 v186, v186
    v_exp_f32 v187, v187
    v_exp_f32 v188, v188
    v_exp_f32 v189, v189
    v_exp_f32 v190, v190
    v_exp_f32 v191, v191
    v_pk_add_f32 v[184:185], v[184:185], v[250:251]
    v_pk_add_f32 v[186:187], v[186:187], v[250:251]
    v_pk_add_f32 v[188:189], v[188:189], v[250:251]
    v_pk_add_f32 v[190:191], v[190:191], v[250:251]
    v_rcp_f32 v184, v184
    v_rcp_f32 v185, v185
    v_rcp_f32 v186, v186
    v_rcp_f32 v187, v187
    v_rcp_f32 v188, v188
    v_rcp_f32 v189, v189
    v_rcp_f32 v190, v190
    v_rcp_f32 v191, v191
    v_pk_mul_f32 v[52:53], v[52:53], v[184:185]
    v_pk_mul_f32 v[54:55], v[54:55], v[186:187]
    v_pk_mul_f32 v[56:57], v[56:57], v[188:189]
    v_pk_mul_f32 v[58:59], v[58:59], v[190:191]
    v_cvt_pk_bf16_f32 v52, v52, v53
    v_cvt_pk_bf16_f32 v53, v54, v55
    v_cvt_pk_bf16_f32 v54, v56, v57
    v_cvt_pk_bf16_f32 v55, v58, v59
    s_nop 0
    v_permlane16_swap_b32 v52, v54
    v_permlane16_swap_b32 v53, v55
    buffer_store_dwordx4 v[52:55], v14, s[24:27], s56 offen sc1
    v_lshlrev_b32 v172, 16, v234
    v_and_b32 v173, s77, v234
    v_lshlrev_b32 v174, 16, v235
    v_and_b32 v175, s77, v235
    s_waitcnt lgkmcnt(5)
    v_pk_fma_f32 v[176:177], v[254:255], v[140:141], v[172:173] op_sel:[0,0,0] op_sel_hi:[0,1,1]
    v_pk_fma_f32 v[178:179], v[254:255], v[142:143], v[174:175] op_sel:[0,0,0] op_sel_hi:[0,1,1]
    v_pk_fma_f32 v[180:181], v[254:255], v[140:141], v[172:173] op_sel:[1,0,0] op_sel_hi:[1,1,1]
    v_pk_fma_f32 v[182:183], v[254:255], v[142:143], v[174:175] op_sel:[1,0,0] op_sel_hi:[1,1,1]
    v_pk_fma_f32 v[60:61], v[252:253], v[60:61], v[176:177] op_sel:[0,0,0] op_sel_hi:[0,1,1]
    v_pk_fma_f32 v[62:63], v[252:253], v[62:63], v[178:179] op_sel:[0,0,0] op_sel_hi:[0,1,1]
    v_pk_fma_f32 v[64:65], v[252:253], v[64:65], v[180:181] op_sel:[1,0,0] op_sel_hi:[1,1,1]
    v_pk_fma_f32 v[66:67], v[252:253], v[66:67], v[182:183] op_sel:[1,0,0] op_sel_hi:[1,1,1]
    v_pk_mul_f32 v[184:185], v[60:61], v[60:61]
    v_pk_mul_f32 v[186:187], v[62:63], v[62:63]
    v_pk_mul_f32 v[188:189], v[64:65], v[64:65]
    v_pk_mul_f32 v[190:191], v[66:67], v[66:67]
    v_pk_fma_f32 v[184:185], v[184:185], v[248:249], v[246:247]
    v_pk_fma_f32 v[186:187], v[186:187], v[248:249], v[246:247]
    v_pk_fma_f32 v[188:189], v[188:189], v[248:249], v[246:247]
    v_pk_fma_f32 v[190:191], v[190:191], v[248:249], v[246:247]
    v_pk_mul_f32 v[184:185], v[184:185], v[60:61]
    v_pk_mul_f32 v[186:187], v[186:187], v[62:63]
    v_pk_mul_f32 v[188:189], v[188:189], v[64:65]
    v_pk_mul_f32 v[190:191], v[190:191], v[66:67]
    v_exp_f32 v184, v184
    v_exp_f32 v185, v185
    v_exp_f32 v186, v186
    v_exp_f32 v187, v187
    v_exp_f32 v188, v188
    v_exp_f32 v189, v189
    v_exp_f32 v190, v190
    v_exp_f32 v191, v191
    v_pk_add_f32 v[184:185], v[184:185], v[250:251]
    v_pk_add_f32 v[186:187], v[186:187], v[250:251]
    v_pk_add_f32 v[188:189], v[188:189], v[250:251]
    v_pk_add_f32 v[190:191], v[190:191], v[250:251]
    v_rcp_f32 v184, v184
    v_rcp_f32 v185, v185
    v_rcp_f32 v186, v186
    v_rcp_f32 v187, v187
    v_rcp_f32 v188, v188
    v_rcp_f32 v189, v189
    v_rcp_f32 v190, v190
    v_rcp_f32 v191, v191
    v_pk_mul_f32 v[60:61], v[60:61], v[184:185]
    v_pk_mul_f32 v[62:63], v[62:63], v[186:187]
    v_pk_mul_f32 v[64:65], v[64:65], v[188:189]
    v_pk_mul_f32 v[66:67], v[66:67], v[190:191]
    v_cvt_pk_bf16_f32 v60, v60, v61
    v_cvt_pk_bf16_f32 v61, v62, v63
    v_cvt_pk_bf16_f32 v62, v64, v65
    v_cvt_pk_bf16_f32 v63, v66, v67
    s_nop 0
    v_permlane16_swap_b32 v60, v62
    v_permlane16_swap_b32 v61, v63
    buffer_store_dwordx4 v[60:63], v14, s[24:27], s57 offen sc1
    v_lshlrev_b32 v172, 16, v236
    v_and_b32 v173, s77, v236
    v_lshlrev_b32 v174, 16, v237
    v_and_b32 v175, s77, v237
    s_waitcnt lgkmcnt(4)
    v_pk_fma_f32 v[176:177], v[254:255], v[144:145], v[172:173] op_sel:[0,0,0] op_sel_hi:[0,1,1]
    v_pk_fma_f32 v[178:179], v[254:255], v[146:147], v[174:175] op_sel:[0,0,0] op_sel_hi:[0,1,1]
    v_pk_fma_f32 v[180:181], v[254:255], v[144:145], v[172:173] op_sel:[1,0,0] op_sel_hi:[1,1,1]
    v_pk_fma_f32 v[182:183], v[254:255], v[146:147], v[174:175] op_sel:[1,0,0] op_sel_hi:[1,1,1]
    v_pk_fma_f32 v[68:69], v[252:253], v[68:69], v[176:177] op_sel:[0,0,0] op_sel_hi:[0,1,1]
    v_pk_fma_f32 v[70:71], v[252:253], v[70:71], v[178:179] op_sel:[0,0,0] op_sel_hi:[0,1,1]
    v_pk_fma_f32 v[72:73], v[252:253], v[72:73], v[180:181] op_sel:[1,0,0] op_sel_hi:[1,1,1]
    v_pk_fma_f32 v[74:75], v[252:253], v[74:75], v[182:183] op_sel:[1,0,0] op_sel_hi:[1,1,1]
    v_pk_mul_f32 v[184:185], v[68:69], v[68:69]
    v_pk_mul_f32 v[186:187], v[70:71], v[70:71]
    v_pk_mul_f32 v[188:189], v[72:73], v[72:73]
    v_pk_mul_f32 v[190:191], v[74:75], v[74:75]
    v_pk_fma_f32 v[184:185], v[184:185], v[248:249], v[246:247]
    v_pk_fma_f32 v[186:187], v[186:187], v[248:249], v[246:247]
    v_pk_fma_f32 v[188:189], v[188:189], v[248:249], v[246:247]
    v_pk_fma_f32 v[190:191], v[190:191], v[248:249], v[246:247]
    v_pk_mul_f32 v[184:185], v[184:185], v[68:69]
    v_pk_mul_f32 v[186:187], v[186:187], v[70:71]
    v_pk_mul_f32 v[188:189], v[188:189], v[72:73]
    v_pk_mul_f32 v[190:191], v[190:191], v[74:75]
    v_exp_f32 v184, v184
    v_exp_f32 v185, v185
    v_exp_f32 v186, v186
    v_exp_f32 v187, v187
    v_exp_f32 v188, v188
    v_exp_f32 v189, v189
    v_exp_f32 v190, v190
    v_exp_f32 v191, v191
    v_pk_add_f32 v[184:185], v[184:185], v[250:251]
    v_pk_add_f32 v[186:187], v[186:187], v[250:251]
    v_pk_add_f32 v[188:189], v[188:189], v[250:251]
    v_pk_add_f32 v[190:191], v[190:191], v[250:251]
    v_rcp_f32 v184, v184
    v_rcp_f32 v185, v185
    v_rcp_f32 v186, v186
    v_rcp_f32 v187, v187
    v_rcp_f32 v188, v188
    v_rcp_f32 v189, v189
    v_rcp_f32 v190, v190
    v_rcp_f32 v191, v191
    v_pk_mul_f32 v[68:69], v[68:69], v[184:185]
    v_pk_mul_f32 v[70:71], v[70:71], v[186:187]
    v_pk_mul_f32 v[72:73], v[72:73], v[188:189]
    v_pk_mul_f32 v[74:75], v[74:75], v[190:191]
    v_cvt_pk_bf16_f32 v68, v68, v69
    v_cvt_pk_bf16_f32 v69, v70, v71
    v_cvt_pk_bf16_f32 v70, v72, v73
    v_cvt_pk_bf16_f32 v71, v74, v75
    s_nop 0
    v_permlane16_swap_b32 v68, v70
    v_permlane16_swap_b32 v69, v71
    buffer_store_dwordx4 v[68:71], v14, s[24:27], s58 offen sc1
    v_lshlrev_b32 v172, 16, v238
    v_and_b32 v173, s77, v238
    v_lshlrev_b32 v174, 16, v239
    v_and_b32 v175, s77, v239
    s_waitcnt lgkmcnt(3)
    v_pk_fma_f32 v[176:177], v[254:255], v[148:149], v[172:173] op_sel:[0,0,0] op_sel_hi:[0,1,1]
    v_pk_fma_f32 v[178:179], v[254:255], v[150:151], v[174:175] op_sel:[0,0,0] op_sel_hi:[0,1,1]
    v_pk_fma_f32 v[180:181], v[254:255], v[148:149], v[172:173] op_sel:[1,0,0] op_sel_hi:[1,1,1]
    v_pk_fma_f32 v[182:183], v[254:255], v[150:151], v[174:175] op_sel:[1,0,0] op_sel_hi:[1,1,1]
    v_pk_fma_f32 v[76:77], v[252:253], v[76:77], v[176:177] op_sel:[0,0,0] op_sel_hi:[0,1,1]
    v_pk_fma_f32 v[78:79], v[252:253], v[78:79], v[178:179] op_sel:[0,0,0] op_sel_hi:[0,1,1]
    v_pk_fma_f32 v[80:81], v[252:253], v[80:81], v[180:181] op_sel:[1,0,0] op_sel_hi:[1,1,1]
    v_pk_fma_f32 v[82:83], v[252:253], v[82:83], v[182:183] op_sel:[1,0,0] op_sel_hi:[1,1,1]
    v_pk_mul_f32 v[184:185], v[76:77], v[76:77]
    v_pk_mul_f32 v[186:187], v[78:79], v[78:79]
    v_pk_mul_f32 v[188:189], v[80:81], v[80:81]
    v_pk_mul_f32 v[190:191], v[82:83], v[82:83]
    v_pk_fma_f32 v[184:185], v[184:185], v[248:249], v[246:247]
    v_pk_fma_f32 v[186:187], v[186:187], v[248:249], v[246:247]
    v_pk_fma_f32 v[188:189], v[188:189], v[248:249], v[246:247]
    v_pk_fma_f32 v[190:191], v[190:191], v[248:249], v[246:247]
    v_pk_mul_f32 v[184:185], v[184:185], v[76:77]
    v_pk_mul_f32 v[186:187], v[186:187], v[78:79]
    v_pk_mul_f32 v[188:189], v[188:189], v[80:81]
    v_pk_mul_f32 v[190:191], v[190:191], v[82:83]
    v_exp_f32 v184, v184
    v_exp_f32 v185, v185
    v_exp_f32 v186, v186
    v_exp_f32 v187, v187
    v_exp_f32 v188, v188
    v_exp_f32 v189, v189
    v_exp_f32 v190, v190
    v_exp_f32 v191, v191
    v_pk_add_f32 v[184:185], v[184:185], v[250:251]
    v_pk_add_f32 v[186:187], v[186:187], v[250:251]
    v_pk_add_f32 v[188:189], v[188:189], v[250:251]
    v_pk_add_f32 v[190:191], v[190:191], v[250:251]
    v_rcp_f32 v184, v184
    v_rcp_f32 v185, v185
    v_rcp_f32 v186, v186
    v_rcp_f32 v187, v187
    v_rcp_f32 v188, v188
    v_rcp_f32 v189, v189
    v_rcp_f32 v190, v190
    v_rcp_f32 v191, v191
    v_pk_mul_f32 v[76:77], v[76:77], v[184:185]
    v_pk_mul_f32 v[78:79], v[78:79], v[186:187]
    v_pk_mul_f32 v[80:81], v[80:81], v[188:189]
    v_pk_mul_f32 v[82:83], v[82:83], v[190:191]
    v_cvt_pk_bf16_f32 v76, v76, v77
    v_cvt_pk_bf16_f32 v77, v78, v79
    v_cvt_pk_bf16_f32 v78, v80, v81
    v_cvt_pk_bf16_f32 v79, v82, v83
    s_nop 0
    v_permlane16_swap_b32 v76, v78
    v_permlane16_swap_b32 v77, v79
    buffer_store_dwordx4 v[76:79], v14, s[24:27], s59 offen sc1
    v_lshlrev_b32 v172, 16, v240
    v_and_b32 v173, s77, v240
    v_lshlrev_b32 v174, 16, v241
    v_and_b32 v175, s77, v241
    s_waitcnt lgkmcnt(2)
    v_pk_fma_f32 v[176:177], v[254:255], v[152:153], v[172:173] op_sel:[0,0,0] op_sel_hi:[0,1,1]
    v_pk_fma_f32 v[178:179], v[254:255], v[154:155], v[174:175] op_sel:[0,0,0] op_sel_hi:[0,1,1]
    v_pk_fma_f32 v[180:181], v[254:255], v[152:153], v[172:173] op_sel:[1,0,0] op_sel_hi:[1,1,1]
    v_pk_fma_f32 v[182:183], v[254:255], v[154:155], v[174:175] op_sel:[1,0,0] op_sel_hi:[1,1,1]
    v_pk_fma_f32 v[84:85], v[252:253], v[84:85], v[176:177] op_sel:[0,0,0] op_sel_hi:[0,1,1]
    v_pk_fma_f32 v[86:87], v[252:253], v[86:87], v[178:179] op_sel:[0,0,0] op_sel_hi:[0,1,1]
    v_pk_fma_f32 v[88:89], v[252:253], v[88:89], v[180:181] op_sel:[1,0,0] op_sel_hi:[1,1,1]
    v_pk_fma_f32 v[90:91], v[252:253], v[90:91], v[182:183] op_sel:[1,0,0] op_sel_hi:[1,1,1]
    v_pk_mul_f32 v[184:185], v[84:85], v[84:85]
    v_pk_mul_f32 v[186:187], v[86:87], v[86:87]
    v_pk_mul_f32 v[188:189], v[88:89], v[88:89]
    v_pk_mul_f32 v[190:191], v[90:91], v[90:91]
    v_pk_fma_f32 v[184:185], v[184:185], v[248:249], v[246:247]
    v_pk_fma_f32 v[186:187], v[186:187], v[248:249], v[246:247]
    v_pk_fma_f32 v[188:189], v[188:189], v[248:249], v[246:247]
    v_pk_fma_f32 v[190:191], v[190:191], v[248:249], v[246:247]
    v_pk_mul_f32 v[184:185], v[184:185], v[84:85]
    v_pk_mul_f32 v[186:187], v[186:187], v[86:87]
    v_pk_mul_f32 v[188:189], v[188:189], v[88:89]
    v_pk_mul_f32 v[190:191], v[190:191], v[90:91]
    v_exp_f32 v184, v184
    v_exp_f32 v185, v185
    v_exp_f32 v186, v186
    v_exp_f32 v187, v187
    v_exp_f32 v188, v188
    v_exp_f32 v189, v189
    v_exp_f32 v190, v190
    v_exp_f32 v191, v191
    v_pk_add_f32 v[184:185], v[184:185], v[250:251]
    v_pk_add_f32 v[186:187], v[186:187], v[250:251]
    v_pk_add_f32 v[188:189], v[188:189], v[250:251]
    v_pk_add_f32 v[190:191], v[190:191], v[250:251]
    v_rcp_f32 v184, v184
    v_rcp_f32 v185, v185
    v_rcp_f32 v186, v186
    v_rcp_f32 v187, v187
    v_rcp_f32 v188, v188
    v_rcp_f32 v189, v189
    v_rcp_f32 v190, v190
    v_rcp_f32 v191, v191
    v_pk_mul_f32 v[84:85], v[84:85], v[184:185]
    v_pk_mul_f32 v[86:87], v[86:87], v[186:187]
    v_pk_mul_f32 v[88:89], v[88:89], v[188:189]
    v_pk_mul_f32 v[90:91], v[90:91], v[190:191]
    v_cvt_pk_bf16_f32 v84, v84, v85
    v_cvt_pk_bf16_f32 v85, v86, v87
    v_cvt_pk_bf16_f32 v86, v88, v89
    v_cvt_pk_bf16_f32 v87, v90, v91
    s_nop 0
    v_permlane16_swap_b32 v84, v86
    v_permlane16_swap_b32 v85, v87
    v_mov_b32 v208, s74
    v_mov_b32 v209, 1
    s_mov_b32 s7, 0
    s_waitcnt vmcnt(4)
    s_mov_b64 exec, 1
    buffer_store_dword v209, v208, s[24:27], s7 offen sc1
    s_mov_b64 exec, -1
    buffer_store_dwordx4 v[84:87], v14, s[24:27], s60 offen sc1
    v_lshlrev_b32 v172, 16, v242
    v_and_b32 v173, s77, v242
    v_lshlrev_b32 v174, 16, v243
    v_and_b32 v175, s77, v243
    s_waitcnt lgkmcnt(1)
    v_pk_fma_f32 v[176:177], v[254:255], v[156:157], v[172:173] op_sel:[0,0,0] op_sel_hi:[0,1,1]
    v_pk_fma_f32 v[178:179], v[254:255], v[158:159], v[174:175] op_sel:[0,0,0] op_sel_hi:[0,1,1]
    v_pk_fma_f32 v[180:181], v[254:255], v[156:157], v[172:173] op_sel:[1,0,0] op_sel_hi:[1,1,1]
    v_pk_fma_f32 v[182:183], v[254:255], v[158:159], v[174:175] op_sel:[1,0,0] op_sel_hi:[1,1,1]
    v_pk_fma_f32 v[92:93], v[252:253], v[92:93], v[176:177] op_sel:[0,0,0] op_sel_hi:[0,1,1]
    v_pk_fma_f32 v[94:95], v[252:253], v[94:95], v[178:179] op_sel:[0,0,0] op_sel_hi:[0,1,1]
    v_pk_fma_f32 v[96:97], v[252:253], v[96:97], v[180:181] op_sel:[1,0,0] op_sel_hi:[1,1,1]
    v_pk_fma_f32 v[98:99], v[252:253], v[98:99], v[182:183] op_sel:[1,0,0] op_sel_hi:[1,1,1]
    v_pk_mul_f32 v[184:185], v[92:93], v[92:93]
    v_pk_mul_f32 v[186:187], v[94:95], v[94:95]
    v_pk_mul_f32 v[188:189], v[96:97], v[96:97]
    v_pk_mul_f32 v[190:191], v[98:99], v[98:99]
    v_pk_fma_f32 v[184:185], v[184:185], v[248:249], v[246:247]
    v_pk_fma_f32 v[186:187], v[186:187], v[248:249], v[246:247]
    v_pk_fma_f32 v[188:189], v[188:189], v[248:249], v[246:247]
    v_pk_fma_f32 v[190:191], v[190:191], v[248:249], v[246:247]
    v_pk_mul_f32 v[184:185], v[184:185], v[92:93]
    v_pk_mul_f32 v[186:187], v[186:187], v[94:95]
    v_pk_mul_f32 v[188:189], v[188:189], v[96:97]
    v_pk_mul_f32 v[190:191], v[190:191], v[98:99]
    v_exp_f32 v184, v184
    v_exp_f32 v185, v185
    v_exp_f32 v186, v186
    v_exp_f32 v187, v187
    v_exp_f32 v188, v188
    v_exp_f32 v189, v189
    v_exp_f32 v190, v190
    v_exp_f32 v191, v191
    v_pk_add_f32 v[184:185], v[184:185], v[250:251]
    v_pk_add_f32 v[186:187], v[186:187], v[250:251]
    v_pk_add_f32 v[188:189], v[188:189], v[250:251]
    v_pk_add_f32 v[190:191], v[190:191], v[250:251]
    v_rcp_f32 v184, v184
    v_rcp_f32 v185, v185
    v_rcp_f32 v186, v186
    v_rcp_f32 v187, v187
    v_rcp_f32 v188, v188
    v_rcp_f32 v189, v189
    v_rcp_f32 v190, v190
    v_rcp_f32 v191, v191
    v_pk_mul_f32 v[92:93], v[92:93], v[184:185]
    v_pk_mul_f32 v[94:95], v[94:95], v[186:187]
    v_pk_mul_f32 v[96:97], v[96:97], v[188:189]
    v_pk_mul_f32 v[98:99], v[98:99], v[190:191]
    v_cvt_pk_bf16_f32 v92, v92, v93
    v_cvt_pk_bf16_f32 v93, v94, v95
    v_cvt_pk_bf16_f32 v94, v96, v97
    v_cvt_pk_bf16_f32 v95, v98, v99
    s_nop 0
    v_permlane16_swap_b32 v92, v94
    v_permlane16_swap_b32 v93, v95
    buffer_store_dwordx4 v[92:95], v14, s[24:27], s61 offen sc1
    v_lshlrev_b32 v172, 16, v244
    v_and_b32 v173, s77, v244
    v_lshlrev_b32 v174, 16, v245
    v_and_b32 v175, s77, v245
    s_waitcnt lgkmcnt(0)
    v_pk_fma_f32 v[176:177], v[254:255], v[160:161], v[172:173] op_sel:[0,0,0] op_sel_hi:[0,1,1]
    v_pk_fma_f32 v[178:179], v[254:255], v[162:163], v[174:175] op_sel:[0,0,0] op_sel_hi:[0,1,1]
    v_pk_fma_f32 v[180:181], v[254:255], v[160:161], v[172:173] op_sel:[1,0,0] op_sel_hi:[1,1,1]
    v_pk_fma_f32 v[182:183], v[254:255], v[162:163], v[174:175] op_sel:[1,0,0] op_sel_hi:[1,1,1]
    v_pk_fma_f32 v[100:101], v[252:253], v[100:101], v[176:177] op_sel:[0,0,0] op_sel_hi:[0,1,1]
    v_pk_fma_f32 v[102:103], v[252:253], v[102:103], v[178:179] op_sel:[0,0,0] op_sel_hi:[0,1,1]
    v_pk_fma_f32 v[104:105], v[252:253], v[104:105], v[180:181] op_sel:[1,0,0] op_sel_hi:[1,1,1]
    v_pk_fma_f32 v[106:107], v[252:253], v[106:107], v[182:183] op_sel:[1,0,0] op_sel_hi:[1,1,1]
    v_pk_mul_f32 v[184:185], v[100:101], v[100:101]
    v_pk_mul_f32 v[186:187], v[102:103], v[102:103]
    v_pk_mul_f32 v[188:189], v[104:105], v[104:105]
    v_pk_mul_f32 v[190:191], v[106:107], v[106:107]
    v_pk_fma_f32 v[184:185], v[184:185], v[248:249], v[246:247]
    v_pk_fma_f32 v[186:187], v[186:187], v[248:249], v[246:247]
    v_pk_fma_f32 v[188:189], v[188:189], v[248:249], v[246:247]
    v_pk_fma_f32 v[190:191], v[190:191], v[248:249], v[246:247]
    v_pk_mul_f32 v[184:185], v[184:185], v[100:101]
    v_pk_mul_f32 v[186:187], v[186:187], v[102:103]
    v_pk_mul_f32 v[188:189], v[188:189], v[104:105]
    v_pk_mul_f32 v[190:191], v[190:191], v[106:107]
    v_exp_f32 v184, v184
    v_exp_f32 v185, v185
    v_exp_f32 v186, v186
    v_exp_f32 v187, v187
    v_exp_f32 v188, v188
    v_exp_f32 v189, v189
    v_exp_f32 v190, v190
    v_exp_f32 v191, v191
    v_pk_add_f32 v[184:185], v[184:185], v[250:251]
    v_pk_add_f32 v[186:187], v[186:187], v[250:251]
    v_pk_add_f32 v[188:189], v[188:189], v[250:251]
    v_pk_add_f32 v[190:191], v[190:191], v[250:251]
    v_rcp_f32 v184, v184
    v_rcp_f32 v185, v185
    v_rcp_f32 v186, v186
    v_rcp_f32 v187, v187
    v_rcp_f32 v188, v188
    v_rcp_f32 v189, v189
    v_rcp_f32 v190, v190
    v_rcp_f32 v191, v191
    v_pk_mul_f32 v[100:101], v[100:101], v[184:185]
    v_pk_mul_f32 v[102:103], v[102:103], v[186:187]
    v_pk_mul_f32 v[104:105], v[104:105], v[188:189]
    v_pk_mul_f32 v[106:107], v[106:107], v[190:191]
    v_cvt_pk_bf16_f32 v100, v100, v101
    v_cvt_pk_bf16_f32 v101, v102, v103
    v_cvt_pk_bf16_f32 v102, v104, v105
    v_cvt_pk_bf16_f32 v103, v106, v107
    s_nop 0
    v_permlane16_swap_b32 v100, v102
    v_permlane16_swap_b32 v101, v103
    buffer_store_dwordx4 v[100:103], v14, s[24:27], s62 offen sc1
    v_lshrrev_b32 v24, 4, v0
    v_bfe_u32 v25, v0, 2, 2
    v_and_b32 v26, 3, v0
    v_and_b32 v27, 1, v24
    v_lshrrev_b32 v28, 1, v26
    v_lshl_add_u32 v27, v27, 1, v28
    v_lshrrev_b32 v28, 1, v25
    v_lshlrev_b32 v28, 2, v28
    v_xor_b32 v27, v27, v28
    v_lshlrev_b32 v27, 4, v27
    v_lshrrev_b32 v24, 1, v24
    v_lshl_add_u32 v27, v24, 10, v27
    v_lshl_add_u32 v27, v25, 7, v27
    v_and_b32 v28, 1, v26
    v_lshl_add_u32 v16, v28, 3, v27
    s_lshl_b32 s7, s3, 11
    v_add_u32 v16, s7, v16
    v_xor_b32 v17, 64, v16
    v_add_u32 v18, 55296, v16
    v_add_u32 v19, 55296, v17
    v_add_u32 v20, 104448, v16
    v_add_u32 v21, 104448, v17
    s_lshl_b32 s7, s3, 2
    s_add_u32 s7, s7, 163648
    v_mov_b32 v22, s7
    s_mov_b32 s73, 0
    s_add_u32 s52, s76, 0
    s_and_b32 s52, s52, 7
    s_lshl_b32 s52, s52, 10
    s_add_u32 s53, s76, 1
    s_and_b32 s53, s53, 7
    s_lshl_b32 s53, s53, 10
    s_add_u32 s54, s76, 2
    s_and_b32 s54, s54, 7
    s_lshl_b32 s54, s54, 10
    s_add_u32 s55, s76, 3
    s_and_b32 s55, s55, 7
    s_lshl_b32 s55, s55, 10
    s_add_u32 s56, s76, 4
    s_and_b32 s56, s56, 7
    s_lshl_b32 s56, s56, 10
    s_add_u32 s57, s76, 5
    s_and_b32 s57, s57, 7
    s_lshl_b32 s57, s57, 10
    s_add_u32 s58, s76, 6
    s_and_b32 s58, s58, 7
    s_lshl_b32 s58, s58, 10
    s_add_u32 s59, s76, 7
    s_and_b32 s59, s59, 7
    s_lshl_b32 s59, s59, 10
    s_mov_b32 s100, s76
    s_sub_u32 s101, s100, 7
    s_min_u32 s100, s101, s100
    s_sub_u32 s101, s100, 7
    s_min_u32 s100, s101, s100
    s_sub_u32 s101, s100, 7
    s_min_u32 s100, s101, s100
    s_sub_u32 s101, s100, 7
    s_min_u32 s100, s101, s100
    s_add_u32 s60, s100, 0
    s_sub_u32 s101, s60, 7
    s_min_u32 s60, s101, s60
    s_add_u32 s60, s60, 8
    s_lshl_b32 s60, s60, 10
    s_add_u32 s61, s100, 1
    s_sub_u32 s101, s61, 7
    s_min_u32 s61, s101, s61
    s_add_u32 s61, s61, 8
    s_lshl_b32 s61, s61, 10
    s_add_u32 s62, s100, 2
    s_sub_u32 s101, s62, 7
    s_min_u32 s62, s101, s62
    s_add_u32 s62, s62, 8
    s_lshl_b32 s62, s62, 10
    s_add_u32 s63, s100, 3
    s_sub_u32 s101, s63, 7
    s_min_u32 s63, s101, s63
    s_add_u32 s63, s63, 8
    s_lshl_b32 s63, s63, 10
    s_add_u32 s64, s100, 4
    s_sub_u32 s101, s64, 7
    s_min_u32 s64, s101, s64
    s_add_u32 s64, s64, 8
    s_lshl_b32 s64, s64, 10
    s_add_u32 s65, s100, 5
    s_sub_u32 s101, s65, 7
    s_min_u32 s65, s101, s65
    s_add_u32 s65, s65, 8
    s_lshl_b32 s65, s65, 10
    s_add_u32 s66, s100, 6
    s_sub_u32 s101, s66, 7
    s_min_u32 s66, s101, s66
    s_add_u32 s66, s66, 8
    s_lshl_b32 s66, s66, 10
    v_mov_b32 v24, s74
    v_mov_b32 v25, 1
    s_mov_b32 s7, 1024
    s_waitcnt vmcnt(4)
    s_mov_b64 exec, 1
    buffer_store_dword v25, v24, s[24:27], s7 offen sc1
    s_mov_b64 exec, -1
    v_mov_b32 v24, s74
    v_mov_b32 v25, 1
    s_mov_b32 s7, 2048
    s_waitcnt vmcnt(1)
    s_mov_b64 exec, 1
    buffer_store_dword v25, v24, s[24:27], s7 offen sc1
    s_mov_b64 exec, -1
    s_lshl_b32 s7, s67, 1
    s_add_u32 s7, s7, s68
    s_lshl_b32 s7, s7, 7
    s_lshl_b32 s70, s48, 2
    s_add_u32 s7, s7, s70
    s_add_u32 s7, s7, 32
    v_add_u32 v3, s7, v0
    s_mov_b32 s50, 0xff
    s_add_u32 s70, s70, 16
    s_lshl_b32 s74, s70, 6
    s_mov_b32 s72, 0
    s_mov_b32 s51, 0
    v_lshlrev_b32 v3, 6, v3
    v_add_u32 v3, 8388608, v3
    s_lshl_b32 s7, s67, 7
    s_lshl_b32 s71, s68, 6
    s_add_u32 s7, s7, s71
    s_lshl_b32 s71, s3, 3
    s_add_u32 s7, s7, s71
    v_lshrrev_b32 v27, 3, v0
    v_and_b32 v26, 7, v0
    s_lshl_b32 s71, s69, 7
    v_lshl_add_u32 v7, v26, 4, s71
    v_add_u32 v6, s7, v27
    v_lshl_add_u32 v6, v6, 10, v7
    buffer_load_dwordx4 v[8:11], v6, s[8:11], 0 offen
    buffer_load_dwordx4 v[12:15], v7, s[36:39], 0 offen
    s_lshl_b32 s7, s67, 2
    s_lshl_b32 s71, s68, 1
    s_add_u32 s7, s7, s71
    s_lshl_b32 s7, s7, 7
    s_mul_i32 s71, s3, 15
    s_add_u32 s7, s7, s71
    s_lshl_b32 s7, s7, 10
    v_lshl_add_u32 v1, v0, 4, s7
    v_add_u32 v2, 0x20000, v1
    v_lshlrev_b32 v26, 1, v26
    v_xor_b32 v26, v26, v27
    v_lshlrev_b32 v26, 4, v26
    v_lshl_add_u32 v26, v27, 8, v26
    s_lshl_b32 s7, s3, 14
    v_add_u32 v4, s7, v26
    v_xor_b32 v5, 16, v4
L_wl_9:
    ds_read_b32 v23, v22
    s_add_u32 s73, s73, 1
    s_waitcnt lgkmcnt(0)
    v_readfirstlane_b32 s7, v23
    s_nop 1
    s_cmp_ge_u32 s7, 1
    s_cbranch_scc1 L_wl_ok_10
    s_sleep 1
    s_cmp_lt_u32 s73, 100000
    s_cbranch_scc1 L_wl_9
L_wl_ok_10:
    ds_read_b64_tr_b16 v[136:137], v16 offset:38912
    ds_read_b64_tr_b16 v[138:139], v16 offset:39424
    ds_read_b64_tr_b16 v[140:141], v17 offset:38912
    ds_read_b64_tr_b16 v[142:143], v17 offset:39424
    ds_read_b64_tr_b16 v[144:145], v16 offset:47104
    ds_read_b64_tr_b16 v[146:147], v16 offset:47616
    ds_read_b64_tr_b16 v[148:149], v17 offset:47104
    ds_read_b64_tr_b16 v[150:151], v17 offset:47616
    ds_read_b64_tr_b16 v[152:153], v20 offset:0
    ds_read_b64_tr_b16 v[154:155], v20 offset:512
    ds_read_b64_tr_b16 v[156:157], v21 offset:0
    ds_read_b64_tr_b16 v[158:159], v21 offset:512
    s_waitcnt lgkmcnt(4)
    ds_read_b64_tr_b16 v[160:161], v20 offset:8192
    ds_read_b64_tr_b16 v[162:163], v20 offset:8704
    ds_read_b64_tr_b16 v[164:165], v21 offset:8192
    ds_read_b64_tr_b16 v[166:167], v21 offset:8704
    ds_read_b64_tr_b16 v[168:169], v20 offset:16384
    ds_read_b64_tr_b16 v[170:171], v20 offset:16896
    ds_read_b64_tr_b16 v[172:173], v21 offset:16384
    ds_read_b64_tr_b16 v[174:175], v21 offset:16896
L_wl_11:
    ds_read_b32 v23, v22
    s_add_u32 s73, s73, 1
    s_waitcnt lgkmcnt(0)
    v_readfirstlane_b32 s7, v23
    s_nop 1
    s_cmp_ge_u32 s7, 2
    s_cbranch_scc1 L_wl_ok_12
    s_sleep 1
    s_cmp_lt_u32 s73, 100000
    s_cbranch_scc1 L_wl_11
L_wl_ok_12:
    ds_read_b64_tr_b16 v[176:177], v16 offset:2048
    ds_read_b64_tr_b16 v[178:179], v16 offset:2560
    ds_read_b64_tr_b16 v[180:181], v17 offset:2048
    ds_read_b64_tr_b16 v[182:183], v17 offset:2560
    ds_read_b64_tr_b16 v[184:185], v16 offset:10240
    ds_read_b64_tr_b16 v[186:187], v16 offset:10752
    ds_read_b64_tr_b16 v[188:189], v17 offset:10240
    ds_read_b64_tr_b16 v[190:191], v17 offset:10752
    ds_read_b64_tr_b16 v[192:193], v18 offset:0
    ds_read_b64_tr_b16 v[194:195], v18 offset:512
    ds_read_b64_tr_b16 v[196:197], v19 offset:0
    ds_read_b64_tr_b16 v[198:199], v19 offset:512
    s_waitcnt lgkmcnt(4)
    ds_read_b64_tr_b16 v[200:201], v18 offset:8192
    ds_read_b64_tr_b16 v[202:203], v18 offset:8704
    ds_read_b64_tr_b16 v[204:205], v19 offset:8192
    ds_read_b64_tr_b16 v[206:207], v19 offset:8704
    ds_read_b64_tr_b16 v[208:209], v18 offset:16384
    ds_read_b64_tr_b16 v[210:211], v18 offset:16896
    ds_read_b64_tr_b16 v[212:213], v19 offset:16384
    ds_read_b64_tr_b16 v[214:215], v19 offset:16896
L_wl_13:
    ds_read_b32 v23, v22
    s_add_u32 s73, s73, 1
    s_waitcnt lgkmcnt(0)
    v_readfirstlane_b32 s7, v23
    s_nop 1
    s_cmp_ge_u32 s7, 3
    s_cbranch_scc1 L_wl_ok_14
    s_sleep 1
    s_cmp_lt_u32 s73, 100000
    s_cbranch_scc1 L_wl_13
L_wl_ok_14:
    ds_read_b64_tr_b16 v[216:217], v16 offset:20480
    ds_read_b64_tr_b16 v[218:219], v16 offset:20992
    ds_read_b64_tr_b16 v[220:221], v17 offset:20480
    ds_read_b64_tr_b16 v[222:223], v17 offset:20992
    ds_read_b64_tr_b16 v[224:225], v16 offset:28672
    ds_read_b64_tr_b16 v[226:227], v16 offset:29184
    ds_read_b64_tr_b16 v[228:229], v17 offset:28672
    ds_read_b64_tr_b16 v[230:231], v17 offset:29184
    ds_read_b64_tr_b16 v[232:233], v18 offset:24576
    ds_read_b64_tr_b16 v[234:235], v18 offset:25088
    ds_read_b64_tr_b16 v[236:237], v19 offset:24576
    ds_read_b64_tr_b16 v[238:239], v19 offset:25088
    s_waitcnt lgkmcnt(4)
    ds_read_b64_tr_b16 v[240:241], v18 offset:32768
    ds_read_b64_tr_b16 v[242:243], v18 offset:33280
    ds_read_b64_tr_b16 v[244:245], v19 offset:32768
    ds_read_b64_tr_b16 v[246:247], v19 offset:33280
    ds_read_b64_tr_b16 v[248:249], v18 offset:40960
    ds_read_b64_tr_b16 v[250:251], v18 offset:41472
    ds_read_b64_tr_b16 v[252:253], v19 offset:40960
    ds_read_b64_tr_b16 v[254:255], v19 offset:41472
    v_mov_b32 v23, 1
    s_waitcnt lgkmcnt(0)
    ds_write_b32 v22, v23 offset:16
    s_setprio 0
    s_branch L_poll
L_poll:
    s_mov_b32 s73, 0
L_poll1:
    s_mov_b64 exec, s[50:51]
    buffer_load_dword v18, v3, s[24:27], s74 offen sc1
L_poll2:
    s_add_u32 s73, s73, 1
    s_waitcnt vmcnt(0)
    v_cmp_ne_u32 vcc, 1, v18
    s_mov_b64 exec, -1
    s_nop 4
    s_cbranch_vccz L_poll_ok
    s_cmp_lt_u32 s73, 20000
    s_cbranch_scc1 L_poll1
L_poll_ok:
    buffer_load_dwordx4 v[80:83], v1, s[24:27], s52 offen sc1
    buffer_load_dwordx4 v[84:87], v2, s[24:27], s52 offen sc1
    buffer_load_dwordx4 v[88:91], v1, s[24:27], s53 offen sc1
    buffer_load_dwordx4 v[92:95], v2, s[24:27], s53 offen sc1
    buffer_load_dwordx4 v[96:99], v1, s[24:27], s54 offen sc1
    buffer_load_dwordx4 v[100:103], v2, s[24:27], s54 offen sc1
    s_mov_b64 exec, 15
    buffer_load_dword v132, v3, s[24:27], s72 offen sc1
    s_mov_b64 exec, -1
    buffer_load_dwordx4 v[104:107], v1, s[24:27], s55 offen sc1
    buffer_load_dwordx4 v[108:111], v2, s[24:27], s55 offen sc1
    buffer_load_dwordx4 v[112:115], v1, s[24:27], s56 offen sc1
    buffer_load_dwordx4 v[116:119], v2, s[24:27], s56 offen sc1
    buffer_load_dwordx4 v[120:123], v1, s[24:27], s57 offen sc1
    buffer_load_dwordx4 v[124:127], v2, s[24:27], s57 offen sc1
    buffer_load_dwordx4 v[128:131], v1, s[24:27], s58 offen sc1
    v_and_b32 v134, 7, v0
    v_lshrrev_b32 v133, 5, v0
    v_xor_b32 v133, v133, v134
    v_lshlrev_b32 v133, 4, v133
    v_lshl_add_u32 v133, v134, 8, v133
    v_bfe_u32 v134, v0, 3, 2
    v_lshl_add_u32 v133, v134, 14, v133
    s_lshl_b32 s7, s3, 11
    v_add_u32 v133, s7, v133
    s_waitcnt vmcnt(13)
    s_waitcnt lgkmcnt(0)
    v_mfma_f32_32x32x16_bf16 v[16:31], v[136:139], v[80:83], 0
    v_mfma_f32_32x32x16_bf16 v[32:47], v[140:143], v[80:83], 0
    buffer_load_dwordx4 v[80:83], v2, s[24:27], s58 offen sc1
    s_waitcnt vmcnt(13)
    v_mfma_f32_32x32x16_bf16 v[48:63], v[136:139], v[84:87], 0
    v_mfma_f32_32x32x16_bf16 v[64:79], v[140:143], v[84:87], 0
    buffer_load_dwordx4 v[84:87], v1, s[24:27], s59 offen sc1
    s_waitcnt vmcnt(13)
    v_mfma_f32_32x32x16_bf16 v[16:31], v[144:147], v[88:91], v[16:31]
    v_mfma_f32_32x32x16_bf16 v[32:47], v[148:151], v[88:91], v[32:47]
    buffer_load_dwordx4 v[88:91], v2, s[24:27], s59 offen sc1
    s_waitcnt vmcnt(13)
    v_mfma_f32_32x32x16_bf16 v[48:63], v[144:147], v[92:95], v[48:63]
    v_mfma_f32_32x32x16_bf16 v[64:79], v[148:151], v[92:95], v[64:79]
    s_waitcnt vmcnt(12)
    v_mfma_f32_32x32x16_bf16 v[16:31], v[152:155], v[96:99], v[16:31]
    v_mfma_f32_32x32x16_bf16 v[32:47], v[156:159], v[96:99], v[32:47]
    s_waitcnt vmcnt(11)
    v_mfma_f32_32x32x16_bf16 v[48:63], v[152:155], v[100:103], v[48:63]
    v_mfma_f32_32x32x16_bf16 v[64:79], v[156:159], v[100:103], v[64:79]
    s_waitcnt vmcnt(10)
    s_mov_b32 s73, 0
L_pb:
    s_mov_b64 exec, 15
    v_cmp_ne_u32 vcc, 1, v132
    s_mov_b64 exec, -1
    s_nop 4
    s_cbranch_vccz L_pb_ok
    s_mov_b64 exec, 15
    buffer_load_dword v132, v3, s[24:27], s72 offen sc1
    s_mov_b64 exec, -1
    s_add_u32 s73, s73, 1
    s_waitcnt vmcnt(0)
    s_cmp_lt_u32 s73, 20000
    s_cbranch_scc1 L_pb
L_pb_ok:
    buffer_load_dwordx4 v[92:95], v1, s[24:27], s60 offen sc1
    buffer_load_dwordx4 v[96:99], v1, s[24:27], s61 offen sc1
    buffer_load_dwordx4 v[100:103], v1, s[24:27], s62 offen sc1
    s_waitcnt vmcnt(12)
    v_mfma_f32_32x32x16_bf16 v[16:31], v[160:163], v[104:107], v[16:31]
    v_mfma_f32_32x32x16_bf16 v[32:47], v[164:167], v[104:107], v[32:47]
    buffer_load_dwordx4 v[104:107], v1, s[24:27], s63 offen sc1
    s_waitcnt vmcnt(12)
    v_mfma_f32_32x32x16_bf16 v[48:63], v[160:163], v[108:111], v[48:63]
    v_mfma_f32_32x32x16_bf16 v[64:79], v[164:167], v[108:111], v[64:79]
    buffer_load_dwordx4 v[108:111], v1, s[24:27], s64 offen sc1
    s_waitcnt vmcnt(12)
    v_mfma_f32_32x32x16_bf16 v[16:31], v[168:171], v[112:115], v[16:31]
    v_mfma_f32_32x32x16_bf16 v[32:47], v[172:175], v[112:115], v[32:47]
    buffer_load_dwordx4 v[112:115], v1, s[24:27], s65 offen sc1
    s_waitcnt vmcnt(12)
    v_mfma_f32_32x32x16_bf16 v[48:63], v[168:171], v[116:119], v[48:63]
    v_mfma_f32_32x32x16_bf16 v[64:79], v[172:175], v[116:119], v[64:79]
    buffer_load_dwordx4 v[116:119], v1, s[24:27], s66 offen sc1
    s_waitcnt vmcnt(12)
    v_mfma_f32_32x32x16_bf16 v[16:31], v[176:179], v[120:123], v[16:31]
    v_mfma_f32_32x32x16_bf16 v[32:47], v[180:183], v[120:123], v[32:47]
    buffer_load_dwordx4 v[120:123], v2, s[24:27], s60 offen sc1
    s_waitcnt vmcnt(12)
    v_mfma_f32_32x32x16_bf16 v[48:63], v[176:179], v[124:127], v[48:63]
    v_mfma_f32_32x32x16_bf16 v[64:79], v[180:183], v[124:127], v[64:79]
    buffer_load_dwordx4 v[124:127], v2, s[24:27], s61 offen sc1
    s_waitcnt vmcnt(12)
    v_mfma_f32_32x32x16_bf16 v[16:31], v[184:187], v[128:131], v[16:31]
    v_mfma_f32_32x32x16_bf16 v[32:47], v[188:191], v[128:131], v[32:47]
    buffer_load_dwordx4 v[128:131], v2, s[24:27], s62 offen sc1
    s_waitcnt vmcnt(12)
    v_mfma_f32_32x32x16_bf16 v[48:63], v[184:187], v[80:83], v[48:63]
    v_mfma_f32_32x32x16_bf16 v[64:79], v[188:191], v[80:83], v[64:79]
    buffer_load_dwordx4 v[80:83], v2, s[24:27], s63 offen sc1
    s_waitcnt vmcnt(12)
    v_mfma_f32_32x32x16_bf16 v[16:31], v[192:195], v[84:87], v[16:31]
    v_mfma_f32_32x32x16_bf16 v[32:47], v[196:199], v[84:87], v[32:47]
    buffer_load_dwordx4 v[84:87], v2, s[24:27], s64 offen sc1
    s_waitcnt vmcnt(12)
    v_mfma_f32_32x32x16_bf16 v[48:63], v[192:195], v[88:91], v[48:63]
    v_mfma_f32_32x32x16_bf16 v[64:79], v[196:199], v[88:91], v[64:79]
    buffer_load_dwordx4 v[88:91], v2, s[24:27], s65 offen sc1
    s_waitcnt vmcnt(12)
    v_mfma_f32_32x32x16_bf16 v[16:31], v[200:203], v[92:95], v[16:31]
    v_mfma_f32_32x32x16_bf16 v[32:47], v[204:207], v[92:95], v[32:47]
    buffer_load_dwordx4 v[92:95], v2, s[24:27], s66 offen sc1
    s_waitcnt vmcnt(12)
    v_mfma_f32_32x32x16_bf16 v[16:31], v[208:211], v[96:99], v[16:31]
    v_mfma_f32_32x32x16_bf16 v[32:47], v[212:215], v[96:99], v[32:47]
    s_waitcnt vmcnt(11)
    v_mfma_f32_32x32x16_bf16 v[16:31], v[216:219], v[100:103], v[16:31]
    v_mfma_f32_32x32x16_bf16 v[32:47], v[220:223], v[100:103], v[32:47]
    s_waitcnt vmcnt(10)
    v_mfma_f32_32x32x16_bf16 v[16:31], v[224:227], v[104:107], v[16:31]
    v_mfma_f32_32x32x16_bf16 v[32:47], v[228:231], v[104:107], v[32:47]
    s_waitcnt vmcnt(9)
    v_mfma_f32_32x32x16_bf16 v[16:31], v[232:235], v[108:111], v[16:31]
    v_mfma_f32_32x32x16_bf16 v[32:47], v[236:239], v[108:111], v[32:47]
    s_waitcnt vmcnt(8)
    v_mfma_f32_32x32x16_bf16 v[16:31], v[240:243], v[112:115], v[16:31]
    v_mfma_f32_32x32x16_bf16 v[32:47], v[244:247], v[112:115], v[32:47]
    s_waitcnt vmcnt(7)
    v_mfma_f32_32x32x16_bf16 v[16:31], v[248:251], v[116:119], v[16:31]
    v_mfma_f32_32x32x16_bf16 v[32:47], v[252:255], v[116:119], v[32:47]
    s_waitcnt vmcnt(6)
    v_mfma_f32_32x32x16_bf16 v[48:63], v[200:203], v[120:123], v[48:63]
    v_mfma_f32_32x32x16_bf16 v[64:79], v[204:207], v[120:123], v[64:79]
    v_mov_b32 v140, 163664
    s_mov_b32 s73, 0
L_pw:
    ds_read_b128 v[136:139], v140
    s_add_u32 s73, s73, 1
    s_waitcnt lgkmcnt(0)
    v_and_b32 v136, v136, v137
    v_and_b32 v138, v138, v139
    v_and_b32 v136, v136, v138
    s_nop 0
    v_readfirstlane_b32 s7, v136
    s_nop 1
    s_cmp_eq_u32 s7, 1
    s_cbranch_scc1 L_pw_ok
    s_sleep 2
    s_cmp_lt_u32 s73, 100000
    s_cbranch_scc1 L_pw
L_pw_ok:
    v_xor_b32 v136, 0, v133
    ds_write_b128 v136, v[16:19]
    v_xor_b32 v137, 32, v133
    ds_write_b128 v137, v[20:23]
    v_xor_b32 v138, 64, v133
    ds_write_b128 v138, v[24:27]
    v_xor_b32 v139, 96, v133
    ds_write_b128 v139, v[28:31]
    v_xor_b32 v136, 128, v133
    ds_write_b128 v136, v[32:35]
    v_xor_b32 v137, 160, v133
    ds_write_b128 v137, v[36:39]
    v_xor_b32 v138, 192, v133
    ds_write_b128 v138, v[40:43]
    v_xor_b32 v139, 224, v133
    ds_write_b128 v139, v[44:47]
    s_lshl_b32 s7, s3, 2
    s_add_u32 s7, s7, 163680
    v_mov_b32 v140, s7
    v_mov_b32_e64 v141, 1
    ds_write_b32 v140, v141
    s_waitcnt vmcnt(5)
    v_mfma_f32_32x32x16_bf16 v[48:63], v[208:211], v[124:127], v[48:63]
    v_mfma_f32_32x32x16_bf16 v[64:79], v[212:215], v[124:127], v[64:79]
    s_waitcnt vmcnt(4)
    v_mfma_f32_32x32x16_bf16 v[48:63], v[216:219], v[128:131], v[48:63]
    v_mfma_f32_32x32x16_bf16 v[64:79], v[220:223], v[128:131], v[64:79]
    s_waitcnt vmcnt(3)
    v_mfma_f32_32x32x16_bf16 v[48:63], v[224:227], v[80:83], v[48:63]
    v_mfma_f32_32x32x16_bf16 v[64:79], v[228:231], v[80:83], v[64:79]
    s_waitcnt vmcnt(2)
    v_mfma_f32_32x32x16_bf16 v[48:63], v[232:235], v[84:87], v[48:63]
    v_mfma_f32_32x32x16_bf16 v[64:79], v[236:239], v[84:87], v[64:79]
    s_waitcnt vmcnt(1)
    v_mfma_f32_32x32x16_bf16 v[48:63], v[240:243], v[88:91], v[48:63]
    v_mfma_f32_32x32x16_bf16 v[64:79], v[244:247], v[88:91], v[64:79]
    s_waitcnt vmcnt(0)
    v_mfma_f32_32x32x16_bf16 v[48:63], v[248:251], v[92:95], v[48:63]
    v_mfma_f32_32x32x16_bf16 v[64:79], v[252:255], v[92:95], v[64:79]
    v_xor_b32 v144, 65536, v133
    s_nop 7
    s_nop 1
    ds_write_b128 v144, v[48:51]
    v_xor_b32 v145, 65568, v133
    ds_write_b128 v145, v[52:55]
    v_xor_b32 v146, 65600, v133
    ds_write_b128 v146, v[56:59]
    v_xor_b32 v147, 65632, v133
    ds_write_b128 v147, v[60:63]
    v_xor_b32 v144, 65664, v133
    ds_write_b128 v144, v[64:67]
    v_xor_b32 v145, 65696, v133
    ds_write_b128 v145, v[68:71]
    v_xor_b32 v146, 65728, v133
    ds_write_b128 v146, v[72:75]
    v_xor_b32 v147, 65760, v133
    ds_write_b128 v147, v[76:79]
    s_cmp_lt_u32 s3, 4
    s_cbranch_scc1 L_own
    s_waitcnt lgkmcnt(0)
    s_barrier
    s_branch L_end
L_own:
    ds_write_b32 v140, v141 offset:32
    s_mov_b32 s70, 32768
    buffer_load_dwordx4 v[84:87], v6, s[8:11], s70 offen
    v_lshlrev_b32 v112, 16, v8
    v_and_b32 v113, s77, v8
    v_lshlrev_b32 v120, 16, v12
    v_and_b32 v121, s77, v12
    v_lshlrev_b32 v114, 16, v9
    v_and_b32 v115, s77, v9
    v_lshlrev_b32 v122, 16, v13
    v_and_b32 v123, s77, v13
    v_lshlrev_b32 v116, 16, v10
    v_and_b32 v117, s77, v10
    v_lshlrev_b32 v124, 16, v14
    v_and_b32 v125, s77, v14
    v_lshlrev_b32 v118, 16, v11
    v_and_b32 v119, s77, v11
    v_lshlrev_b32 v126, 16, v15
    v_and_b32 v127, s77, v15
    v_add_f32 v112, v112, v120
    v_add_f32 v113, v113, v121
    v_add_f32 v114, v114, v122
    v_add_f32 v115, v115, v123
    v_add_f32 v116, v116, v124
    v_add_f32 v117, v117, v125
    v_add_f32 v118, v118, v126
    v_add_f32 v119, v119, v127
    v_add_u32 v134, 0x10000, v4
    v_add_u32 v135, 0x10000, v5
    v_mov_b32 v142, 163680
    s_mov_b32 s73, 0
L_sc:
    ds_read_b128 v[136:139], v142 offset:32
    s_add_u32 s73, s73, 1
    s_waitcnt lgkmcnt(0)
    v_and_b32 v136, v136, v137
    v_and_b32 v138, v138, v139
    v_and_b32 v136, v136, v138
    s_nop 0
    v_readfirstlane_b32 s7, v136
    s_nop 1
    s_cmp_eq_u32 s7, 1
    s_cbranch_scc1 L_sc_ok
    s_sleep 1
    s_cmp_lt_u32 s73, 100000
    s_cbranch_scc1 L_sc
L_sc_ok:
    ds_read_b128 v[152:155], v4 offset:0
    ds_read_b128 v[156:159], v5 offset:0
    ds_read_b128 v[160:163], v4 offset:2048
    ds_read_b128 v[164:167], v5 offset:2048
    ds_read_b128 v[168:171], v4 offset:4096
    ds_read_b128 v[172:175], v5 offset:4096
    ds_read_b128 v[176:179], v4 offset:6144
    ds_read_b128 v[180:183], v5 offset:6144
    ds_read_b128 v[184:187], v134 offset:0
    ds_read_b128 v[188:191], v135 offset:0
    ds_read_b128 v[192:195], v134 offset:2048
    ds_read_b128 v[196:199], v135 offset:2048
    ds_read_b128 v[200:203], v134 offset:4096
    ds_read_b128 v[204:207], v135 offset:4096
    s_waitcnt lgkmcnt(12)
    ds_read_b128 v[208:211], v134 offset:6144
    ds_read_b128 v[212:215], v135 offset:6144
    s_waitcnt lgkmcnt(14)
    v_add_f32 v112, v112, v152
    v_add_f32 v113, v113, v153
    v_add_f32 v114, v114, v154
    v_add_f32 v115, v115, v155
    v_add_f32 v116, v116, v156
    v_add_f32 v117, v117, v157
    v_add_f32 v118, v118, v158
    v_add_f32 v119, v119, v159
    s_waitcnt lgkmcnt(12)
    v_add_f32 v112, v112, v160
    v_add_f32 v113, v113, v161
    v_add_f32 v114, v114, v162
    v_add_f32 v115, v115, v163
    v_add_f32 v116, v116, v164
    v_add_f32 v117, v117, v165
    v_add_f32 v118, v118, v166
    v_add_f32 v119, v119, v167
    s_waitcnt lgkmcnt(10)
    v_add_f32 v112, v112, v168
    v_add_f32 v113, v113, v169
    v_add_f32 v114, v114, v170
    v_add_f32 v115, v115, v171
    v_add_f32 v116, v116, v172
    v_add_f32 v117, v117, v173
    v_add_f32 v118, v118, v174
    v_add_f32 v119, v119, v175
    s_waitcnt lgkmcnt(8)
    v_add_f32 v112, v112, v176
    v_add_f32 v113, v113, v177
    v_add_f32 v114, v114, v178
    v_add_f32 v115, v115, v179
    v_add_f32 v116, v116, v180
    v_add_f32 v117, v117, v181
    v_add_f32 v118, v118, v182
    v_add_f32 v119, v119, v183
    s_waitcnt vmcnt(0)
    v_lshlrev_b32 v96, 16, v84
    v_and_b32 v97, s77, v84
    v_lshlrev_b32 v98, 16, v85
    v_and_b32 v99, s77, v85
    v_lshlrev_b32 v100, 16, v86
    v_and_b32 v101, s77, v86
    v_lshlrev_b32 v102, 16, v87
    v_and_b32 v103, s77, v87
    v_add_f32 v96, v96, v120
    v_add_f32 v97, v97, v121
    v_add_f32 v98, v98, v122
    v_add_f32 v99, v99, v123
    v_add_f32 v100, v100, v124
    v_add_f32 v101, v101, v125
    v_add_f32 v102, v102, v126
    v_add_f32 v103, v103, v127
    s_waitcnt lgkmcnt(6)
    v_add_f32 v96, v96, v184
    v_add_f32 v97, v97, v185
    v_add_f32 v98, v98, v186
    v_add_f32 v99, v99, v187
    v_add_f32 v100, v100, v188
    v_add_f32 v101, v101, v189
    v_add_f32 v102, v102, v190
    v_add_f32 v103, v103, v191
    s_waitcnt lgkmcnt(4)
    v_add_f32 v96, v96, v192
    v_add_f32 v97, v97, v193
    v_add_f32 v98, v98, v194
    v_add_f32 v99, v99, v195
    v_add_f32 v100, v100, v196
    v_add_f32 v101, v101, v197
    v_add_f32 v102, v102, v198
    v_add_f32 v103, v103, v199
    s_waitcnt lgkmcnt(2)
    v_add_f32 v96, v96, v200
    v_add_f32 v97, v97, v201
    v_add_f32 v98, v98, v202
    v_add_f32 v99, v99, v203
    v_add_f32 v100, v100, v204
    v_add_f32 v101, v101, v205
    v_add_f32 v102, v102, v206
    v_add_f32 v103, v103, v207
    s_waitcnt lgkmcnt(0)
    v_add_f32 v96, v96, v208
    v_add_f32 v97, v97, v209
    v_add_f32 v98, v98, v210
    v_add_f32 v99, v99, v211
    v_add_f32 v100, v100, v212
    v_add_f32 v101, v101, v213
    v_add_f32 v102, v102, v214
    v_add_f32 v103, v103, v215
    s_mov_b32 s73, 0
L_sl:
    ds_read_b128 v[136:139], v142 offset:16
    s_add_u32 s73, s73, 1
    s_waitcnt lgkmcnt(0)
    v_and_b32 v136, v136, v137
    v_and_b32 v138, v138, v139
    v_and_b32 v136, v136, v138
    s_nop 0
    v_readfirstlane_b32 s7, v136
    s_nop 1
    s_cmp_eq_u32 s7, 1
    s_cbranch_scc1 L_sl_ok
    s_sleep 1
    s_cmp_lt_u32 s73, 100000
    s_cbranch_scc1 L_sl
L_sl_ok:
    ds_read_b128 v[152:155], v4 offset:8192
    ds_read_b128 v[156:159], v5 offset:8192
    ds_read_b128 v[160:163], v4 offset:10240
    ds_read_b128 v[164:167], v5 offset:10240
    ds_read_b128 v[168:171], v4 offset:12288
    ds_read_b128 v[172:175], v5 offset:12288
    ds_read_b128 v[176:179], v4 offset:14336
    ds_read_b128 v[180:183], v5 offset:14336
    s_waitcnt lgkmcnt(6)
    v_add_f32 v112, v112, v152
    v_add_f32 v113, v113, v153
    v_add_f32 v114, v114, v154
    v_add_f32 v115, v115, v155
    v_add_f32 v116, v116, v156
    v_add_f32 v117, v117, v157
    v_add_f32 v118, v118, v158
    v_add_f32 v119, v119, v159
    s_waitcnt lgkmcnt(4)
    v_add_f32 v112, v112, v160
    v_add_f32 v113, v113, v161
    v_add_f32 v114, v114, v162
    v_add_f32 v115, v115, v163
    v_add_f32 v116, v116, v164
    v_add_f32 v117, v117, v165
    v_add_f32 v118, v118, v166
    v_add_f32 v119, v119, v167
    s_waitcnt lgkmcnt(2)
    v_add_f32 v112, v112, v168
    v_add_f32 v113, v113, v169
    v_add_f32 v114, v114, v170
    v_add_f32 v115, v115, v171
    v_add_f32 v116, v116, v172
    v_add_f32 v117, v117, v173
    v_add_f32 v118, v118, v174
    v_add_f32 v119, v119, v175
    s_waitcnt lgkmcnt(0)
    v_add_f32 v112, v112, v176
    v_add_f32 v113, v113, v177
    v_add_f32 v114, v114, v178
    v_add_f32 v115, v115, v179
    v_add_f32 v116, v116, v180
    v_add_f32 v117, v117, v181
    v_add_f32 v118, v118, v182
    v_add_f32_e64 v119, v119, v183
    v_cvt_pk_bf16_f32 v104, v112, v113
    v_cvt_pk_bf16_f32 v105, v114, v115
    v_cvt_pk_bf16_f32 v106, v116, v117
    v_cvt_pk_bf16_f32 v107, v118, v119
    buffer_store_dwordx4 v[104:107], v6, s[28:31], 0 offen sc1
    s_barrier
    ds_read_b128 v[184:187], v134 offset:8192
    ds_read_b128 v[188:191], v135 offset:8192
    ds_read_b128 v[192:195], v134 offset:10240
    ds_read_b128 v[196:199], v135 offset:10240
    ds_read_b128 v[200:203], v134 offset:12288
    ds_read_b128 v[204:207], v135 offset:12288
    ds_read_b128 v[208:211], v134 offset:14336
    ds_read_b128 v[212:215], v135 offset:14336
    s_waitcnt lgkmcnt(6)
    v_pk_add_f32 v[96:97], v[96:97], v[184:185]
    v_pk_add_f32 v[98:99], v[98:99], v[186:187]
    v_pk_add_f32 v[100:101], v[100:101], v[188:189]
    v_pk_add_f32 v[102:103], v[102:103], v[190:191]
    s_waitcnt lgkmcnt(4)
    v_pk_add_f32 v[96:97], v[96:97], v[192:193]
    v_pk_add_f32 v[98:99], v[98:99], v[194:195]
    v_pk_add_f32 v[100:101], v[100:101], v[196:197]
    v_pk_add_f32 v[102:103], v[102:103], v[198:199]
    s_waitcnt lgkmcnt(2)
    v_pk_add_f32 v[96:97], v[96:97], v[200:201]
    v_pk_add_f32 v[98:99], v[98:99], v[202:203]
    v_pk_add_f32 v[100:101], v[100:101], v[204:205]
    v_pk_add_f32 v[102:103], v[102:103], v[206:207]
    s_waitcnt lgkmcnt(0)
    s_nop 0
    v_pk_add_f32 v[96:97], v[96:97], v[208:209]
    v_pk_add_f32 v[98:99], v[98:99], v[210:211]
    v_pk_add_f32 v[100:101], v[100:101], v[212:213]
    v_pk_add_f32 v[102:103], v[102:103], v[214:215]
    v_cvt_pk_bf16_f32 v108, v96, v97
    v_cvt_pk_bf16_f32 v109, v98, v99
    v_cvt_pk_bf16_f32 v110, v100, v101
    v_cvt_pk_bf16_f32 v111, v102, v103
    buffer_store_dwordx4 v[108:111], v6, s[28:31], s70 offen sc1
L_end:
    s_endpgm
L_A:
    v_lshrrev_b32 v1, 6, v0
    v_and_b32 v0, 63, v0
    v_readfirstlane_b32 s3, v1
    s_mov_b32 s10, 2097152
    s_mov_b32 s11, 0x20000
    s_mov_b32 s14, 1572864
    s_mov_b32 s15, 0x20000
    s_mov_b32 s46, 1409024
    s_mov_b32 s47, 0x20000
    s_mov_b32 s26, 268435456
    s_mov_b32 s27, 0x20000
    s_mov_b32 s42, 256
    s_mov_b32 s43, 0x20000
    s_mov_b32 s18, 524288
    s_mov_b32 s19, 0x20000
    s_mov_b32 s22, 1409024
    s_mov_b32 s23, 0x20000
    s_mov_b32 s30, 2097152
    s_mov_b32 s31, 0x20000
    s_mov_b32 s34, 2752
    s_mov_b32 s35, 0x20000
    s_mov_b32 s38, 1024
    s_mov_b32 s39, 0x20000
    s_and_b32 s7, s2, 7
    s_lshr_b32 s70, s2, 3
    s_lshr_b32 s100, s7, 1
    s_lshl_b32 s4, s100, 2
    s_and_b32 s71, s70, 3
    s_add_u32 s4, s4, s71
    s_lshr_b32 s5, s70, 2
    s_and_b32 s5, s7, 1
    s_lshl_b32 s5, s5, 2
    s_lshr_b32 s76, s70, 3
    s_add_u32 s5, s5, s76
    s_add_u32 s6, s71, s5
    s_and_b32 s6, s6, 3
    s_lshl_b32 s67, s7, 1
    s_lshr_b32 s71, s70, 4
    s_add_u32 s67, s67, s71
    s_lshr_b32 s68, s70, 3
    s_and_b32 s68, s68, 1
    s_and_b32 s69, s70, 7
    s_lshr_b32 s76, s70, 3
    s_lshl_b32 s76, s76, 2
    s_lshl_b32 s71, s69, 1
    s_add_u32 s76, s76, s71
    s_and_b32 s48, s3, 3
    s_lshl_b32 s49, s48, 10
    s_mov_b32 s77, 0xffff0000
    s_bfe_u32 s7, s70, 0x10002
    s_cmp_lg_u32 s5, 0
    s_cbranch_scc1 L_nolead_15
    s_cmp_lg_u32 s3, 3
    s_cbranch_scc1 L_nolead_15
    s_lshl_b32 s7, s4, 14
    s_add_u32 s7, s7, 8388608
    v_lshl_add_u32 v16, v0, 4, s7
    s_lshl_b32 s7, s4, 10
    s_add_u32 s7, s7, 9437184
    v_lshl_add_u32 v17, v0, 4, s7
    s_lshl_b32 s7, s4, 4
    v_mov_b32 v18, s7
    v_mov_b32 v19, 1
    v_mov_b32 v20, 0
    v_mov_b32 v21, 0
    v_mov_b32 v22, 0
    v_mov_b32 v23, 0
    s_waitcnt lgkmcnt(0)
    buffer_store_dwordx4 v[20:23], v17, s[24:27], 0 offen sc1
    buffer_load_dword v24, v18, s[40:43], 0 offen sc1
    s_mov_b32 s7, 0
    buffer_store_dwordx4 v[20:23], v16, s[24:27], s7 offen sc1
    s_mov_b32 s7, 1024
    buffer_store_dwordx4 v[20:23], v16, s[24:27], s7 offen sc1
    s_mov_b32 s7, 2048
    buffer_store_dwordx4 v[20:23], v16, s[24:27], s7 offen sc1
    s_mov_b32 s7, 3072
    buffer_store_dwordx4 v[20:23], v16, s[24:27], s7 offen sc1
    s_mov_b32 s7, 4096
    buffer_store_dwordx4 v[20:23], v16, s[24:27], s7 offen sc1
    s_mov_b32 s7, 8192
    buffer_store_dwordx4 v[20:23], v16, s[24:27], s7 offen sc1
    s_mov_b32 s7, 9216
    buffer_store_dwordx4 v[20:23], v16, s[24:27], s7 offen sc1
    s_mov_b32 s7, 10240
    buffer_store_dwordx4 v[20:23], v16, s[24:27], s7 offen sc1
    s_mov_b32 s7, 11264
    buffer_store_dwordx4 v[20:23], v16, s[24:27], s7 offen sc1
    s_mov_b32 s7, 12288
    buffer_store_dwordx4 v[20:23], v16, s[24:27], s7 offen sc1
L_nolead_15:
    s_cmp_lt_u32 s3, 4
    s_cbranch_scc1 L_catt
    v_lshrrev_b32 v24, 3, v0
    v_and_b32 v25, 7, v0
    v_lshrrev_b32 v26, 1, v24
    s_and_b32 s71, s48, 1
    s_lshl_b32 s72, s71, 2
    v_or_b32 v27, s72, v26
    v_xor_b32 v27, v27, v25
    v_lshlrev_b32 v27, 4, v27
    s_lshl_b32 s74, s4, 7
    s_lshl_b32 s70, s48, 3
    s_add_u32 s70, s74, s70
    v_add_u32 v28, s70, v24
    v_lshl_add_u32 v1, v28, 10, v27
    s_lshr_b32 s70, s48, 1
    s_lshl_b32 s70, s70, 4
    s_add_u32 s70, s70, s72
    v_and_b32 v28, 3, v24
    v_lshrrev_b32 v29, 2, v24
    v_lshl_add_u32 v28, v29, 3, v28
    v_add_u32 v28, s70, v28
    v_lshrrev_b32 v29, 1, v25
    v_xor_b32 v29, v29, v26
    v_lshlrev_b32 v29, 5, v29
    v_and_b32 v30, 1, v25
    v_lshl_add_u32 v29, v30, 4, v29
    s_lshl_b32 s70, s5, 7
    v_mul_u32_u24 v28, 3072, v28
    v_add_u32 v28, v28, v29
    v_add_u32 v2, s70, v28
    s_lshl_b32 s70, s48, 2
    s_add_u32 s70, s70, s74
    s_sub_u32 s70, s70, 16
    v_add_u32 v30, s70, v24
    s_lshl_b32 s71, s48, 1
    v_add_u32 v31, s71, v26
    v_xor_b32 v31, v31, v25
    v_lshlrev_b32 v31, 4, v31
    v_lshl_add_u32 v3, v30, 10, v31
    s_cmp_eq_u32 s48, 0
    s_cselect_b32 s50, s77, -1
    s_mov_b32 s51, 0
    s_lshl_b32 s100, s5, 3
    s_add_u32 s100, s100, s74
    s_lshl_b32 s70, s48, 1
    s_add_u32 s100, s100, s70
    s_lshl_b32 s70, s100, 10
    v_lshl_add_u32 v5, v0, 4, s70
    v_lshrrev_b32 v34, 5, v0
    v_add_u32 v34, s100, v34
    v_lshlrev_b32 v34, 3, v34
    v_add_u32 v34, 9437184, v34
    s_lshl_b32 s70, s48, 5
    s_add_u32 s70, s70, s74
    s_sub_u32 s71, s74, 48
    v_add_u32 v35, s70, v0
    v_add_u32 v30, s71, v0
    v_cmp_lt_u32 vcc, 31, v0
    s_nop 1
    v_cndmask_b32 v35, v35, v30, vcc
    v_lshlrev_b32 v35, 3, v35
    v_add_u32 v35, 9437184, v35
    s_waitcnt lgkmcnt(0)
    s_xor_b32 s72, s6, 0
    s_and_b32 s72, s72, 7
    s_lshl_b32 s74, s72, 7
    s_mul_i32 s75, s72, 196608
    s_add_u32 m0, s49, 2048
    s_add_u32 s0, s74, 0
    buffer_load_dwordx4 v1, s[8:11], s0 offen lds
    s_add_u32 m0, s49, 55296
    s_nop 0
    buffer_load_dwordx4 v2, s[12:15], s75 offen offset:0 lds
    s_add_u32 m0, s49, 62464
    s_nop 0
    buffer_load_dwordx4 v2, s[12:15], s75 offen offset:1024 lds
    s_add_u32 m0, s49, 6144
    s_add_u32 s0, s74, 32768
    buffer_load_dwordx4 v1, s[8:11], s0 offen lds
    s_add_u32 m0, s49, 69632
    s_nop 0
    buffer_load_dwordx4 v2, s[12:15], s75 offen offset:2048 lds
    s_lshr_b32 s0, s49, 1
    s_add_u32 m0, s0, 0
    s_mov_b64 exec, s[50:51]
    buffer_load_dwordx4 v3, s[8:11], s74 offen lds
    s_mov_b64 exec, -1
    s_add_u32 m0, s49, 10240
    s_add_u32 s0, s74, 65536
    buffer_load_dwordx4 v1, s[8:11], s0 offen lds
    s_add_u32 m0, s49, 59392
    s_add_u32 s1, s75, 98304
    buffer_load_dwordx4 v2, s[12:15], s1 offen offset:0 lds
    s_add_u32 m0, s49, 66560
    s_add_u32 s1, s75, 98304
    buffer_load_dwordx4 v2, s[12:15], s1 offen offset:1024 lds
    s_add_u32 m0, s49, 14336
    s_add_u32 s0, s74, 98304
    buffer_load_dwordx4 v1, s[8:11], s0 offen lds
    s_add_u32 m0, s49, 73728
    s_add_u32 s1, s75, 98304
    buffer_load_dwordx4 v2, s[12:15], s1 offen offset:2048 lds
    buffer_load_dwordx4 v[16:19], v5, s[8:11], 0 offen offset:0
    buffer_load_dwordx4 v[20:23], v5, s[8:11], 0 offen offset:1024
    s_xor_b32 s72, s6, 1
    s_and_b32 s72, s72, 7
    s_lshl_b32 s74, s72, 7
    s_mul_i32 s75, s72, 196608
    s_add_u32 m0, s49, 20480
    s_add_u32 s0, s74, 0
    buffer_load_dwordx4 v1, s[8:11], s0 offen lds
    s_add_u32 m0, s49, 79872
    s_nop 0
    buffer_load_dwordx4 v2, s[12:15], s75 offen offset:0 lds
    s_add_u32 m0, s49, 87040
    s_nop 0
    buffer_load_dwordx4 v2, s[12:15], s75 offen offset:1024 lds
    s_add_u32 m0, s49, 24576
    s_add_u32 s0, s74, 32768
    buffer_load_dwordx4 v1, s[8:11], s0 offen lds
    s_add_u32 m0, s49, 94208
    s_nop 0
    buffer_load_dwordx4 v2, s[12:15], s75 offen offset:2048 lds
    s_waitcnt vmcnt(7)
    s_waitcnt lgkmcnt(0)
    s_barrier
    s_lshr_b32 s0, s49, 1
    s_add_u32 m0, s0, 18432
    s_mov_b64 exec, s[50:51]
    buffer_load_dwordx4 v3, s[8:11], s74 offen lds
    s_mov_b64 exec, -1
    s_add_u32 m0, s49, 28672
    s_add_u32 s0, s74, 65536
    buffer_load_dwordx4 v1, s[8:11], s0 offen lds
    s_add_u32 m0, s49, 83968
    s_add_u32 s1, s75, 98304
    buffer_load_dwordx4 v2, s[12:15], s1 offen offset:0 lds
    s_add_u32 m0, s49, 91136
    s_add_u32 s1, s75, 98304
    buffer_load_dwordx4 v2, s[12:15], s1 offen offset:1024 lds
    s_add_u32 m0, s49, 32768
    s_add_u32 s0, s74, 98304
    buffer_load_dwordx4 v1, s[8:11], s0 offen lds
    s_add_u32 m0, s49, 98304
    s_add_u32 s1, s75, 98304
    buffer_load_dwordx4 v2, s[12:15], s1 offen offset:2048 lds
    s_xor_b32 s72, s6, 2
    s_and_b32 s72, s72, 7
    s_lshl_b32 s74, s72, 7
    s_mul_i32 s75, s72, 196608
    s_add_u32 m0, s49, 38912
    s_add_u32 s0, s74, 0
    buffer_load_dwordx4 v1, s[8:11], s0 offen lds
    s_add_u32 m0, s49, 104448
    s_nop 0
    buffer_load_dwordx4 v2, s[12:15], s75 offen offset:0 lds
    s_add_u32 m0, s49, 111616
    s_nop 0
    buffer_load_dwordx4 v2, s[12:15], s75 offen offset:1024 lds
    s_add_u32 m0, s49, 43008
    s_add_u32 s0, s74, 32768
    buffer_load_dwordx4 v1, s[8:11], s0 offen lds
    s_add_u32 m0, s49, 118784
    s_nop 0
    buffer_load_dwordx4 v2, s[12:15], s75 offen offset:2048 lds
    s_waitcnt vmcnt(5)
    s_barrier
    s_lshr_b32 s0, s49, 1
    s_add_u32 m0, s0, 36864
    s_mov_b64 exec, s[50:51]
    buffer_load_dwordx4 v3, s[8:11], s74 offen lds
    s_mov_b64 exec, -1
    s_add_u32 m0, s49, 47104
    s_add_u32 s0, s74, 65536
    buffer_load_dwordx4 v1, s[8:11], s0 offen lds
    s_add_u32 m0, s49, 108544
    s_add_u32 s1, s75, 98304
    buffer_load_dwordx4 v2, s[12:15], s1 offen offset:0 lds
    s_add_u32 m0, s49, 115712
    s_add_u32 s1, s75, 98304
    buffer_load_dwordx4 v2, s[12:15], s1 offen offset:1024 lds
    s_add_u32 m0, s49, 51200
    s_add_u32 s0, s74, 98304
    buffer_load_dwordx4 v1, s[8:11], s0 offen lds
    s_add_u32 m0, s49, 122880
    s_add_u32 s1, s75, 98304
    buffer_load_dwordx4 v2, s[12:15], s1 offen offset:2048 lds
    v_and_b32 v33, 15, v0
    v_lshlrev_b32 v33, 4, v33
    s_xor_b32 s72, s6, 3
    s_and_b32 s72, s72, 7
    s_lshl_b32 s74, s72, 7
    s_mul_i32 s75, s72, 196608
    s_add_u32 m0, s49, 2048
    s_add_u32 s0, s74, 0
    buffer_load_dwordx4 v1, s[8:11], s0 offen lds
    s_add_u32 m0, s49, 55296
    s_nop 0
    buffer_load_dwordx4 v2, s[12:15], s75 offen offset:0 lds
    buffer_load_dword v32, v33, s[40:43], 0 offen sc1
    s_add_u32 m0, s49, 62464
    s_nop 0
    buffer_load_dwordx4 v2, s[12:15], s75 offen offset:1024 lds
    s_add_u32 m0, s49, 6144
    s_add_u32 s0, s74, 32768
    buffer_load_dwordx4 v1, s[8:11], s0 offen lds
    s_add_u32 m0, s49, 69632
    s_nop 0
    buffer_load_dwordx4 v2, s[12:15], s75 offen offset:2048 lds
    s_lshr_b32 s0, s49, 1
    s_add_u32 m0, s0, 0
    s_mov_b64 exec, s[50:51]
    buffer_load_dwordx4 v3, s[8:11], s74 offen lds
    s_mov_b64 exec, -1
    s_add_u32 m0, s49, 10240
    s_add_u32 s0, s74, 65536
    buffer_load_dwordx4 v1, s[8:11], s0 offen lds
    v_and_b32 v40, s77, v16
    v_lshlrev_b32 v41, 16, v16
    v_add_f32 v26, v40, v41
    v_mul_f32 v27, v40, v40
    v_fmac_f32 v27, v41, v41
    v_and_b32 v40, s77, v17
    v_lshlrev_b32 v41, 16, v17
    v_add_f32 v26, v26, v40
    v_fmac_f32 v27, v40, v40
    v_add_f32 v26, v26, v41
    v_fmac_f32 v27, v41, v41
    v_and_b32 v40, s77, v18
    v_lshlrev_b32 v41, 16, v18
    v_add_f32 v26, v26, v40
    v_fmac_f32 v27, v40, v40
    v_add_f32 v26, v26, v41
    v_fmac_f32 v27, v41, v41
    v_and_b32 v40, s77, v19
    v_lshlrev_b32 v41, 16, v19
    v_add_f32 v26, v26, v40
    v_fmac_f32 v27, v40, v40
    v_add_f32 v26, v26, v41
    v_fmac_f32 v27, v41, v41
    v_and_b32 v40, s77, v20
    v_lshlrev_b32 v41, 16, v20
    v_add_f32 v28, v40, v41
    v_mul_f32 v29, v40, v40
    v_fmac_f32 v29, v41, v41
    v_and_b32 v40, s77, v21
    v_lshlrev_b32 v41, 16, v21
    v_add_f32 v28, v28, v40
    v_fmac_f32 v29, v40, v40
    v_add_f32 v28, v28, v41
    v_fmac_f32 v29, v41, v41
    v_and_b32 v40, s77, v22
    v_lshlrev_b32 v41, 16, v22
    v_add_f32 v28, v28, v40
    v_fmac_f32 v29, v40, v40
    v_add_f32 v28, v28, v41
    s_waitcnt vmcnt(8)
    s_waitcnt lgkmcnt(0)
    s_barrier
    s_add_u32 m0, s49, 59392
    s_add_u32 s1, s75, 98304
    buffer_load_dwordx4 v2, s[12:15], s1 offen offset:0 lds
    s_add_u32 m0, s49, 66560
    s_add_u32 s1, s75, 98304
    buffer_load_dwordx4 v2, s[12:15], s1 offen offset:1024 lds
    s_add_u32 m0, s49, 14336
    s_add_u32 s0, s74, 98304
    buffer_load_dwordx4 v1, s[8:11], s0 offen lds
    s_add_u32 m0, s49, 73728
    s_add_u32 s1, s75, 98304
    buffer_load_dwordx4 v2, s[12:15], s1 offen offset:2048 lds
    s_xor_b32 s72, s6, 4
    s_and_b32 s72, s72, 7
    s_lshl_b32 s74, s72, 7
    s_mul_i32 s75, s72, 196608
    s_add_u32 m0, s49, 20480
    s_add_u32 s0, s74, 0
    buffer_load_dwordx4 v1, s[8:11], s0 offen lds
    s_add_u32 m0, s49, 79872
    s_nop 0
    buffer_load_dwordx4 v2, s[12:15], s75 offen offset:0 lds
    s_add_u32 m0, s49, 87040
    s_nop 0
    buffer_load_dwordx4 v2, s[12:15], s75 offen offset:1024 lds
    s_add_u32 m0, s49, 24576
    s_add_u32 s0, s74, 32768
    buffer_load_dwordx4 v1, s[8:11], s0 offen lds
    s_add_u32 m0, s49, 94208
    s_nop 0
    buffer_load_dwordx4 v2, s[12:15], s75 offen offset:2048 lds
    s_lshr_b32 s0, s49, 1
    s_add_u32 m0, s0, 18432
    s_mov_b64 exec, s[50:51]
    buffer_load_dwordx4 v3, s[8:11], s74 offen lds
    s_mov_b64 exec, -1
    s_add_u32 m0, s49, 28672
    s_add_u32 s0, s74, 65536
    buffer_load_dwordx4 v1, s[8:11], s0 offen lds
    v_fmac_f32 v29, v41, v41
    v_and_b32 v40, s77, v23
    v_lshlrev_b32 v41, 16, v23
    v_add_f32 v28, v28, v40
    v_fmac_f32 v29, v40, v40
    v_add_f32 v28, v28, v41
    v_fmac_f32 v29, v41, v41
    s_nop 0
    v_permlane32_swap_b32 v26, v28
    v_permlane32_swap_b32 v27, v29
    v_add_f32 v26, v26, v28
    v_add_f32 v27, v27, v29
    s_nop 1
    v_permlane16_swap_b32 v26, v27
    v_add_f32 v26, v26, v27
    s_nop 1
    v_add_f32_dpp v26, v26, v26 row_ror:8 row_mask:0xf bank_mask:0xf
    s_nop 1
    v_add_f32_dpp v26, v26, v26 row_ror:4 row_mask:0xf bank_mask:0xf
    s_nop 1
    v_add_f32_dpp v26, v26, v26 row_ror:2 row_mask:0xf bank_mask:0xf
    s_nop 1
    v_add_f32_dpp v26, v26, v26 row_ror:1 row_mask:0xf bank_mask:0xf
    v_mov_b32 v27, v26
    s_nop 1
    v_permlane16_swap_b32 v26, v27
    s_mov_b32 s71, 0x3b000000
    v_mul_f32 v26, s71, v26
    v_mul_f32 v40, v26, v26
    v_fma_f32 v27, v27, s71, -v40
    v_max_f32 v27, 0, v27
    v_add_f32 v27, 0x3727c5ac, v27
    v_rsq_f32 v27, v27
    s_nop 0
    v_mul_f32 v26, v26, v27
    v_sub_f32 v26, 0, v26
    v_xor_b32 v24, 0x80000000, v27
    v_mov_b32 v25, v26
    s_waitcnt vmcnt(7)
    s_waitcnt lgkmcnt(0)
    s_barrier
    s_add_u32 m0, s49, 83968
    s_add_u32 s1, s75, 98304
    buffer_load_dwordx4 v2, s[12:15], s1 offen offset:0 lds
    s_add_u32 m0, s49, 91136
    s_add_u32 s1, s75, 98304
    buffer_load_dwordx4 v2, s[12:15], s1 offen offset:1024 lds
    s_add_u32 m0, s49, 32768
    s_add_u32 s0, s74, 98304
    buffer_load_dwordx4 v1, s[8:11], s0 offen lds
    s_add_u32 m0, s49, 98304
    s_add_u32 s1, s75, 98304
    buffer_load_dwordx4 v2, s[12:15], s1 offen offset:2048 lds
    s_mov_b32 s70, 0
L_gate_17:
    v_cmp_ne_u32 vcc, 1, v32
    s_nop 1
    s_cmp_lg_u64 vcc, 0
    s_cbranch_scc0 L_gate_ok_18
    buffer_load_dword v32, v33, s[40:43], 0 offen sc1
    s_add_u32 s70, s70, 1
    s_waitcnt vmcnt(0)
    s_cmp_lt_u32 s70, 20000
    s_cbranch_scc1 L_gate_17
L_gate_ok_18:
    s_mov_b32 exec_lo, 1
    s_mov_b32 exec_hi, 1
    buffer_store_dwordx2 v[24:25], v34, s[24:27], 0 offen sc1
    s_mov_b64 exec, -1
    s_xor_b32 s72, s6, 5
    s_and_b32 s72, s72, 7
    s_lshl_b32 s74, s72, 7
    s_mul_i32 s75, s72, 196608
    s_add_u32 m0, s49, 38912
    s_add_u32 s0, s74, 0
    buffer_load_dwordx4 v1, s[8:11], s0 offen lds
    s_add_u32 m0, s49, 104448
    s_nop 0
    buffer_load_dwordx4 v2, s[12:15], s75 offen offset:0 lds
    s_add_u32 m0, s49, 111616
    s_nop 0
    buffer_load_dwordx4 v2, s[12:15], s75 offen offset:1024 lds
    s_add_u32 m0, s49, 43008
    s_add_u32 s0, s74, 32768
    buffer_load_dwordx4 v1, s[8:11], s0 offen lds
    s_add_u32 m0, s49, 118784
    s_nop 0
    buffer_load_dwordx4 v2, s[12:15], s75 offen offset:2048 lds
    s_lshr_b32 s0, s49, 1
    s_add_u32 m0, s0, 36864
    s_mov_b64 exec, s[50:51]
    buffer_load_dwordx4 v3, s[8:11], s74 offen lds
    s_mov_b64 exec, -1
    s_add_u32 m0, s49, 47104
    s_add_u32 s0, s74, 65536
    buffer_load_dwordx4 v1, s[8:11], s0 offen lds
    v_and_b32 v44, 15, v0
    v_lshrrev_b32 v45, 4, v0
    s_lshl_b32 s7, s48, 1
    s_add_u32 s7, s7, 1
    v_add_u32 v45, s7, v45
    v_lshlrev_b32 v45, 7, v45
    v_cmp_lt_u32 vcc, 31, v0
    s_nop 1
    v_cndmask_b32 v45, v45, 0, vcc
    v_lshl_add_u32 v45, v44, 2, v45
    v_add_u32 v38, 161792, v45
    v_lshrrev_b32 v44, 3, v0
    v_and_b32 v45, 7, v0
    v_and_b32 v46, 2, v44
    v_lshlrev_b32 v46, 1, v46
    v_xor_b32 v45, v45, v46
    v_lshlrev_b32 v45, 4, v45
    v_lshl_add_u32 v45, v44, 10, v45
    s_lshl_b32 s7, s69, 7
    v_add_u32 v4, s7, v45
    s_waitcnt vmcnt(8)
    s_waitcnt lgkmcnt(0)
    s_barrier
    s_add_u32 m0, s49, 108544
    s_add_u32 s1, s75, 98304
    buffer_load_dwordx4 v2, s[12:15], s1 offen offset:0 lds
    s_add_u32 m0, s49, 115712
    s_add_u32 s1, s75, 98304
    buffer_load_dwordx4 v2, s[12:15], s1 offen offset:1024 lds
    s_add_u32 m0, s49, 51200
    s_add_u32 s0, s74, 98304
    buffer_load_dwordx4 v1, s[8:11], s0 offen lds
    s_add_u32 m0, s49, 122880
    s_add_u32 s1, s75, 98304
    buffer_load_dwordx4 v2, s[12:15], s1 offen offset:2048 lds
    s_xor_b32 s72, s6, 6
    s_and_b32 s72, s72, 7
    s_lshl_b32 s74, s72, 7
    s_mul_i32 s75, s72, 196608
    s_add_u32 m0, s49, 2048
    s_add_u32 s0, s74, 0
    buffer_load_dwordx4 v1, s[8:11], s0 offen lds
    s_add_u32 m0, s49, 55296
    s_nop 0
    buffer_load_dwordx4 v2, s[12:15], s75 offen offset:0 lds
    s_add_u32 m0, s49, 62464
    s_nop 0
    buffer_load_dwordx4 v2, s[12:15], s75 offen offset:1024 lds
    s_add_u32 m0, s49, 6144
    s_add_u32 s0, s74, 32768
    buffer_load_dwordx4 v1, s[8:11], s0 offen lds
    s_add_u32 m0, s49, 69632
    s_nop 0
    buffer_load_dwordx4 v2, s[12:15], s75 offen offset:2048 lds
    s_lshr_b32 s0, s49, 1
    s_add_u32 m0, s0, 0
    s_mov_b64 exec, s[50:51]
    buffer_load_dwordx4 v3, s[8:11], s74 offen lds
    s_mov_b64 exec, -1
    s_add_u32 m0, s49, 10240
    s_add_u32 s0, s74, 65536
    buffer_load_dwordx4 v1, s[8:11], s0 offen lds
    v_lshrrev_b32 v44, 4, v0
    v_bfe_u32 v45, v0, 2, 2
    v_and_b32 v46, 3, v0
    v_and_b32 v47, 1, v44
    v_lshrrev_b32 v48, 1, v46
    v_lshl_add_u32 v47, v47, 1, v48
    v_lshrrev_b32 v48, 1, v45
    v_lshlrev_b32 v48, 2, v48
    v_xor_b32 v47, v47, v48
    v_lshlrev_b32 v47, 4, v47
    v_lshrrev_b32 v44, 1, v44
    v_lshl_add_u32 v47, v44, 10, v47
    v_lshl_add_u32 v47, v45, 7, v47
    v_and_b32 v48, 1, v46
    v_lshl_add_u32 v60, v48, 3, v47
    s_sub_u32 s7, 3, s48
    s_lshl_b32 s7, s7, 11
    s_add_u32 s73, s7, 129024
    v_add_u32 v60, s73, v60
    v_xor_b32 v61, 64, v60
    s_add_u32 s52, s76, 0
    s_and_b32 s52, s52, 7
    s_lshl_b32 s52, s52, 10
    s_add_u32 s53, s76, 1
    s_and_b32 s53, s53, 7
    s_lshl_b32 s53, s53, 10
    s_add_u32 s54, s76, 2
    s_and_b32 s54, s54, 7
    s_lshl_b32 s54, s54, 10
    s_add_u32 s55, s76, 3
    s_and_b32 s55, s55, 7
    s_lshl_b32 s55, s55, 10
    s_add_u32 s56, s76, 4
    s_and_b32 s56, s56, 7
    s_lshl_b32 s56, s56, 10
    s_add_u32 s57, s76, 5
    s_and_b32 s57, s57, 7
    s_lshl_b32 s57, s57, 10
    s_add_u32 s58, s76, 6
    s_and_b32 s58, s58, 7
    s_lshl_b32 s58, s58, 10
    s_add_u32 s59, s76, 7
    s_and_b32 s59, s59, 7
    s_lshl_b32 s59, s59, 10
    s_waitcnt vmcnt(7)
    s_waitcnt lgkmcnt(0)
    s_barrier
    s_add_u32 m0, s49, 59392
    s_add_u32 s1, s75, 98304
    buffer_load_dwordx4 v2, s[12:15], s1 offen offset:0 lds
    s_add_u32 m0, s49, 66560
    s_add_u32 s1, s75, 98304
    buffer_load_dwordx4 v2, s[12:15], s1 offen offset:1024 lds
    s_add_u32 m0, s49, 14336
    s_add_u32 s0, s74, 98304
    buffer_load_dwordx4 v1, s[8:11], s0 offen lds
    s_add_u32 m0, s49, 73728
    s_add_u32 s1, s75, 98304
    buffer_load_dwordx4 v2, s[12:15], s1 offen offset:2048 lds
    s_xor_b32 s72, s6, 7
    s_and_b32 s72, s72, 7
    s_lshl_b32 s74, s72, 7
    s_mul_i32 s75, s72, 196608
    s_add_u32 m0, s49, 20480
    s_add_u32 s0, s74, 0
    buffer_load_dwordx4 v1, s[8:11], s0 offen lds
    s_add_u32 m0, s49, 79872
    s_nop 0
    buffer_load_dwordx4 v2, s[12:15], s75 offen offset:0 lds
    s_add_u32 m0, s49, 87040
    s_nop 0
    buffer_load_dwordx4 v2, s[12:15], s75 offen offset:1024 lds
    s_add_u32 m0, s49, 24576
    s_add_u32 s0, s74, 32768
    buffer_load_dwordx4 v1, s[8:11], s0 offen lds
    s_add_u32 m0, s49, 94208
    s_nop 0
    buffer_load_dwordx4 v2, s[12:15], s75 offen offset:2048 lds
    s_lshr_b32 s0, s49, 1
    s_add_u32 m0, s0, 18432
    s_mov_b64 exec, s[50:51]
    buffer_load_dwordx4 v3, s[8:11], s74 offen lds
    s_mov_b64 exec, -1
    s_add_u32 m0, s49, 28672
    s_add_u32 s0, s74, 65536
    buffer_load_dwordx4 v1, s[8:11], s0 offen lds
    s_mov_b32 s100, s76
    s_sub_u32 s101, s100, 7
    s_min_u32 s100, s101, s100
    s_sub_u32 s101, s100, 7
    s_min_u32 s100, s101, s100
    s_sub_u32 s101, s100, 7
    s_min_u32 s100, s101, s100
    s_sub_u32 s101, s100, 7
    s_min_u32 s100, s101, s100
    s_add_u32 s60, s100, 0
    s_sub_u32 s101, s60, 7
    s_min_u32 s60, s101, s60
    s_add_u32 s60, s60, 8
    s_lshl_b32 s60, s60, 10
    s_add_u32 s61, s100, 1
    s_sub_u32 s101, s61, 7
    s_min_u32 s61, s101, s61
    s_add_u32 s61, s61, 8
    s_lshl_b32 s61, s61, 10
    s_add_u32 s62, s100, 2
    s_sub_u32 s101, s62, 7
    s_min_u32 s62, s101, s62
    s_add_u32 s62, s62, 8
    s_lshl_b32 s62, s62, 10
    s_add_u32 s63, s100, 3
    s_sub_u32 s101, s63, 7
    s_min_u32 s63, s101, s63
    s_add_u32 s63, s63, 8
    s_lshl_b32 s63, s63, 10
    s_add_u32 s64, s100, 4
    s_sub_u32 s101, s64, 7
    s_min_u32 s64, s101, s64
    s_add_u32 s64, s64, 8
    s_lshl_b32 s64, s64, 10
    s_add_u32 s65, s100, 5
    s_sub_u32 s101, s65, 7
    s_min_u32 s65, s101, s65
    s_add_u32 s65, s65, 8
    s_lshl_b32 s65, s65, 10
    s_add_u32 s66, s100, 6
    s_sub_u32 s101, s66, 7
    s_min_u32 s66, s101, s66
    s_add_u32 s66, s66, 8
    s_lshl_b32 s66, s66, 10
    s_waitcnt vmcnt(7)
    s_waitcnt lgkmcnt(0)
    s_barrier
    s_add_u32 m0, s49, 83968
    s_add_u32 s1, s75, 98304
    buffer_load_dwordx4 v2, s[12:15], s1 offen offset:0 lds
    s_add_u32 m0, s49, 91136
    s_add_u32 s1, s75, 98304
    buffer_load_dwordx4 v2, s[12:15], s1 offen offset:1024 lds
    s_add_u32 m0, s49, 32768
    s_add_u32 s0, s74, 98304
    buffer_load_dwordx4 v1, s[8:11], s0 offen lds
    s_add_u32 m0, s49, 98304
    s_add_u32 s1, s75, 98304
    buffer_load_dwordx4 v2, s[12:15], s1 offen offset:2048 lds
    buffer_load_dwordx2 v[36:37], v35, s[24:27], 0 offen sc1
    s_cmp_ge_u32 s52, 4096
    s_cselect_b32 s7, 7168, 0
    s_add_u32 s7, s7, s52
    s_lshl_b32 s7, s7, 4
    s_mul_i32 s70, s48, 360448
    s_add_u32 s0, s7, s70
    s_add_u32 s1, s0, 8192
    v_add_u32 v5, s0, v4
    v_add_u32 v6, 8192, v5
    s_add_u32 m0, s73, 0
    s_nop 0
    buffer_load_dwordx4 v5, s[20:23], 0 offen lds
    s_add_u32 m0, s73, 1024
    s_nop 0
    buffer_load_dwordx4 v6, s[20:23], 0 offen lds
    s_cmp_ge_u32 s53, 4096
    s_cselect_b32 s7, 7168, 0
    s_add_u32 s7, s7, s53
    s_lshl_b32 s7, s7, 4
    s_mul_i32 s70, s48, 360448
    s_add_u32 s0, s7, s70
    s_add_u32 s1, s0, 8192
    v_add_u32 v5, s0, v4
    v_add_u32 v6, 8192, v5
    s_add_u32 m0, s73, 8192
    s_nop 0
    buffer_load_dwordx4 v5, s[20:23], 0 offen lds
    s_add_u32 m0, s73, 9216
    s_nop 0
    buffer_load_dwordx4 v6, s[20:23], 0 offen lds
    s_cmp_ge_u32 s54, 4096
    s_cselect_b32 s7, 7168, 0
    s_add_u32 s7, s7, s54
    s_lshl_b32 s7, s7, 4
    s_mul_i32 s70, s48, 360448
    s_add_u32 s0, s7, s70
    s_add_u32 s1, s0, 8192
    v_add_u32 v5, s0, v4
    v_add_u32 v6, 8192, v5
    s_add_u32 m0, s73, 16384
    s_nop 0
    buffer_load_dwordx4 v5, s[20:23], 0 offen lds
    s_add_u32 m0, s73, 17408
    s_nop 0
    buffer_load_dwordx4 v6, s[20:23], 0 offen lds
    s_cmp_ge_u32 s55, 4096
    s_cselect_b32 s7, 7168, 0
    s_add_u32 s7, s7, s55
    s_lshl_b32 s7, s7, 4
    s_mul_i32 s70, s48, 360448
    s_add_u32 s0, s7, s70
    s_add_u32 s1, s0, 8192
    v_add_u32 v5, s0, v4
    v_add_u32 v6, 8192, v5
    s_add_u32 m0, s73, 24576
    s_nop 0
    buffer_load_dwordx4 v5, s[20:23], 0 offen lds
    s_add_u32 m0, s73, 25600
    s_nop 0
    buffer_load_dwordx4 v6, s[20:23], 0 offen lds
    s_lshl_b32 s7, s52, 4
    s_lshl_b32 s70, s48, 17
    s_add_u32 s0, s7, s70
    s_add_u32 s1, s0, 8192
    s_lshl_b32 s7, s49, 1
    v_add_u32 v5, s0, v4
    v_add_u32 v6, 8192, v5
    s_add_u32 m0, s7, 38912
    s_nop 0
    buffer_load_dwordx4 v5, s[16:19], 0 offen lds
    s_add_u32 m0, s7, 39936
    s_nop 0
    buffer_load_dwordx4 v6, s[16:19], 0 offen lds
    s_lshl_b32 s7, s53, 4
    s_lshl_b32 s70, s48, 17
    s_add_u32 s0, s7, s70
    s_add_u32 s1, s0, 8192
    s_lshl_b32 s7, s49, 1
    v_add_u32 v5, s0, v4
    v_add_u32 v6, 8192, v5
    s_add_u32 m0, s7, 47104
    s_nop 0
    buffer_load_dwordx4 v5, s[16:19], 0 offen lds
    s_add_u32 m0, s7, 48128
    s_nop 0
    buffer_load_dwordx4 v6, s[16:19], 0 offen lds
    s_waitcnt vmcnt(13)
    s_waitcnt lgkmcnt(0)
    s_barrier
    s_mov_b32 s78, -1
    s_mov_b32 s79, 0
    s_cmp_lg_u32 s4, 0
    s_cselect_b32 s79, 0xffff, 0
    s_waitcnt vmcnt(12)
    s_mov_b32 s70, 0
L_stat_19:
    v_cmp_eq_u32 vcc, 0, v36
    s_nop 1
    s_and_b64 vcc, vcc, s[78:79]
    s_cbranch_scc0 L_stat_ok_20
    buffer_load_dwordx2 v[36:37], v35, s[24:27], 0 offen sc1
    s_add_u32 s70, s70, 1
    s_waitcnt vmcnt(0)
    s_cmp_lt_u32 s70, 20000
    s_cbranch_scc1 L_stat_19
L_stat_ok_20:
    v_and_b32 v36, 0x7fffffff, v36
    v_cndmask_b32 v36, 0, v36, s[78:79]
    v_cndmask_b32 v37, 0, v37, s[78:79]
    s_mov_b32 exec_hi, 0xffff
    ds_write2_b32 v38, v36, v37 offset0:0 offset1:16
    s_mov_b64 exec, -1
    s_waitcnt vmcnt(10)
    ds_read_b64_tr_b16 v[136:137], v60 offset:0
    ds_read_b64_tr_b16 v[138:139], v60 offset:512
    ds_read_b64_tr_b16 v[140:141], v61 offset:0
    ds_read_b64_tr_b16 v[142:143], v61 offset:512
    s_waitcnt lgkmcnt(0)
    v_mov_b32 v5, v143
    s_cmp_ge_u32 s56, 4096
    s_cselect_b32 s7, 7168, 0
    s_add_u32 s7, s7, s56
    s_lshl_b32 s7, s7, 4
    s_mul_i32 s70, s48, 360448
    s_add_u32 s0, s7, s70
    s_add_u32 s1, s0, 8192
    v_add_u32 v5, s0, v4
    v_add_u32 v6, 8192, v5
    s_add_u32 m0, s73, 0
    s_nop 0
    buffer_load_dwordx4 v5, s[20:23], 0 offen lds
    s_add_u32 m0, s73, 1024
    s_nop 0
    buffer_load_dwordx4 v6, s[20:23], 0 offen lds
    s_waitcnt vmcnt(10)
    ds_read_b64_tr_b16 v[144:145], v60 offset:8192
    ds_read_b64_tr_b16 v[146:147], v60 offset:8704
    ds_read_b64_tr_b16 v[148:149], v61 offset:8192
    ds_read_b64_tr_b16 v[150:151], v61 offset:8704
    s_waitcnt lgkmcnt(0)
    v_mov_b32 v5, v151
    s_cmp_ge_u32 s57, 4096
    s_cselect_b32 s7, 7168, 0
    s_add_u32 s7, s7, s57
    s_lshl_b32 s7, s7, 4
    s_mul_i32 s70, s48, 360448
    s_add_u32 s0, s7, s70
    s_add_u32 s1, s0, 8192
    v_add_u32 v5, s0, v4
    v_add_u32 v6, 8192, v5
    s_add_u32 m0, s73, 8192
    s_nop 0
    buffer_load_dwordx4 v5, s[20:23], 0 offen lds
    s_add_u32 m0, s73, 9216
    s_nop 0
    buffer_load_dwordx4 v6, s[20:23], 0 offen lds
    s_waitcnt vmcnt(10)
    ds_read_b64_tr_b16 v[152:153], v60 offset:16384
    ds_read_b64_tr_b16 v[154:155], v60 offset:16896
    ds_read_b64_tr_b16 v[156:157], v61 offset:16384
    ds_read_b64_tr_b16 v[158:159], v61 offset:16896
    s_waitcnt lgkmcnt(0)
    v_mov_b32 v5, v159
    s_cmp_ge_u32 s58, 4096
    s_cselect_b32 s7, 7168, 0
    s_add_u32 s7, s7, s58
    s_lshl_b32 s7, s7, 4
    s_mul_i32 s70, s48, 360448
    s_add_u32 s0, s7, s70
    s_add_u32 s1, s0, 8192
    v_add_u32 v5, s0, v4
    v_add_u32 v6, 8192, v5
    s_add_u32 m0, s73, 16384
    s_nop 0
    buffer_load_dwordx4 v5, s[20:23], 0 offen lds
    s_add_u32 m0, s73, 17408
    s_nop 0
    buffer_load_dwordx4 v6, s[20:23], 0 offen lds
    s_waitcnt vmcnt(10)
    ds_read_b64_tr_b16 v[160:161], v60 offset:24576
    ds_read_b64_tr_b16 v[162:163], v60 offset:25088
    ds_read_b64_tr_b16 v[164:165], v61 offset:24576
    ds_read_b64_tr_b16 v[166:167], v61 offset:25088
    s_waitcnt lgkmcnt(0)
    v_mov_b32 v5, v167
    s_cmp_ge_u32 s59, 4096
    s_cselect_b32 s7, 7168, 0
    s_add_u32 s7, s7, s59
    s_lshl_b32 s7, s7, 4
    s_mul_i32 s70, s48, 360448
    s_add_u32 s0, s7, s70
    s_add_u32 s1, s0, 8192
    v_add_u32 v5, s0, v4
    v_add_u32 v6, 8192, v5
    s_add_u32 m0, s73, 24576
    s_nop 0
    buffer_load_dwordx4 v5, s[20:23], 0 offen lds
    s_add_u32 m0, s73, 25600
    s_nop 0
    buffer_load_dwordx4 v6, s[20:23], 0 offen lds
    s_lshl_b32 s7, s54, 4
    s_lshl_b32 s70, s48, 17
    s_add_u32 s0, s7, s70
    s_add_u32 s1, s0, 8192
    s_lshl_b32 s7, s49, 1
    v_add_u32 v5, s0, v4
    v_add_u32 v6, 8192, v5
    s_add_u32 m0, s7, 104448
    s_nop 0
    buffer_load_dwordx4 v5, s[16:19], 0 offen lds
    s_add_u32 m0, s7, 105472
    s_nop 0
    buffer_load_dwordx4 v6, s[16:19], 0 offen lds
    s_lshl_b32 s7, s55, 4
    s_lshl_b32 s70, s48, 17
    s_add_u32 s0, s7, s70
    s_add_u32 s1, s0, 8192
    s_lshl_b32 s7, s49, 1
    v_add_u32 v5, s0, v4
    v_add_u32 v6, 8192, v5
    s_add_u32 m0, s7, 112640
    s_nop 0
    buffer_load_dwordx4 v5, s[16:19], 0 offen lds
    s_add_u32 m0, s7, 113664
    s_nop 0
    buffer_load_dwordx4 v6, s[16:19], 0 offen lds
    s_waitcnt lgkmcnt(0)
    s_barrier
    s_lshl_b32 s7, s48, 2
    s_add_u32 s7, s7, 163648
    v_mov_b32 v72, s7
    s_waitcnt vmcnt(10)
    ds_read_b64_tr_b16 v[168:169], v60 offset:0
    ds_read_b64_tr_b16 v[170:171], v60 offset:512
    ds_read_b64_tr_b16 v[172:173], v61 offset:0
    ds_read_b64_tr_b16 v[174:175], v61 offset:512
    s_waitcnt lgkmcnt(0)
    v_mov_b32 v5, v175
    s_cmp_ge_u32 s60, 12288
    s_cselect_b32 s7, 7168, 0
    s_sub_u32 s7, s7, 4096
    s_add_u32 s7, s7, s60
    s_lshl_b32 s7, s7, 4
    s_mul_i32 s70, s48, 360448
    s_add_u32 s0, s7, s70
    s_add_u32 s1, s0, 8192
    v_add_u32 v5, s0, v4
    v_add_u32 v6, 8192, v5
    s_add_u32 m0, s73, 0
    s_nop 0
    buffer_load_dwordx4 v5, s[20:23], 0 offen lds
    s_add_u32 m0, s73, 1024
    s_nop 0
    buffer_load_dwordx4 v6, s[20:23], 0 offen lds
    s_lshl_b32 s7, s56, 4
    s_lshl_b32 s70, s48, 17
    s_add_u32 s0, s7, s70
    s_add_u32 s1, s0, 8192
    s_lshl_b32 s7, s49, 1
    v_add_u32 v5, s0, v4
    v_add_u32 v6, 8192, v5
    s_add_u32 m0, s7, 120832
    s_nop 0
    buffer_load_dwordx4 v5, s[16:19], 0 offen lds
    s_add_u32 m0, s7, 121856
    s_nop 0
    buffer_load_dwordx4 v6, s[16:19], 0 offen lds
    s_waitcnt vmcnt(12)
    ds_read_b64_tr_b16 v[176:177], v60 offset:8192
    ds_read_b64_tr_b16 v[178:179], v60 offset:8704
    ds_read_b64_tr_b16 v[180:181], v61 offset:8192
    ds_read_b64_tr_b16 v[182:183], v61 offset:8704
    s_waitcnt lgkmcnt(0)
    v_mov_b32 v5, v183
    s_cmp_ge_u32 s61, 12288
    s_cselect_b32 s7, 7168, 0
    s_sub_u32 s7, s7, 4096
    s_add_u32 s7, s7, s61
    s_lshl_b32 s7, s7, 4
    s_mul_i32 s70, s48, 360448
    s_add_u32 s0, s7, s70
    s_add_u32 s1, s0, 8192
    v_add_u32 v5, s0, v4
    v_add_u32 v6, 8192, v5
    s_add_u32 m0, s73, 8192
    s_nop 0
    buffer_load_dwordx4 v5, s[20:23], 0 offen lds
    s_add_u32 m0, s73, 9216
    s_nop 0
    buffer_load_dwordx4 v6, s[20:23], 0 offen lds
    s_lshl_b32 s7, s57, 4
    s_lshl_b32 s70, s48, 17
    s_add_u32 s0, s7, s70
    s_add_u32 s1, s0, 8192
    s_lshl_b32 s7, s49, 1
    v_add_u32 v5, s0, v4
    v_add_u32 v6, 8192, v5
    s_add_u32 m0, s7, 2048
    s_nop 0
    buffer_load_dwordx4 v5, s[16:19], 0 offen lds
    s_add_u32 m0, s7, 3072
    s_nop 0
    buffer_load_dwordx4 v6, s[16:19], 0 offen lds
    s_waitcnt vmcnt(14)
    ds_read_b64_tr_b16 v[184:185], v60 offset:16384
    ds_read_b64_tr_b16 v[186:187], v60 offset:16896
    ds_read_b64_tr_b16 v[188:189], v61 offset:16384
    ds_read_b64_tr_b16 v[190:191], v61 offset:16896
    s_waitcnt lgkmcnt(0)
    v_mov_b32 v5, v191
    s_cmp_ge_u32 s62, 12288
    s_cselect_b32 s7, 7168, 0
    s_sub_u32 s7, s7, 4096
    s_add_u32 s7, s7, s62
    s_lshl_b32 s7, s7, 4
    s_mul_i32 s70, s48, 360448
    s_add_u32 s0, s7, s70
    s_add_u32 s1, s0, 8192
    v_add_u32 v5, s0, v4
    v_add_u32 v6, 8192, v5
    s_add_u32 m0, s73, 16384
    s_nop 0
    buffer_load_dwordx4 v5, s[20:23], 0 offen lds
    s_add_u32 m0, s73, 17408
    s_nop 0
    buffer_load_dwordx4 v6, s[20:23], 0 offen lds
    s_lshl_b32 s7, s58, 4
    s_lshl_b32 s70, s48, 17
    s_add_u32 s0, s7, s70
    s_add_u32 s1, s0, 8192
    s_lshl_b32 s7, s49, 1
    v_add_u32 v5, s0, v4
    v_add_u32 v6, 8192, v5
    s_add_u32 m0, s7, 10240
    s_nop 0
    buffer_load_dwordx4 v5, s[16:19], 0 offen lds
    s_add_u32 m0, s7, 11264
    s_nop 0
    buffer_load_dwordx4 v6, s[16:19], 0 offen lds
    s_waitcnt vmcnt(16)
    ds_read_b64_tr_b16 v[192:193], v60 offset:24576
    ds_read_b64_tr_b16 v[194:195], v60 offset:25088
    ds_read_b64_tr_b16 v[196:197], v61 offset:24576
    ds_read_b64_tr_b16 v[198:199], v61 offset:25088
    s_waitcnt lgkmcnt(0)
    v_mov_b32 v5, v199
    s_cmp_ge_u32 s63, 12288
    s_cselect_b32 s7, 7168, 0
    s_sub_u32 s7, s7, 4096
    s_add_u32 s7, s7, s63
    s_lshl_b32 s7, s7, 4
    s_mul_i32 s70, s48, 360448
    s_add_u32 s0, s7, s70
    s_add_u32 s1, s0, 8192
    v_add_u32 v5, s0, v4
    v_add_u32 v6, 8192, v5
    s_add_u32 m0, s73, 24576
    s_nop 0
    buffer_load_dwordx4 v5, s[20:23], 0 offen lds
    s_add_u32 m0, s73, 25600
    s_nop 0
    buffer_load_dwordx4 v6, s[20:23], 0 offen lds
    s_lshl_b32 s7, s59, 4
    s_lshl_b32 s70, s48, 17
    s_add_u32 s0, s7, s70
    s_add_u32 s1, s0, 8192
    s_lshl_b32 s7, s49, 1
    v_add_u32 v5, s0, v4
    v_add_u32 v6, 8192, v5
    s_add_u32 m0, s7, 55296
    s_nop 0
    buffer_load_dwordx4 v5, s[16:19], 0 offen lds
    s_add_u32 m0, s7, 56320
    s_nop 0
    buffer_load_dwordx4 v6, s[16:19], 0 offen lds
    s_waitcnt vmcnt(14)
    ds_read_b64_tr_b16 v[200:201], v60 offset:0
    ds_read_b64_tr_b16 v[202:203], v60 offset:512
    ds_read_b64_tr_b16 v[204:205], v61 offset:0
    ds_read_b64_tr_b16 v[206:207], v61 offset:512
    s_waitcnt lgkmcnt(0)
    v_mov_b32 v5, v207
    s_cmp_ge_u32 s64, 12288
    s_cselect_b32 s7, 7168, 0
    s_sub_u32 s7, s7, 4096
    s_add_u32 s7, s7, s64
    s_lshl_b32 s7, s7, 4
    s_mul_i32 s70, s48, 360448
    s_add_u32 s0, s7, s70
    s_add_u32 s1, s0, 8192
    v_add_u32 v5, s0, v4
    v_add_u32 v6, 8192, v5
    s_add_u32 m0, s73, 0
    s_nop 0
    buffer_load_dwordx4 v5, s[20:23], 0 offen lds
    s_add_u32 m0, s73, 1024
    s_nop 0
    buffer_load_dwordx4 v6, s[20:23], 0 offen lds
    s_cmp_ge_u32 s60, 11264
    s_cselect_b32 s7, 7168, 0
    s_add_u32 s7, s7, s60
    s_lshl_b32 s7, s7, 4
    s_mul_i32 s70, s48, 360448
    s_add_u32 s0, s7, s70
    s_add_u32 s1, s0, 8192
    s_lshl_b32 s7, s49, 1
    v_add_u32 v5, s0, v4
    v_add_u32 v6, 8192, v5
    s_add_u32 m0, s7, 63488
    s_nop 0
    buffer_load_dwordx4 v5, s[20:23], 0 offen lds
    s_add_u32 m0, s7, 64512
    s_nop 0
    buffer_load_dwordx4 v6, s[20:23], 0 offen lds
    s_waitcnt vmcnt(14)
    ds_read_b64_tr_b16 v[208:209], v60 offset:8192
    ds_read_b64_tr_b16 v[210:211], v60 offset:8704
    ds_read_b64_tr_b16 v[212:213], v61 offset:8192
    ds_read_b64_tr_b16 v[214:215], v61 offset:8704
    s_waitcnt lgkmcnt(0)
    v_mov_b32 v5, v215
    s_cmp_ge_u32 s65, 12288
    s_cselect_b32 s7, 7168, 0
    s_sub_u32 s7, s7, 4096
    s_add_u32 s7, s7, s65
    s_lshl_b32 s7, s7, 4
    s_mul_i32 s70, s48, 360448
    s_add_u32 s0, s7, s70
    s_add_u32 s1, s0, 8192
    v_add_u32 v5, s0, v4
    v_add_u32 v6, 8192, v5
    s_add_u32 m0, s73, 8192
    s_nop 0
    buffer_load_dwordx4 v5, s[20:23], 0 offen lds
    s_add_u32 m0, s73, 9216
    s_nop 0
    buffer_load_dwordx4 v6, s[20:23], 0 offen lds
    v_mov_b32 v73, 1
    ds_write_b32 v72, v73
    s_cmp_ge_u32 s61, 11264
    s_cselect_b32 s7, 7168, 0
    s_add_u32 s7, s7, s61
    s_lshl_b32 s7, s7, 4
    s_mul_i32 s70, s48, 360448
    s_add_u32 s0, s7, s70
    s_add_u32 s1, s0, 8192
    s_lshl_b32 s7, s49, 1
    v_add_u32 v5, s0, v4
    v_add_u32 v6, 8192, v5
    s_add_u32 m0, s7, 71680
    s_nop 0
    buffer_load_dwordx4 v5, s[20:23], 0 offen lds
    s_add_u32 m0, s7, 72704
    s_nop 0
    buffer_load_dwordx4 v6, s[20:23], 0 offen lds
    s_waitcnt vmcnt(14)
    ds_read_b64_tr_b16 v[216:217], v60 offset:16384
    ds_read_b64_tr_b16 v[218:219], v60 offset:16896
    ds_read_b64_tr_b16 v[220:221], v61 offset:16384
    ds_read_b64_tr_b16 v[222:223], v61 offset:16896
    s_waitcnt lgkmcnt(0)
    v_mov_b32 v5, v223
    s_cmp_ge_u32 s66, 12288
    s_cselect_b32 s7, 7168, 0
    s_sub_u32 s7, s7, 4096
    s_add_u32 s7, s7, s66
    s_lshl_b32 s7, s7, 4
    s_mul_i32 s70, s48, 360448
    s_add_u32 s0, s7, s70
    s_add_u32 s1, s0, 8192
    v_add_u32 v5, s0, v4
    v_add_u32 v6, 8192, v5
    s_add_u32 m0, s73, 16384
    s_nop 0
    buffer_load_dwordx4 v5, s[20:23], 0 offen lds
    s_add_u32 m0, s73, 17408
    s_nop 0
    buffer_load_dwordx4 v6, s[20:23], 0 offen lds
    s_cmp_ge_u32 s62, 11264
    s_cselect_b32 s7, 7168, 0
    s_add_u32 s7, s7, s62
    s_lshl_b32 s7, s7, 4
    s_mul_i32 s70, s48, 360448
    s_add_u32 s0, s7, s70
    s_add_u32 s1, s0, 8192
    s_lshl_b32 s7, s49, 1
    v_add_u32 v5, s0, v4
    v_add_u32 v6, 8192, v5
    s_add_u32 m0, s7, 20480
    s_nop 0
    buffer_load_dwordx4 v5, s[20:23], 0 offen lds
    s_add_u32 m0, s7, 21504
    s_nop 0
    buffer_load_dwordx4 v6, s[20:23], 0 offen lds
    s_cmp_ge_u32 s63, 11264
    s_cselect_b32 s7, 7168, 0
    s_add_u32 s7, s7, s63
    s_lshl_b32 s7, s7, 4
    s_mul_i32 s70, s48, 360448
    s_add_u32 s0, s7, s70
    s_add_u32 s1, s0, 8192
    s_lshl_b32 s7, s49, 1
    v_add_u32 v5, s0, v4
    v_add_u32 v6, 8192, v5
    s_add_u32 m0, s7, 28672
    s_nop 0
    buffer_load_dwordx4 v5, s[20:23], 0 offen lds
    s_add_u32 m0, s7, 29696
    s_nop 0
    buffer_load_dwordx4 v6, s[20:23], 0 offen lds
    s_cmp_ge_u32 s64, 11264
    s_cselect_b32 s7, 7168, 0
    s_add_u32 s7, s7, s64
    s_lshl_b32 s7, s7, 4
    s_mul_i32 s70, s48, 360448
    s_add_u32 s0, s7, s70
    s_add_u32 s1, s0, 8192
    s_lshl_b32 s7, s49, 1
    v_add_u32 v5, s0, v4
    v_add_u32 v6, 8192, v5
    s_add_u32 m0, s7, 79872
    s_nop 0
    buffer_load_dwordx4 v5, s[20:23], 0 offen lds
    s_add_u32 m0, s7, 80896
    s_nop 0
    buffer_load_dwordx4 v6, s[20:23], 0 offen lds
    s_cmp_ge_u32 s65, 11264
    s_cselect_b32 s7, 7168, 0
    s_add_u32 s7, s7, s65
    s_lshl_b32 s7, s7, 4
    s_mul_i32 s70, s48, 360448
    s_add_u32 s0, s7, s70
    s_add_u32 s1, s0, 8192
    s_lshl_b32 s7, s49, 1
    v_add_u32 v5, s0, v4
    v_add_u32 v6, 8192, v5
    s_add_u32 m0, s7, 88064
    s_nop 0
    buffer_load_dwordx4 v5, s[20:23], 0 offen lds
    s_add_u32 m0, s7, 89088
    s_nop 0
    buffer_load_dwordx4 v6, s[20:23], 0 offen lds
    s_cmp_ge_u32 s66, 11264
    s_cselect_b32 s7, 7168, 0
    s_add_u32 s7, s7, s66
    s_lshl_b32 s7, s7, 4
    s_mul_i32 s70, s48, 360448
    s_add_u32 s0, s7, s70
    s_add_u32 s1, s0, 8192
    s_lshl_b32 s7, s49, 1
    v_add_u32 v5, s0, v4
    v_add_u32 v6, 8192, v5
    s_add_u32 m0, s7, 96256
    s_nop 0
    buffer_load_dwordx4 v5, s[20:23], 0 offen lds
    s_add_u32 m0, s7, 97280
    s_nop 0
    buffer_load_dwordx4 v6, s[20:23], 0 offen lds
    s_waitcnt vmcnt(22)
    ds_read_b64_tr_b16 v[224:225], v60 offset:24576
    ds_read_b64_tr_b16 v[226:227], v60 offset:25088
    ds_read_b64_tr_b16 v[228:229], v61 offset:24576
    ds_read_b64_tr_b16 v[230:231], v61 offset:25088
    s_waitcnt vmcnt(18)
    ds_read_b64_tr_b16 v[232:233], v60 offset:0
    ds_read_b64_tr_b16 v[234:235], v60 offset:512
    ds_read_b64_tr_b16 v[236:237], v61 offset:0
    ds_read_b64_tr_b16 v[238:239], v61 offset:512
    s_waitcnt vmcnt(14)
    ds_read_b64_tr_b16 v[240:241], v60 offset:8192
    ds_read_b64_tr_b16 v[242:243], v60 offset:8704
    ds_read_b64_tr_b16 v[244:245], v61 offset:8192
    ds_read_b64_tr_b16 v[246:247], v61 offset:8704
    s_waitcnt vmcnt(10)
    ds_read_b64_tr_b16 v[248:249], v60 offset:16384
    ds_read_b64_tr_b16 v[250:251], v60 offset:16896
    ds_read_b64_tr_b16 v[252:253], v61 offset:16384
    ds_read_b64_tr_b16 v[254:255], v61 offset:16896
    v_mov_b32 v73, 2
    ds_write_b32 v72, v73
    s_lshl_b32 s7, s67, 1
    s_add_u32 s7, s7, s68
    s_lshl_b32 s7, s7, 7
    s_lshl_b32 s70, s48, 2
    s_add_u32 s7, s7, s70
    v_add_u32 v3, s7, v0
    s_mov_b32 s50, 15
    s_mov_b32 s72, 1024
    s_mov_b32 s74, 0
    s_mov_b32 s51, 0
    v_lshlrev_b32 v3, 6, v3
    v_add_u32 v3, 8388608, v3
    s_lshl_b32 s7, s67, 2
    s_lshl_b32 s71, s68, 1
    s_add_u32 s7, s7, s71
    s_lshl_b32 s7, s7, 7
    s_mul_i32 s71, s3, 15
    s_add_u32 s7, s7, s71
    s_lshl_b32 s7, s7, 10
    v_lshl_add_u32 v1, v0, 4, s7
    v_add_u32 v2, 0x20000, v1
    s_waitcnt vmcnt(0)
    s_lshl_b32 s7, s48, 2
    s_add_u32 s7, s7, 163648
    v_mov_b32 v16, s7
    v_mov_b32 v17, 3
    ds_write_b32 v16, v17
    s_setprio 0
    s_branch L_poll
L_catt:
    s_getpc_b64 s[78:79]
L_pcA:
    s_sub_u32 s78, s78, L_pcA-L_poll
    s_subb_u32 s79, s79, 0
    s_bfe_u32 s7, s2, 0x20003
    s_lshr_b32 s0, s2, 6
    s_lshl2_add_u32 s7, s0, s7
    s_mul_i32 s7, s7, 1536
    v_lshl_add_u32 v239, v0, 6, s7
    v_min_u32 v239, L_last-L_poll, v239
    v_and_b32 v216, 15, v0
    v_lshrrev_b32 v217, 4, v0
    v_lshrrev_b32 v218, 1, v216
    v_xor_b32 v218, v218, v217
    v_lshlrev_b32 v218, 4, v218
    v_lshl_add_u32 v1, v216, 7, v218
    v_xor_b32 v2, 64, v1
    v_lshrrev_b32 v222, 4, v0
    v_bfe_u32 v223, v0, 2, 2
    v_and_b32 v224, 3, v0
    v_and_b32 v225, 1, v222
    v_lshl_add_u32 v225, v225, 2, v223
    v_lshrrev_b32 v221, 1, v225
    v_lshrrev_b32 v222, 1, v222
    v_lshlrev_b32 v222, 11, v222
    v_lshl_add_u32 v222, v225, 7, v222
    v_lshl_add_u32 v222, v224, 3, v222
    v_add_u32 v220, 55296, v222
    v_xor_b32_e64 v221, s3, v221
    v_lshl_add_u32 v3, v221, 5, v220
    v_add_u32 v4, 8192, v3
    v_add_u32 v5, 16384, v3
    v_mov_b32 v8, 0x3f803f80
    v_mov_b32 v9, 0x3f803f80
    v_mov_b32 v10, 0x3f803f80
    v_mov_b32 v11, 0x3f803f80
    s_cmp_lg_u32 s3, 0
    s_cbranch_scc1 L_noones_21
    v_lshlrev_b32 v220, 2, v0
    ds_write_b32 v220, v8 offset:0
    ds_write_b32 v220, v8 offset:18432
    ds_write_b32 v220, v8 offset:36864
    v_and_b32 v220, 124, v220
    v_add_u32 v220, 163648, v220
    v_mov_b32 v221, 0
    ds_write_b32 v220, v221
L_noones_21:
    s_lshr_b32 s7, s5, 1
    s_mul_i32 s7, s7, 15
    s_and_b32 s70, s5, 1
    s_lshl_b32 s70, s70, 2
    s_add_u32 s7, s7, s70
    s_add_u32 s7, s7, s3
    s_lshl_b32 s70, s4, 9
    s_add_u32 s7, s7, s70
    s_lshl_b32 s7, s7, 10
    v_lshl_add_u32 v6, v0, 4, s7
    s_lshl_b32 s7, s4, 8
    s_lshl_b32 s70, s5, 2
    s_add_u32 s7, s7, s70
    s_add_u32 s7, s7, s3
    s_add_u32 s7, s7, 48
    s_lshl_b32 s7, s7, 6
    s_add_u32 s74, s7, 8388608
    s_mov_b32 s53, 131072
    s_mov_b32 s54, 262144
    s_mov_b32 s55, 393216
    v_mov_b32 v222, 0xf149f2ca
    v_lshlrev_b32 v220, 2, v217
    v_sub_u32 v220, v216, v220
    v_subrev_u32 v221, 0, v220
    v_and_b32 v221, 0x80000001, v221
    v_cmp_eq_u32 vcc, 0, v221
    s_nop 1
    v_cndmask_b32 v244, v222, 0, vcc
    v_cmp_eq_u32 vcc, 0x80000000, v221
    s_nop 1
    v_cndmask_b32 v248, v222, 0, vcc
    v_subrev_u32 v221, 1, v220
    v_and_b32 v221, 0x80000001, v221
    v_cmp_eq_u32 vcc, 0, v221
    s_nop 1
    v_cndmask_b32 v245, v222, 0, vcc
    v_cmp_eq_u32 vcc, 0x80000000, v221
    s_nop 1
    v_cndmask_b32 v249, v222, 0, vcc
    v_subrev_u32 v221, 2, v220
    v_and_b32 v221, 0x80000001, v221
    v_cmp_eq_u32 vcc, 0, v221
    s_nop 1
    v_cndmask_b32 v246, v222, 0, vcc
    v_cmp_eq_u32 vcc, 0x80000000, v221
    s_nop 1
    v_cndmask_b32 v250, v222, 0, vcc
    v_subrev_u32 v221, 3, v220
    v_and_b32 v221, 0x80000001, v221
    v_cmp_eq_u32 vcc, 0, v221
    s_nop 1
    v_cndmask_b32 v247, v222, 0, vcc
    v_cmp_eq_u32 vcc, 0x80000000, v221
    s_nop 1
    v_cndmask_b32 v251, v222, 0, vcc
    s_cmp_eq_u32 s4, 0
    s_cselect_b64 vcc, -1, 0
    v_cndmask_b32 v252, v248, v222, vcc
    v_cndmask_b32 v253, v249, v222, vcc
    v_cndmask_b32 v254, v250, v222, vcc
    v_cndmask_b32 v255, v251, v222, vcc
    v_lshlrev_b32 v240, 2, v216
    v_add_u32 v240, 161792, v240
    v_lshlrev_b32 v241, 4, v217
    v_add_u32 v241, 161792, v241
    v_mov_b32 v242, 0x3eb8aa3b
    v_mov_b32 v243, 0x3eb8aa3b
    s_mul_i32 s7, s2, 6
    s_lshl_b32 s70, s3, 1
    s_add_u32 s7, s7, s70
    s_lshl_b32 s7, s7, 10
    v_lshl_add_u32 v224, v0, 4, s7
    s_lshl_b32 s7, s2, 11
    v_lshl_add_u32 v225, v0, 4, s7
    s_waitcnt lgkmcnt(0)
    s_cmp_eq_u32 s3, 3
    s_cbranch_scc1 L_pf3_22
    buffer_load_dwordx4 v[228:231], v224, s[20:23], 0 offen
    buffer_load_dwordx4 v[232:235], v224, s[20:23], 0 offen offset:1024
    s_branch L_pfd_23
L_pf3_22:
    buffer_load_dwordx4 v[228:231], v225, s[16:19], 0 offen
    buffer_load_dwordx4 v[232:235], v225, s[16:19], 0 offen offset:1024
L_pfd_23:
    s_cmp_lg_u32 s5, 0
    s_cbranch_scc1 L_nogate_16
    s_cmp_lg_u32 s3, 3
    s_cbranch_scc1 L_nogate_16
    s_lshl_b32 s7, s4, 4
    v_mov_b32 v18, s7
    v_mov_b32 v19, 1
    s_waitcnt vmcnt(2)
    s_mov_b64 exec, 1
    buffer_store_dword v19, v18, s[40:43], 0 offen sc1
    s_mov_b64 exec, -1
L_nogate_16:
    v_lshrrev_b32 v219, 1, v0
    v_and_b32 v220, 1, v0
    v_lshlrev_b32 v220, 6, v220
    s_bfe_u32 s7, s2, 0x20003
    s_lshr_b32 s70, s2, 6
    s_lshl2_add_u32 s7, s70, s7
    v_lshl_add_u32 v221, v219, 10, v220
    s_lshl_b32 s70, s7, 2
    s_add_u32 s70, s70, s3
    s_lshl_b32 s70, s70, 15
    s_add_u32 s70, s70, 384
    v_add_u32 v221, s70, v221
    v_subrev_u32 v218, 1409024, v221
    s_waitcnt lgkmcnt(0)
    s_barrier
    s_setprio 2
    ds_read_b64_tr_b16 v[160:161], v4 offset:0
    ds_read_b64_tr_b16 v[162:163], v4 offset:1024
    ds_read_b128 v[120:123], v1 offset:0
    ds_read_b64_tr_b16 v[164:165], v5 offset:0
    ds_read_b64_tr_b16 v[166:167], v5 offset:1024
    ds_read_b64_tr_b16 v[156:157], v3 offset:0
    ds_read_b64_tr_b16 v[158:159], v3 offset:1024
    ds_read_b128 v[124:127], v1 offset:2048
    ds_read_b128 v[128:131], v1 offset:4096
    ds_read_b128 v[132:135], v1 offset:6144
    ds_read_b128 v[136:139], v1 offset:8192
    ds_read_b128 v[140:143], v1 offset:10240
    ds_read_b128 v[144:147], v1 offset:12288
    ds_read_b128 v[148:151], v1 offset:14336
    ds_read_b128 v[152:155], v1 offset:16384
    ds_read_b64_tr_b16 v[208:209], v4 offset:4096
    s_waitcnt lgkmcnt(13)
    v_mfma_f32_16x16x32_bf16 v[44:47], v[160:163], v[120:123], 0
    ds_read_b64_tr_b16 v[210:211], v4 offset:5120
    s_waitcnt lgkmcnt(12)
    v_mfma_f32_16x16x32_bf16 v[80:83], v[120:123], v[164:167], 0
    ds_read_b128 v[168:171], v2 offset:0
    s_waitcnt lgkmcnt(11)
    v_mfma_f32_16x16x32_bf16 v[116:119], v[156:159], v[8:11], 0
    s_waitcnt lgkmcnt(10)
    v_mfma_f32_16x16x32_bf16 v[48:51], v[160:163], v[124:127], 0
    ds_read_b64_tr_b16 v[212:213], v5 offset:4096
    v_mfma_f32_16x16x32_bf16 v[84:87], v[124:127], v[164:167], 0
    ds_read_b64_tr_b16 v[214:215], v5 offset:5120
    v_mfma_f32_16x16x32_bf16 v[12:15], v[156:159], v[124:127], 0
    ds_read_b64_tr_b16 v[204:205], v3 offset:4096
    s_waitcnt lgkmcnt(12)
    v_mfma_f32_16x16x32_bf16 v[52:55], v[160:163], v[128:131], 0
    v_mfma_f32_16x16x32_bf16 v[88:91], v[128:131], v[164:167], 0
    ds_read_b64_tr_b16 v[206:207], v3 offset:5120
    v_mfma_f32_16x16x32_bf16 v[16:19], v[156:159], v[128:131], 0
    ds_read_b128 v[172:175], v2 offset:2048
    s_waitcnt lgkmcnt(13)
    v_mfma_f32_16x16x32_bf16 v[56:59], v[160:163], v[132:135], 0
    ds_read_b128 v[176:179], v2 offset:4096
    v_mfma_f32_16x16x32_bf16 v[92:95], v[132:135], v[164:167], 0
    v_mfma_f32_16x16x32_bf16 v[20:23], v[156:159], v[132:135], 0
    ds_read_b128 v[180:183], v2 offset:6144
    s_waitcnt lgkmcnt(14)
    v_mfma_f32_16x16x32_bf16 v[60:63], v[160:163], v[136:139], 0
    ds_read_b128 v[184:187], v2 offset:8192
    v_mfma_f32_16x16x32_bf16 v[96:99], v[136:139], v[164:167], 0
    ds_read_b128 v[188:191], v2 offset:10240
    v_mfma_f32_16x16x32_bf16 v[24:27], v[156:159], v[136:139], 0
    s_waitcnt lgkmcnt(15)
    v_mfma_f32_16x16x32_bf16 v[64:67], v[160:163], v[140:143], 0
    ds_read_b128 v[192:195], v2 offset:12288
    v_mfma_f32_16x16x32_bf16 v[100:103], v[140:143], v[164:167], 0
    ds_read_b128 v[196:199], v2 offset:14336
    v_mfma_f32_16x16x32_bf16 v[28:31], v[156:159], v[140:143], 0
    ds_read_b128 v[200:203], v2 offset:16384
    s_waitcnt lgkmcnt(15)
    v_mfma_f32_16x16x32_bf16 v[68:71], v[160:163], v[144:147], 0
    v_mfma_f32_16x16x32_bf16 v[104:107], v[144:147], v[164:167], 0
    v_mfma_f32_16x16x32_bf16 v[32:35], v[156:159], v[144:147], 0
    v_mfma_f32_16x16x32_bf16 v[72:75], v[160:163], v[148:151], 0
    v_mfma_f32_16x16x32_bf16 v[108:111], v[148:151], v[164:167], 0
    v_mfma_f32_16x16x32_bf16 v[36:39], v[156:159], v[148:151], 0
    v_mfma_f32_16x16x32_bf16 v[76:79], v[160:163], v[152:155], 0
    v_mfma_f32_16x16x32_bf16 v[112:115], v[152:155], v[164:167], 0
    v_mfma_f32_16x16x32_bf16 v[40:43], v[156:159], v[152:155], 0
    s_waitcnt lgkmcnt(12)
    v_mfma_f32_16x16x32_bf16 v[44:47], v[208:211], v[168:171], v[44:47]
    s_waitcnt lgkmcnt(10)
    v_mfma_f32_16x16x32_bf16 v[80:83], v[168:171], v[212:215], v[80:83]
    s_waitcnt lgkmcnt(8)
    v_mfma_f32_16x16x32_bf16 v[116:119], v[204:207], v[8:11], v[116:119]
    s_waitcnt lgkmcnt(7)
    v_mfma_f32_16x16x32_bf16 v[48:51], v[208:211], v[172:175], v[48:51]
    v_mfma_f32_16x16x32_bf16 v[84:87], v[172:175], v[212:215], v[84:87]
    s_waitcnt lgkmcnt(0)
    s_barrier
    ds_read_b64_tr_b16 v[160:161], v4 offset:24576
    v_mfma_f32_16x16x32_bf16 v[12:15], v[204:207], v[172:175], v[12:15]
    ds_read_b64_tr_b16 v[162:163], v4 offset:25600
    v_mfma_f32_16x16x32_bf16 v[52:55], v[208:211], v[176:179], v[52:55]
    ds_read_b128 v[120:123], v1 offset:18432
    v_mfma_f32_16x16x32_bf16 v[88:91], v[176:179], v[212:215], v[88:91]
    ds_read_b64_tr_b16 v[164:165], v5 offset:24576
    v_mfma_f32_16x16x32_bf16 v[16:19], v[204:207], v[176:179], v[16:19]
    v_mfma_f32_16x16x32_bf16 v[56:59], v[208:211], v[180:183], v[56:59]
    ds_read_b64_tr_b16 v[166:167], v5 offset:25600
    v_mfma_f32_16x16x32_bf16 v[92:95], v[180:183], v[212:215], v[92:95]
    ds_read_b64_tr_b16 v[156:157], v3 offset:24576
    v_mfma_f32_16x16x32_bf16 v[20:23], v[204:207], v[180:183], v[20:23]
    ds_read_b64_tr_b16 v[158:159], v3 offset:25600
    v_mfma_f32_16x16x32_bf16 v[60:63], v[208:211], v[184:187], v[60:63]
    v_mfma_f32_16x16x32_bf16 v[96:99], v[184:187], v[212:215], v[96:99]
    ds_read_b128 v[124:127], v1 offset:20480
    v_mfma_f32_16x16x32_bf16 v[24:27], v[204:207], v[184:187], v[24:27]
    ds_read_b128 v[128:131], v1 offset:22528
    v_mfma_f32_16x16x32_bf16 v[64:67], v[208:211], v[188:191], v[64:67]
    ds_read_b128 v[132:135], v1 offset:24576
    v_mfma_f32_16x16x32_bf16 v[100:103], v[188:191], v[212:215], v[100:103]
    v_mfma_f32_16x16x32_bf16 v[28:31], v[204:207], v[188:191], v[28:31]
    ds_read_b128 v[136:139], v1 offset:26624
    v_mfma_f32_16x16x32_bf16 v[68:71], v[208:211], v[192:195], v[68:71]
    ds_read_b128 v[140:143], v1 offset:28672
    v_mfma_f32_16x16x32_bf16 v[104:107], v[192:195], v[212:215], v[104:107]
    ds_read_b128 v[144:147], v1 offset:30720
    v_mfma_f32_16x16x32_bf16 v[32:35], v[204:207], v[192:195], v[32:35]
    v_mfma_f32_16x16x32_bf16 v[72:75], v[208:211], v[196:199], v[72:75]
    ds_read_b128 v[148:151], v1 offset:32768
    v_mfma_f32_16x16x32_bf16 v[108:111], v[196:199], v[212:215], v[108:111]
    ds_read_b128 v[152:155], v1 offset:34816
    v_mfma_f32_16x16x32_bf16 v[36:39], v[204:207], v[196:199], v[36:39]
    v_mfma_f32_16x16x32_bf16 v[76:79], v[208:211], v[200:203], v[76:79]
    v_mfma_f32_16x16x32_bf16 v[112:115], v[200:203], v[212:215], v[112:115]
    v_mfma_f32_16x16x32_bf16 v[40:43], v[204:207], v[200:203], v[40:43]
    s_cmp_lg_u32 s3, 0
    s_cbranch_scc1 L_nocp_24
    s_mov_b64 exec, 0xffffff
    global_load_dword v236, v239, s[78:79]
    s_mov_b64 exec, -1
L_nocp_24:
    s_mov_b64 exec, -1
    buffer_load_dword v236, v221, s[20:23], 0 offen
    buffer_load_dword v237, v218, s[16:19], 0 offen
    s_mov_b64 exec, -1
    ds_read_b64_tr_b16 v[208:209], v4 offset:28672
    s_waitcnt lgkmcnt(13)
    v_mfma_f32_16x16x32_bf16 v[44:47], v[160:163], v[120:123], v[44:47]
    ds_read_b64_tr_b16 v[210:211], v4 offset:29696
    s_waitcnt lgkmcnt(12)
    v_mfma_f32_16x16x32_bf16 v[80:83], v[120:123], v[164:167], v[80:83]
    ds_read_b128 v[168:171], v2 offset:18432
    s_waitcnt lgkmcnt(11)
    v_mfma_f32_16x16x32_bf16 v[116:119], v[156:159], v[8:11], v[116:119]
    s_waitcnt lgkmcnt(10)
    v_mfma_f32_16x16x32_bf16 v[48:51], v[160:163], v[124:127], v[48:51]
    ds_read_b64_tr_b16 v[212:213], v5 offset:28672
    v_mfma_f32_16x16x32_bf16 v[84:87], v[124:127], v[164:167], v[84:87]
    ds_read_b64_tr_b16 v[214:215], v5 offset:29696
    v_mfma_f32_16x16x32_bf16 v[12:15], v[156:159], v[124:127], v[12:15]
    ds_read_b64_tr_b16 v[204:205], v3 offset:28672
    s_waitcnt lgkmcnt(12)
    v_mfma_f32_16x16x32_bf16 v[52:55], v[160:163], v[128:131], v[52:55]
    v_mfma_f32_16x16x32_bf16 v[88:91], v[128:131], v[164:167], v[88:91]
    ds_read_b64_tr_b16 v[206:207], v3 offset:29696
    v_mfma_f32_16x16x32_bf16 v[16:19], v[156:159], v[128:131], v[16:19]
    ds_read_b128 v[172:175], v2 offset:20480
    s_waitcnt lgkmcnt(13)
    v_mfma_f32_16x16x32_bf16 v[56:59], v[160:163], v[132:135], v[56:59]
    ds_read_b128 v[176:179], v2 offset:22528
    v_mfma_f32_16x16x32_bf16 v[92:95], v[132:135], v[164:167], v[92:95]
    v_mfma_f32_16x16x32_bf16 v[20:23], v[156:159], v[132:135], v[20:23]
    ds_read_b128 v[180:183], v2 offset:24576
    s_waitcnt lgkmcnt(14)
    v_mfma_f32_16x16x32_bf16 v[60:63], v[160:163], v[136:139], v[60:63]
    ds_read_b128 v[184:187], v2 offset:26624
    v_mfma_f32_16x16x32_bf16 v[96:99], v[136:139], v[164:167], v[96:99]
    ds_read_b128 v[188:191], v2 offset:28672
    v_mfma_f32_16x16x32_bf16 v[24:27], v[156:159], v[136:139], v[24:27]
    s_waitcnt lgkmcnt(15)
    v_mfma_f32_16x16x32_bf16 v[64:67], v[160:163], v[140:143], v[64:67]
    ds_read_b128 v[192:195], v2 offset:30720
    v_mfma_f32_16x16x32_bf16 v[100:103], v[140:143], v[164:167], v[100:103]
    ds_read_b128 v[196:199], v2 offset:32768
    v_mfma_f32_16x16x32_bf16 v[28:31], v[156:159], v[140:143], v[28:31]
    ds_read_b128 v[200:203], v2 offset:34816
    s_waitcnt lgkmcnt(15)
    v_mfma_f32_16x16x32_bf16 v[68:71], v[160:163], v[144:147], v[68:71]
    v_mfma_f32_16x16x32_bf16 v[104:107], v[144:147], v[164:167], v[104:107]
    v_mfma_f32_16x16x32_bf16 v[32:35], v[156:159], v[144:147], v[32:35]
    v_mfma_f32_16x16x32_bf16 v[72:75], v[160:163], v[148:151], v[72:75]
    v_mfma_f32_16x16x32_bf16 v[108:111], v[148:151], v[164:167], v[108:111]
    v_mfma_f32_16x16x32_bf16 v[36:39], v[156:159], v[148:151], v[36:39]
    v_mfma_f32_16x16x32_bf16 v[76:79], v[160:163], v[152:155], v[76:79]
    v_mfma_f32_16x16x32_bf16 v[112:115], v[152:155], v[164:167], v[112:115]
    v_mfma_f32_16x16x32_bf16 v[40:43], v[156:159], v[152:155], v[40:43]
    s_waitcnt lgkmcnt(12)
    v_mfma_f32_16x16x32_bf16 v[44:47], v[208:211], v[168:171], v[44:47]
    s_waitcnt lgkmcnt(10)
    v_mfma_f32_16x16x32_bf16 v[80:83], v[168:171], v[212:215], v[80:83]
    s_waitcnt lgkmcnt(8)
    v_mfma_f32_16x16x32_bf16 v[116:119], v[204:207], v[8:11], v[116:119]
    s_waitcnt lgkmcnt(7)
    v_mfma_f32_16x16x32_bf16 v[48:51], v[208:211], v[172:175], v[48:51]
    v_mfma_f32_16x16x32_bf16 v[84:87], v[172:175], v[212:215], v[84:87]
    s_waitcnt lgkmcnt(0)
    s_barrier
    ds_read_b64_tr_b16 v[160:161], v4 offset:49152
    v_mfma_f32_16x16x32_bf16 v[12:15], v[204:207], v[172:175], v[12:15]
    ds_read_b64_tr_b16 v[162:163], v4 offset:50176
    v_mfma_f32_16x16x32_bf16 v[52:55], v[208:211], v[176:179], v[52:55]
    ds_read_b128 v[120:123], v1 offset:36864
    v_mfma_f32_16x16x32_bf16 v[88:91], v[176:179], v[212:215], v[88:91]
    ds_read_b64_tr_b16 v[164:165], v5 offset:49152
    v_mfma_f32_16x16x32_bf16 v[16:19], v[204:207], v[176:179], v[16:19]
    v_mfma_f32_16x16x32_bf16 v[56:59], v[208:211], v[180:183], v[56:59]
    ds_read_b64_tr_b16 v[166:167], v5 offset:50176
    v_mfma_f32_16x16x32_bf16 v[92:95], v[180:183], v[212:215], v[92:95]
    ds_read_b64_tr_b16 v[156:157], v3 offset:49152
    v_mfma_f32_16x16x32_bf16 v[20:23], v[204:207], v[180:183], v[20:23]
    ds_read_b64_tr_b16 v[158:159], v3 offset:50176
    v_mfma_f32_16x16x32_bf16 v[60:63], v[208:211], v[184:187], v[60:63]
    v_mfma_f32_16x16x32_bf16 v[96:99], v[184:187], v[212:215], v[96:99]
    ds_read_b128 v[124:127], v1 offset:38912
    v_mfma_f32_16x16x32_bf16 v[24:27], v[204:207], v[184:187], v[24:27]
    ds_read_b128 v[128:131], v1 offset:40960
    v_mfma_f32_16x16x32_bf16 v[64:67], v[208:211], v[188:191], v[64:67]
    ds_read_b128 v[132:135], v1 offset:43008
    v_mfma_f32_16x16x32_bf16 v[100:103], v[188:191], v[212:215], v[100:103]
    v_mfma_f32_16x16x32_bf16 v[28:31], v[204:207], v[188:191], v[28:31]
    ds_read_b128 v[136:139], v1 offset:45056
    v_mfma_f32_16x16x32_bf16 v[68:71], v[208:211], v[192:195], v[68:71]
    ds_read_b128 v[140:143], v1 offset:47104
    v_mfma_f32_16x16x32_bf16 v[104:107], v[192:195], v[212:215], v[104:107]
    ds_read_b128 v[144:147], v1 offset:49152
    v_mfma_f32_16x16x32_bf16 v[32:35], v[204:207], v[192:195], v[32:35]
    v_mfma_f32_16x16x32_bf16 v[72:75], v[208:211], v[196:199], v[72:75]
    ds_read_b128 v[148:151], v1 offset:51200
    v_mfma_f32_16x16x32_bf16 v[108:111], v[196:199], v[212:215], v[108:111]
    ds_read_b128 v[152:155], v1 offset:53248
    v_mfma_f32_16x16x32_bf16 v[36:39], v[204:207], v[196:199], v[36:39]
    v_mfma_f32_16x16x32_bf16 v[76:79], v[208:211], v[200:203], v[76:79]
    v_mfma_f32_16x16x32_bf16 v[112:115], v[200:203], v[212:215], v[112:115]
    v_mfma_f32_16x16x32_bf16 v[40:43], v[204:207], v[200:203], v[40:43]
    ds_read_b64_tr_b16 v[208:209], v4 offset:53248
    s_waitcnt lgkmcnt(13)
    v_mfma_f32_16x16x32_bf16 v[44:47], v[160:163], v[120:123], v[44:47]
    ds_read_b64_tr_b16 v[210:211], v4 offset:54272
    s_waitcnt lgkmcnt(12)
    v_mfma_f32_16x16x32_bf16 v[80:83], v[120:123], v[164:167], v[80:83]
    ds_read_b128 v[168:171], v2 offset:36864
    s_waitcnt lgkmcnt(11)
    v_mfma_f32_16x16x32_bf16 v[116:119], v[156:159], v[8:11], v[116:119]
    s_waitcnt lgkmcnt(10)
    v_mfma_f32_16x16x32_bf16 v[48:51], v[160:163], v[124:127], v[48:51]
    ds_read_b64_tr_b16 v[212:213], v5 offset:53248
    v_mfma_f32_16x16x32_bf16 v[84:87], v[124:127], v[164:167], v[84:87]
    ds_read_b64_tr_b16 v[214:215], v5 offset:54272
    v_mfma_f32_16x16x32_bf16 v[12:15], v[156:159], v[124:127], v[12:15]
    ds_read_b64_tr_b16 v[204:205], v3 offset:53248
    s_waitcnt lgkmcnt(12)
    v_mfma_f32_16x16x32_bf16 v[52:55], v[160:163], v[128:131], v[52:55]
    v_mfma_f32_16x16x32_bf16 v[88:91], v[128:131], v[164:167], v[88:91]
    ds_read_b64_tr_b16 v[206:207], v3 offset:54272
    v_mfma_f32_16x16x32_bf16 v[16:19], v[156:159], v[128:131], v[16:19]
    ds_read_b128 v[172:175], v2 offset:38912
    s_waitcnt lgkmcnt(13)
    v_mfma_f32_16x16x32_bf16 v[56:59], v[160:163], v[132:135], v[56:59]
    ds_read_b128 v[176:179], v2 offset:40960
    v_mfma_f32_16x16x32_bf16 v[92:95], v[132:135], v[164:167], v[92:95]
    v_mfma_f32_16x16x32_bf16 v[20:23], v[156:159], v[132:135], v[20:23]
    ds_read_b128 v[180:183], v2 offset:43008
    s_waitcnt lgkmcnt(14)
    v_mfma_f32_16x16x32_bf16 v[60:63], v[160:163], v[136:139], v[60:63]
    ds_read_b128 v[184:187], v2 offset:45056
    v_mfma_f32_16x16x32_bf16 v[96:99], v[136:139], v[164:167], v[96:99]
    ds_read_b128 v[188:191], v2 offset:47104
    v_mfma_f32_16x16x32_bf16 v[24:27], v[156:159], v[136:139], v[24:27]
    s_waitcnt lgkmcnt(15)
    v_mfma_f32_16x16x32_bf16 v[64:67], v[160:163], v[140:143], v[64:67]
    ds_read_b128 v[192:195], v2 offset:49152
    v_mfma_f32_16x16x32_bf16 v[100:103], v[140:143], v[164:167], v[100:103]
    ds_read_b128 v[196:199], v2 offset:51200
    v_mfma_f32_16x16x32_bf16 v[28:31], v[156:159], v[140:143], v[28:31]
    ds_read_b128 v[200:203], v2 offset:53248
    s_waitcnt lgkmcnt(15)
    v_mfma_f32_16x16x32_bf16 v[68:71], v[160:163], v[144:147], v[68:71]
    v_mfma_f32_16x16x32_bf16 v[104:107], v[144:147], v[164:167], v[104:107]
    v_mfma_f32_16x16x32_bf16 v[32:35], v[156:159], v[144:147], v[32:35]
    v_mfma_f32_16x16x32_bf16 v[72:75], v[160:163], v[148:151], v[72:75]
    v_mfma_f32_16x16x32_bf16 v[108:111], v[148:151], v[164:167], v[108:111]
    v_mfma_f32_16x16x32_bf16 v[36:39], v[156:159], v[148:151], v[36:39]
    v_mfma_f32_16x16x32_bf16 v[76:79], v[160:163], v[152:155], v[76:79]
    v_mfma_f32_16x16x32_bf16 v[112:115], v[152:155], v[164:167], v[112:115]
    v_mfma_f32_16x16x32_bf16 v[40:43], v[156:159], v[152:155], v[40:43]
    s_waitcnt lgkmcnt(12)
    v_mfma_f32_16x16x32_bf16 v[44:47], v[208:211], v[168:171], v[44:47]
    s_waitcnt lgkmcnt(10)
    v_mfma_f32_16x16x32_bf16 v[80:83], v[168:171], v[212:215], v[80:83]
    s_waitcnt lgkmcnt(8)
    v_mfma_f32_16x16x32_bf16 v[116:119], v[204:207], v[8:11], v[116:119]
    s_waitcnt lgkmcnt(7)
    v_mfma_f32_16x16x32_bf16 v[48:51], v[208:211], v[172:175], v[48:51]
    v_mfma_f32_16x16x32_bf16 v[84:87], v[172:175], v[212:215], v[84:87]
    s_waitcnt lgkmcnt(0)
    s_barrier
    ds_read_b64_tr_b16 v[160:161], v4 offset:0
    v_mfma_f32_16x16x32_bf16 v[12:15], v[204:207], v[172:175], v[12:15]
    ds_read_b64_tr_b16 v[162:163], v4 offset:1024
    v_mfma_f32_16x16x32_bf16 v[52:55], v[208:211], v[176:179], v[52:55]
    ds_read_b128 v[120:123], v1 offset:0
    v_mfma_f32_16x16x32_bf16 v[88:91], v[176:179], v[212:215], v[88:91]
    ds_read_b64_tr_b16 v[164:165], v5 offset:0
    v_mfma_f32_16x16x32_bf16 v[16:19], v[204:207], v[176:179], v[16:19]
    v_mfma_f32_16x16x32_bf16 v[56:59], v[208:211], v[180:183], v[56:59]
    ds_read_b64_tr_b16 v[166:167], v5 offset:1024
    v_mfma_f32_16x16x32_bf16 v[92:95], v[180:183], v[212:215], v[92:95]
    ds_read_b64_tr_b16 v[156:157], v3 offset:0
    v_mfma_f32_16x16x32_bf16 v[20:23], v[204:207], v[180:183], v[20:23]
    ds_read_b64_tr_b16 v[158:159], v3 offset:1024
    v_mfma_f32_16x16x32_bf16 v[60:63], v[208:211], v[184:187], v[60:63]
    v_mfma_f32_16x16x32_bf16 v[96:99], v[184:187], v[212:215], v[96:99]
    ds_read_b128 v[124:127], v1 offset:2048
    v_mfma_f32_16x16x32_bf16 v[24:27], v[204:207], v[184:187], v[24:27]
    ds_read_b128 v[128:131], v1 offset:4096
    v_mfma_f32_16x16x32_bf16 v[64:67], v[208:211], v[188:191], v[64:67]
    ds_read_b128 v[132:135], v1 offset:6144
    v_mfma_f32_16x16x32_bf16 v[100:103], v[188:191], v[212:215], v[100:103]
    v_mfma_f32_16x16x32_bf16 v[28:31], v[204:207], v[188:191], v[28:31]
    ds_read_b128 v[136:139], v1 offset:8192
    v_mfma_f32_16x16x32_bf16 v[68:71], v[208:211], v[192:195], v[68:71]
    ds_read_b128 v[140:143], v1 offset:10240
    v_mfma_f32_16x16x32_bf16 v[104:107], v[192:195], v[212:215], v[104:107]
    ds_read_b128 v[144:147], v1 offset:12288
    v_mfma_f32_16x16x32_bf16 v[32:35], v[204:207], v[192:195], v[32:35]
    v_mfma_f32_16x16x32_bf16 v[72:75], v[208:211], v[196:199], v[72:75]
    ds_read_b128 v[148:151], v1 offset:14336
    v_mfma_f32_16x16x32_bf16 v[108:111], v[196:199], v[212:215], v[108:111]
    ds_read_b128 v[152:155], v1 offset:16384
    v_mfma_f32_16x16x32_bf16 v[36:39], v[204:207], v[196:199], v[36:39]
    v_mfma_f32_16x16x32_bf16 v[76:79], v[208:211], v[200:203], v[76:79]
    v_mfma_f32_16x16x32_bf16 v[112:115], v[200:203], v[212:215], v[112:115]
    v_mfma_f32_16x16x32_bf16 v[40:43], v[204:207], v[200:203], v[40:43]
    ds_read_b64_tr_b16 v[208:209], v4 offset:4096
    s_waitcnt lgkmcnt(13)
    v_mfma_f32_16x16x32_bf16 v[44:47], v[160:163], v[120:123], v[44:47]
    ds_read_b64_tr_b16 v[210:211], v4 offset:5120
    s_waitcnt lgkmcnt(12)
    v_mfma_f32_16x16x32_bf16 v[80:83], v[120:123], v[164:167], v[80:83]
    ds_read_b128 v[168:171], v2 offset:0
    s_waitcnt lgkmcnt(11)
    v_mfma_f32_16x16x32_bf16 v[116:119], v[156:159], v[8:11], v[116:119]
    s_waitcnt lgkmcnt(10)
    v_mfma_f32_16x16x32_bf16 v[48:51], v[160:163], v[124:127], v[48:51]
    ds_read_b64_tr_b16 v[212:213], v5 offset:4096
    v_mfma_f32_16x16x32_bf16 v[84:87], v[124:127], v[164:167], v[84:87]
    ds_read_b64_tr_b16 v[214:215], v5 offset:5120
    v_mfma_f32_16x16x32_bf16 v[12:15], v[156:159], v[124:127], v[12:15]
    ds_read_b64_tr_b16 v[204:205], v3 offset:4096
    s_waitcnt lgkmcnt(12)
    v_mfma_f32_16x16x32_bf16 v[52:55], v[160:163], v[128:131], v[52:55]
    v_mfma_f32_16x16x32_bf16 v[88:91], v[128:131], v[164:167], v[88:91]
    ds_read_b64_tr_b16 v[206:207], v3 offset:5120
    v_mfma_f32_16x16x32_bf16 v[16:19], v[156:159], v[128:131], v[16:19]
    ds_read_b128 v[172:175], v2 offset:2048
    s_waitcnt lgkmcnt(13)
    v_mfma_f32_16x16x32_bf16 v[56:59], v[160:163], v[132:135], v[56:59]
    ds_read_b128 v[176:179], v2 offset:4096
    v_mfma_f32_16x16x32_bf16 v[92:95], v[132:135], v[164:167], v[92:95]
    v_mfma_f32_16x16x32_bf16 v[20:23], v[156:159], v[132:135], v[20:23]
    ds_read_b128 v[180:183], v2 offset:6144
    s_waitcnt lgkmcnt(14)
    v_mfma_f32_16x16x32_bf16 v[60:63], v[160:163], v[136:139], v[60:63]
    ds_read_b128 v[184:187], v2 offset:8192
    v_mfma_f32_16x16x32_bf16 v[96:99], v[136:139], v[164:167], v[96:99]
    ds_read_b128 v[188:191], v2 offset:10240
    v_mfma_f32_16x16x32_bf16 v[24:27], v[156:159], v[136:139], v[24:27]
    s_waitcnt lgkmcnt(15)
    v_mfma_f32_16x16x32_bf16 v[64:67], v[160:163], v[140:143], v[64:67]
    ds_read_b128 v[192:195], v2 offset:12288
    v_mfma_f32_16x16x32_bf16 v[100:103], v[140:143], v[164:167], v[100:103]
    ds_read_b128 v[196:199], v2 offset:14336
    v_mfma_f32_16x16x32_bf16 v[28:31], v[156:159], v[140:143], v[28:31]
    ds_read_b128 v[200:203], v2 offset:16384
    s_waitcnt lgkmcnt(15)
    v_mfma_f32_16x16x32_bf16 v[68:71], v[160:163], v[144:147], v[68:71]
    v_mfma_f32_16x16x32_bf16 v[104:107], v[144:147], v[164:167], v[104:107]
    v_mfma_f32_16x16x32_bf16 v[32:35], v[156:159], v[144:147], v[32:35]
    v_mfma_f32_16x16x32_bf16 v[72:75], v[160:163], v[148:151], v[72:75]
    v_mfma_f32_16x16x32_bf16 v[108:111], v[148:151], v[164:167], v[108:111]
    v_mfma_f32_16x16x32_bf16 v[36:39], v[156:159], v[148:151], v[36:39]
    v_mfma_f32_16x16x32_bf16 v[76:79], v[160:163], v[152:155], v[76:79]
    v_mfma_f32_16x16x32_bf16 v[112:115], v[152:155], v[164:167], v[112:115]
    v_mfma_f32_16x16x32_bf16 v[40:43], v[156:159], v[152:155], v[40:43]
    s_waitcnt lgkmcnt(12)
    v_mfma_f32_16x16x32_bf16 v[44:47], v[208:211], v[168:171], v[44:47]
    s_waitcnt lgkmcnt(10)
    v_mfma_f32_16x16x32_bf16 v[80:83], v[168:171], v[212:215], v[80:83]
    s_waitcnt lgkmcnt(8)
    v_mfma_f32_16x16x32_bf16 v[116:119], v[204:207], v[8:11], v[116:119]
    s_waitcnt lgkmcnt(7)
    v_mfma_f32_16x16x32_bf16 v[48:51], v[208:211], v[172:175], v[48:51]
    v_mfma_f32_16x16x32_bf16 v[84:87], v[172:175], v[212:215], v[84:87]
    s_waitcnt lgkmcnt(0)
    s_barrier
    ds_read_b64_tr_b16 v[160:161], v4 offset:24576
    v_mfma_f32_16x16x32_bf16 v[12:15], v[204:207], v[172:175], v[12:15]
    ds_read_b64_tr_b16 v[162:163], v4 offset:25600
    v_mfma_f32_16x16x32_bf16 v[52:55], v[208:211], v[176:179], v[52:55]
    ds_read_b128 v[120:123], v1 offset:18432
    v_mfma_f32_16x16x32_bf16 v[88:91], v[176:179], v[212:215], v[88:91]
    ds_read_b64_tr_b16 v[164:165], v5 offset:24576
    v_mfma_f32_16x16x32_bf16 v[16:19], v[204:207], v[176:179], v[16:19]
    v_mfma_f32_16x16x32_bf16 v[56:59], v[208:211], v[180:183], v[56:59]
    ds_read_b64_tr_b16 v[166:167], v5 offset:25600
    v_mfma_f32_16x16x32_bf16 v[92:95], v[180:183], v[212:215], v[92:95]
    ds_read_b64_tr_b16 v[156:157], v3 offset:24576
    v_mfma_f32_16x16x32_bf16 v[20:23], v[204:207], v[180:183], v[20:23]
    ds_read_b64_tr_b16 v[158:159], v3 offset:25600
    v_mfma_f32_16x16x32_bf16 v[60:63], v[208:211], v[184:187], v[60:63]
    v_mfma_f32_16x16x32_bf16 v[96:99], v[184:187], v[212:215], v[96:99]
    ds_read_b128 v[124:127], v1 offset:20480
    v_mfma_f32_16x16x32_bf16 v[24:27], v[204:207], v[184:187], v[24:27]
    ds_read_b128 v[128:131], v1 offset:22528
    v_mfma_f32_16x16x32_bf16 v[64:67], v[208:211], v[188:191], v[64:67]
    ds_read_b128 v[132:135], v1 offset:24576
    v_mfma_f32_16x16x32_bf16 v[100:103], v[188:191], v[212:215], v[100:103]
    v_mfma_f32_16x16x32_bf16 v[28:31], v[204:207], v[188:191], v[28:31]
    ds_read_b128 v[136:139], v1 offset:26624
    v_mfma_f32_16x16x32_bf16 v[68:71], v[208:211], v[192:195], v[68:71]
    ds_read_b128 v[140:143], v1 offset:28672
    v_mfma_f32_16x16x32_bf16 v[104:107], v[192:195], v[212:215], v[104:107]
    ds_read_b128 v[144:147], v1 offset:30720
    v_mfma_f32_16x16x32_bf16 v[32:35], v[204:207], v[192:195], v[32:35]
    v_mfma_f32_16x16x32_bf16 v[72:75], v[208:211], v[196:199], v[72:75]
    ds_read_b128 v[148:151], v1 offset:32768
    v_mfma_f32_16x16x32_bf16 v[108:111], v[196:199], v[212:215], v[108:111]
    ds_read_b128 v[152:155], v1 offset:34816
    v_mfma_f32_16x16x32_bf16 v[36:39], v[204:207], v[196:199], v[36:39]
    v_mfma_f32_16x16x32_bf16 v[76:79], v[208:211], v[200:203], v[76:79]
    v_mfma_f32_16x16x32_bf16 v[112:115], v[200:203], v[212:215], v[112:115]
    v_mfma_f32_16x16x32_bf16 v[40:43], v[204:207], v[200:203], v[40:43]
    ds_read_b64_tr_b16 v[208:209], v4 offset:28672
    s_waitcnt lgkmcnt(13)
    v_mfma_f32_16x16x32_bf16 v[44:47], v[160:163], v[120:123], v[44:47]
    ds_read_b64_tr_b16 v[210:211], v4 offset:29696
    s_waitcnt lgkmcnt(12)
    v_mfma_f32_16x16x32_bf16 v[80:83], v[120:123], v[164:167], v[80:83]
    ds_read_b128 v[168:171], v2 offset:18432
    s_waitcnt lgkmcnt(11)
    v_mfma_f32_16x16x32_bf16 v[116:119], v[156:159], v[8:11], v[116:119]
    s_waitcnt lgkmcnt(10)
    v_mfma_f32_16x16x32_bf16 v[48:51], v[160:163], v[124:127], v[48:51]
    ds_read_b64_tr_b16 v[212:213], v5 offset:28672
    v_mfma_f32_16x16x32_bf16 v[84:87], v[124:127], v[164:167], v[84:87]
    ds_read_b64_tr_b16 v[214:215], v5 offset:29696
    v_mfma_f32_16x16x32_bf16 v[12:15], v[156:159], v[124:127], v[12:15]
    ds_read_b64_tr_b16 v[204:205], v3 offset:28672
    s_waitcnt lgkmcnt(12)
    v_mfma_f32_16x16x32_bf16 v[52:55], v[160:163], v[128:131], v[52:55]
    v_mfma_f32_16x16x32_bf16 v[88:91], v[128:131], v[164:167], v[88:91]
    ds_read_b64_tr_b16 v[206:207], v3 offset:29696
    v_mfma_f32_16x16x32_bf16 v[16:19], v[156:159], v[128:131], v[16:19]
    ds_read_b128 v[172:175], v2 offset:20480
    s_waitcnt lgkmcnt(13)
    v_mfma_f32_16x16x32_bf16 v[56:59], v[160:163], v[132:135], v[56:59]
    ds_read_b128 v[176:179], v2 offset:22528
    v_mfma_f32_16x16x32_bf16 v[92:95], v[132:135], v[164:167], v[92:95]
    v_mfma_f32_16x16x32_bf16 v[20:23], v[156:159], v[132:135], v[20:23]
    ds_read_b128 v[180:183], v2 offset:24576
    s_waitcnt lgkmcnt(14)
    v_mfma_f32_16x16x32_bf16 v[60:63], v[160:163], v[136:139], v[60:63]
    ds_read_b128 v[184:187], v2 offset:26624
    v_mfma_f32_16x16x32_bf16 v[96:99], v[136:139], v[164:167], v[96:99]
    ds_read_b128 v[188:191], v2 offset:28672
    v_mfma_f32_16x16x32_bf16 v[24:27], v[156:159], v[136:139], v[24:27]
    s_waitcnt lgkmcnt(15)
    v_mfma_f32_16x16x32_bf16 v[64:67], v[160:163], v[140:143], v[64:67]
    ds_read_b128 v[192:195], v2 offset:30720
    v_mfma_f32_16x16x32_bf16 v[100:103], v[140:143], v[164:167], v[100:103]
    ds_read_b128 v[196:199], v2 offset:32768
    v_mfma_f32_16x16x32_bf16 v[28:31], v[156:159], v[140:143], v[28:31]
    ds_read_b128 v[200:203], v2 offset:34816
    s_waitcnt lgkmcnt(15)
    v_mfma_f32_16x16x32_bf16 v[68:71], v[160:163], v[144:147], v[68:71]
    v_mfma_f32_16x16x32_bf16 v[104:107], v[144:147], v[164:167], v[104:107]
    v_mfma_f32_16x16x32_bf16 v[32:35], v[156:159], v[144:147], v[32:35]
    v_mfma_f32_16x16x32_bf16 v[72:75], v[160:163], v[148:151], v[72:75]
    v_mfma_f32_16x16x32_bf16 v[108:111], v[148:151], v[164:167], v[108:111]
    v_mfma_f32_16x16x32_bf16 v[36:39], v[156:159], v[148:151], v[36:39]
    v_mfma_f32_16x16x32_bf16 v[76:79], v[160:163], v[152:155], v[76:79]
    v_mfma_f32_16x16x32_bf16 v[112:115], v[152:155], v[164:167], v[112:115]
    v_mfma_f32_16x16x32_bf16 v[40:43], v[156:159], v[152:155], v[40:43]
    s_waitcnt lgkmcnt(12)
    v_mfma_f32_16x16x32_bf16 v[44:47], v[208:211], v[168:171], v[44:47]
    s_waitcnt lgkmcnt(10)
    v_mfma_f32_16x16x32_bf16 v[80:83], v[168:171], v[212:215], v[80:83]
    s_waitcnt lgkmcnt(8)
    v_mfma_f32_16x16x32_bf16 v[116:119], v[204:207], v[8:11], v[116:119]
    s_waitcnt lgkmcnt(7)
    v_mfma_f32_16x16x32_bf16 v[48:51], v[208:211], v[172:175], v[48:51]
    v_mfma_f32_16x16x32_bf16 v[84:87], v[172:175], v[212:215], v[84:87]
    s_waitcnt lgkmcnt(0)
    s_barrier
    ds_read_b64_tr_b16 v[160:161], v4 offset:49152
    v_mfma_f32_16x16x32_bf16 v[12:15], v[204:207], v[172:175], v[12:15]
    ds_read_b64_tr_b16 v[162:163], v4 offset:50176
    v_mfma_f32_16x16x32_bf16 v[52:55], v[208:211], v[176:179], v[52:55]
    ds_read_b128 v[120:123], v1 offset:36864
    v_mfma_f32_16x16x32_bf16 v[88:91], v[176:179], v[212:215], v[88:91]
    ds_read_b64_tr_b16 v[164:165], v5 offset:49152
    v_mfma_f32_16x16x32_bf16 v[16:19], v[204:207], v[176:179], v[16:19]
    v_mfma_f32_16x16x32_bf16 v[56:59], v[208:211], v[180:183], v[56:59]
    ds_read_b64_tr_b16 v[166:167], v5 offset:50176
    v_mfma_f32_16x16x32_bf16 v[92:95], v[180:183], v[212:215], v[92:95]
    ds_read_b64_tr_b16 v[156:157], v3 offset:49152
    v_mfma_f32_16x16x32_bf16 v[20:23], v[204:207], v[180:183], v[20:23]
    ds_read_b64_tr_b16 v[158:159], v3 offset:50176
    v_mfma_f32_16x16x32_bf16 v[60:63], v[208:211], v[184:187], v[60:63]
    v_mfma_f32_16x16x32_bf16 v[96:99], v[184:187], v[212:215], v[96:99]
    ds_read_b128 v[124:127], v1 offset:38912
    v_mfma_f32_16x16x32_bf16 v[24:27], v[204:207], v[184:187], v[24:27]
    ds_read_b128 v[128:131], v1 offset:40960
    v_mfma_f32_16x16x32_bf16 v[64:67], v[208:211], v[188:191], v[64:67]
    ds_read_b128 v[132:135], v1 offset:43008
    v_mfma_f32_16x16x32_bf16 v[100:103], v[188:191], v[212:215], v[100:103]
    v_mfma_f32_16x16x32_bf16 v[28:31], v[204:207], v[188:191], v[28:31]
    ds_read_b128 v[136:139], v1 offset:45056
    v_mfma_f32_16x16x32_bf16 v[68:71], v[208:211], v[192:195], v[68:71]
    ds_read_b128 v[140:143], v1 offset:47104
    v_mfma_f32_16x16x32_bf16 v[104:107], v[192:195], v[212:215], v[104:107]
    ds_read_b128 v[144:147], v1 offset:49152
    v_mfma_f32_16x16x32_bf16 v[32:35], v[204:207], v[192:195], v[32:35]
    v_mfma_f32_16x16x32_bf16 v[72:75], v[208:211], v[196:199], v[72:75]
    ds_read_b128 v[148:151], v1 offset:51200
    v_mfma_f32_16x16x32_bf16 v[108:111], v[196:199], v[212:215], v[108:111]
    ds_read_b128 v[152:155], v1 offset:53248
    v_mfma_f32_16x16x32_bf16 v[36:39], v[204:207], v[196:199], v[36:39]
    v_mfma_f32_16x16x32_bf16 v[76:79], v[208:211], v[200:203], v[76:79]
    v_mfma_f32_16x16x32_bf16 v[112:115], v[200:203], v[212:215], v[112:115]
    v_mfma_f32_16x16x32_bf16 v[40:43], v[204:207], v[200:203], v[40:43]
    ds_read_b64_tr_b16 v[208:209], v4 offset:53248
    s_waitcnt lgkmcnt(13)
    v_mfma_f32_16x16x32_bf16 v[44:47], v[160:163], v[120:123], v[44:47]
    ds_read_b64_tr_b16 v[210:211], v4 offset:54272
    s_waitcnt lgkmcnt(12)
    v_mfma_f32_16x16x32_bf16 v[80:83], v[120:123], v[164:167], v[80:83]
    ds_read_b128 v[168:171], v2 offset:36864
    s_waitcnt lgkmcnt(11)
    v_mfma_f32_16x16x32_bf16 v[116:119], v[156:159], v[8:11], v[116:119]
    s_waitcnt lgkmcnt(10)
    v_mfma_f32_16x16x32_bf16 v[48:51], v[160:163], v[124:127], v[48:51]
    ds_read_b64_tr_b16 v[212:213], v5 offset:53248
    v_mfma_f32_16x16x32_bf16 v[84:87], v[124:127], v[164:167], v[84:87]
    ds_read_b64_tr_b16 v[214:215], v5 offset:54272
    v_mfma_f32_16x16x32_bf16 v[12:15], v[156:159], v[124:127], v[12:15]
    ds_read_b64_tr_b16 v[204:205], v3 offset:53248
    s_waitcnt lgkmcnt(12)
    v_mfma_f32_16x16x32_bf16 v[52:55], v[160:163], v[128:131], v[52:55]
    v_mfma_f32_16x16x32_bf16 v[88:91], v[128:131], v[164:167], v[88:91]
    ds_read_b64_tr_b16 v[206:207], v3 offset:54272
    v_mfma_f32_16x16x32_bf16 v[16:19], v[156:159], v[128:131], v[16:19]
    ds_read_b128 v[172:175], v2 offset:38912
    s_waitcnt lgkmcnt(13)
    v_mfma_f32_16x16x32_bf16 v[56:59], v[160:163], v[132:135], v[56:59]
    ds_read_b128 v[176:179], v2 offset:40960
    v_mfma_f32_16x16x32_bf16 v[92:95], v[132:135], v[164:167], v[92:95]
    v_mfma_f32_16x16x32_bf16 v[20:23], v[156:159], v[132:135], v[20:23]
    ds_read_b128 v[180:183], v2 offset:43008
    s_waitcnt lgkmcnt(14)
    v_mfma_f32_16x16x32_bf16 v[60:63], v[160:163], v[136:139], v[60:63]
    ds_read_b128 v[184:187], v2 offset:45056
    v_mfma_f32_16x16x32_bf16 v[96:99], v[136:139], v[164:167], v[96:99]
    ds_read_b128 v[188:191], v2 offset:47104
    v_mfma_f32_16x16x32_bf16 v[24:27], v[156:159], v[136:139], v[24:27]
    s_waitcnt lgkmcnt(15)
    v_mfma_f32_16x16x32_bf16 v[64:67], v[160:163], v[140:143], v[64:67]
    ds_read_b128 v[192:195], v2 offset:49152
    v_mfma_f32_16x16x32_bf16 v[100:103], v[140:143], v[164:167], v[100:103]
    ds_read_b128 v[196:199], v2 offset:51200
    v_mfma_f32_16x16x32_bf16 v[28:31], v[156:159], v[140:143], v[28:31]
    ds_read_b128 v[200:203], v2 offset:53248
    s_waitcnt lgkmcnt(15)
    v_mfma_f32_16x16x32_bf16 v[68:71], v[160:163], v[144:147], v[68:71]
    v_mfma_f32_16x16x32_bf16 v[104:107], v[144:147], v[164:167], v[104:107]
    v_mfma_f32_16x16x32_bf16 v[32:35], v[156:159], v[144:147], v[32:35]
    v_mfma_f32_16x16x32_bf16 v[72:75], v[160:163], v[148:151], v[72:75]
    v_mfma_f32_16x16x32_bf16 v[108:111], v[148:151], v[164:167], v[108:111]
    v_mfma_f32_16x16x32_bf16 v[36:39], v[156:159], v[148:151], v[36:39]
    v_mfma_f32_16x16x32_bf16 v[76:79], v[160:163], v[152:155], v[76:79]
    v_mfma_f32_16x16x32_bf16 v[112:115], v[152:155], v[164:167], v[112:115]
    v_mfma_f32_16x16x32_bf16 v[40:43], v[156:159], v[152:155], v[40:43]
    s_waitcnt lgkmcnt(12)
    v_mfma_f32_16x16x32_bf16 v[44:47], v[208:211], v[168:171], v[44:47]
    s_waitcnt lgkmcnt(10)
    v_mfma_f32_16x16x32_bf16 v[80:83], v[168:171], v[212:215], v[80:83]
    s_waitcnt lgkmcnt(8)
    v_mfma_f32_16x16x32_bf16 v[116:119], v[204:207], v[8:11], v[116:119]
    s_waitcnt lgkmcnt(7)
    v_mfma_f32_16x16x32_bf16 v[48:51], v[208:211], v[172:175], v[48:51]
    v_mfma_f32_16x16x32_bf16 v[84:87], v[172:175], v[212:215], v[84:87]
    s_waitcnt lgkmcnt(0)
    s_barrier
    ds_read_b64_tr_b16 v[160:161], v4 offset:0
    v_mfma_f32_16x16x32_bf16 v[12:15], v[204:207], v[172:175], v[12:15]
    ds_read_b64_tr_b16 v[162:163], v4 offset:1024
    v_mfma_f32_16x16x32_bf16 v[52:55], v[208:211], v[176:179], v[52:55]
    ds_read_b128 v[120:123], v1 offset:0
    v_mfma_f32_16x16x32_bf16 v[88:91], v[176:179], v[212:215], v[88:91]
    ds_read_b64_tr_b16 v[164:165], v5 offset:0
    v_mfma_f32_16x16x32_bf16 v[16:19], v[204:207], v[176:179], v[16:19]
    v_mfma_f32_16x16x32_bf16 v[56:59], v[208:211], v[180:183], v[56:59]
    ds_read_b64_tr_b16 v[166:167], v5 offset:1024
    v_mfma_f32_16x16x32_bf16 v[92:95], v[180:183], v[212:215], v[92:95]
    ds_read_b64_tr_b16 v[156:157], v3 offset:0
    v_mfma_f32_16x16x32_bf16 v[20:23], v[204:207], v[180:183], v[20:23]
    ds_read_b64_tr_b16 v[158:159], v3 offset:1024
    v_mfma_f32_16x16x32_bf16 v[60:63], v[208:211], v[184:187], v[60:63]
    v_mfma_f32_16x16x32_bf16 v[96:99], v[184:187], v[212:215], v[96:99]
    ds_read_b128 v[124:127], v1 offset:2048
    v_mfma_f32_16x16x32_bf16 v[24:27], v[204:207], v[184:187], v[24:27]
    ds_read_b128 v[128:131], v1 offset:4096
    v_mfma_f32_16x16x32_bf16 v[64:67], v[208:211], v[188:191], v[64:67]
    ds_read_b128 v[132:135], v1 offset:6144
    v_mfma_f32_16x16x32_bf16 v[100:103], v[188:191], v[212:215], v[100:103]
    v_mfma_f32_16x16x32_bf16 v[28:31], v[204:207], v[188:191], v[28:31]
    ds_read_b128 v[136:139], v1 offset:8192
    v_mfma_f32_16x16x32_bf16 v[68:71], v[208:211], v[192:195], v[68:71]
    ds_read_b128 v[140:143], v1 offset:10240
    v_mfma_f32_16x16x32_bf16 v[104:107], v[192:195], v[212:215], v[104:107]
    ds_read_b128 v[144:147], v1 offset:12288
    v_mfma_f32_16x16x32_bf16 v[32:35], v[204:207], v[192:195], v[32:35]
    v_mfma_f32_16x16x32_bf16 v[72:75], v[208:211], v[196:199], v[72:75]
    ds_read_b128 v[148:151], v1 offset:14336
    v_mfma_f32_16x16x32_bf16 v[108:111], v[196:199], v[212:215], v[108:111]
    ds_read_b128 v[152:155], v1 offset:16384
    v_mfma_f32_16x16x32_bf16 v[36:39], v[204:207], v[196:199], v[36:39]
    v_mfma_f32_16x16x32_bf16 v[76:79], v[208:211], v[200:203], v[76:79]
    v_mfma_f32_16x16x32_bf16 v[112:115], v[200:203], v[212:215], v[112:115]
    v_mfma_f32_16x16x32_bf16 v[40:43], v[204:207], v[200:203], v[40:43]
    s_waitcnt vmcnt(0)
    ds_read_b64_tr_b16 v[208:209], v4 offset:4096
    s_waitcnt lgkmcnt(13)
    v_mfma_f32_16x16x32_bf16 v[44:47], v[160:163], v[120:123], v[44:47]
    ds_read_b64_tr_b16 v[210:211], v4 offset:5120
    s_waitcnt lgkmcnt(12)
    v_mfma_f32_16x16x32_bf16 v[80:83], v[120:123], v[164:167], v[80:83]
    ds_read_b128 v[168:171], v2 offset:0
    s_waitcnt lgkmcnt(11)
    v_mfma_f32_16x16x32_bf16 v[116:119], v[156:159], v[8:11], v[116:119]
    s_waitcnt lgkmcnt(10)
    v_mfma_f32_16x16x32_bf16 v[48:51], v[160:163], v[124:127], v[48:51]
    ds_read_b64_tr_b16 v[212:213], v5 offset:4096
    v_mfma_f32_16x16x32_bf16 v[84:87], v[124:127], v[164:167], v[84:87]
    ds_read_b64_tr_b16 v[214:215], v5 offset:5120
    v_mfma_f32_16x16x32_bf16 v[12:15], v[156:159], v[124:127], v[12:15]
    ds_read_b64_tr_b16 v[204:205], v3 offset:4096
    s_waitcnt lgkmcnt(12)
    v_mfma_f32_16x16x32_bf16 v[52:55], v[160:163], v[128:131], v[52:55]
    v_mfma_f32_16x16x32_bf16 v[88:91], v[128:131], v[164:167], v[88:91]
    ds_read_b64_tr_b16 v[206:207], v3 offset:5120
    v_mfma_f32_16x16x32_bf16 v[16:19], v[156:159], v[128:131], v[16:19]
    ds_read_b128 v[172:175], v2 offset:2048
    s_waitcnt lgkmcnt(13)
    v_mfma_f32_16x16x32_bf16 v[56:59], v[160:163], v[132:135], v[56:59]
    ds_read_b128 v[176:179], v2 offset:4096
    v_mfma_f32_16x16x32_bf16 v[92:95], v[132:135], v[164:167], v[92:95]
    v_mfma_f32_16x16x32_bf16 v[20:23], v[156:159], v[132:135], v[20:23]
    ds_read_b128 v[180:183], v2 offset:6144
    s_waitcnt lgkmcnt(14)
    v_mfma_f32_16x16x32_bf16 v[60:63], v[160:163], v[136:139], v[60:63]
    ds_read_b128 v[184:187], v2 offset:8192
    v_mfma_f32_16x16x32_bf16 v[96:99], v[136:139], v[164:167], v[96:99]
    ds_read_b128 v[188:191], v2 offset:10240
    v_mfma_f32_16x16x32_bf16 v[24:27], v[156:159], v[136:139], v[24:27]
    s_waitcnt lgkmcnt(15)
    v_mfma_f32_16x16x32_bf16 v[64:67], v[160:163], v[140:143], v[64:67]
    ds_read_b128 v[192:195], v2 offset:12288
    v_mfma_f32_16x16x32_bf16 v[100:103], v[140:143], v[164:167], v[100:103]
    ds_read_b128 v[196:199], v2 offset:14336
    v_mfma_f32_16x16x32_bf16 v[28:31], v[156:159], v[140:143], v[28:31]
    ds_read_b128 v[200:203], v2 offset:16384
    s_waitcnt lgkmcnt(15)
    v_mfma_f32_16x16x32_bf16 v[68:71], v[160:163], v[144:147], v[68:71]
    v_mfma_f32_16x16x32_bf16 v[104:107], v[144:147], v[164:167], v[104:107]
    v_mfma_f32_16x16x32_bf16 v[32:35], v[156:159], v[144:147], v[32:35]
    v_mfma_f32_16x16x32_bf16 v[72:75], v[160:163], v[148:151], v[72:75]
    v_mfma_f32_16x16x32_bf16 v[108:111], v[148:151], v[164:167], v[108:111]
    v_mfma_f32_16x16x32_bf16 v[36:39], v[156:159], v[148:151], v[36:39]
    v_mfma_f32_16x16x32_bf16 v[76:79], v[160:163], v[152:155], v[76:79]
    v_mfma_f32_16x16x32_bf16 v[112:115], v[152:155], v[164:167], v[112:115]
    v_mfma_f32_16x16x32_bf16 v[40:43], v[156:159], v[152:155], v[40:43]
    s_waitcnt lgkmcnt(12)
    v_mfma_f32_16x16x32_bf16 v[44:47], v[208:211], v[168:171], v[44:47]
    s_waitcnt lgkmcnt(10)
    v_mfma_f32_16x16x32_bf16 v[80:83], v[168:171], v[212:215], v[80:83]
    s_waitcnt lgkmcnt(8)
    v_mfma_f32_16x16x32_bf16 v[116:119], v[204:207], v[8:11], v[116:119]
    s_waitcnt lgkmcnt(7)
    v_mfma_f32_16x16x32_bf16 v[48:51], v[208:211], v[172:175], v[48:51]
    v_mfma_f32_16x16x32_bf16 v[84:87], v[172:175], v[212:215], v[84:87]
    s_waitcnt lgkmcnt(0)
    s_barrier
    ds_read_b64_tr_b16 v[160:161], v4 offset:24576
    v_mfma_f32_16x16x32_bf16 v[12:15], v[204:207], v[172:175], v[12:15]
    ds_read_b64_tr_b16 v[162:163], v4 offset:25600
    v_mfma_f32_16x16x32_bf16 v[52:55], v[208:211], v[176:179], v[52:55]
    ds_read_b128 v[120:123], v1 offset:18432
    v_mfma_f32_16x16x32_bf16 v[88:91], v[176:179], v[212:215], v[88:91]
    ds_read_b64_tr_b16 v[164:165], v5 offset:24576
    v_mfma_f32_16x16x32_bf16 v[16:19], v[204:207], v[176:179], v[16:19]
    v_mfma_f32_16x16x32_bf16 v[56:59], v[208:211], v[180:183], v[56:59]
    ds_read_b64_tr_b16 v[166:167], v5 offset:25600
    v_mfma_f32_16x16x32_bf16 v[92:95], v[180:183], v[212:215], v[92:95]
    ds_read_b64_tr_b16 v[156:157], v3 offset:24576
    v_mfma_f32_16x16x32_bf16 v[20:23], v[204:207], v[180:183], v[20:23]
    ds_read_b64_tr_b16 v[158:159], v3 offset:25600
    v_mfma_f32_16x16x32_bf16 v[60:63], v[208:211], v[184:187], v[60:63]
    v_mfma_f32_16x16x32_bf16 v[96:99], v[184:187], v[212:215], v[96:99]
    ds_read_b128 v[124:127], v1 offset:20480
    v_mfma_f32_16x16x32_bf16 v[24:27], v[204:207], v[184:187], v[24:27]
    ds_read_b128 v[128:131], v1 offset:22528
    v_mfma_f32_16x16x32_bf16 v[64:67], v[208:211], v[188:191], v[64:67]
    ds_read_b128 v[132:135], v1 offset:24576
    v_mfma_f32_16x16x32_bf16 v[100:103], v[188:191], v[212:215], v[100:103]
    v_mfma_f32_16x16x32_bf16 v[28:31], v[204:207], v[188:191], v[28:31]
    ds_read_b128 v[136:139], v1 offset:26624
    v_mfma_f32_16x16x32_bf16 v[68:71], v[208:211], v[192:195], v[68:71]
    ds_read_b128 v[140:143], v1 offset:28672
    v_mfma_f32_16x16x32_bf16 v[104:107], v[192:195], v[212:215], v[104:107]
    ds_read_b128 v[144:147], v1 offset:30720
    v_mfma_f32_16x16x32_bf16 v[32:35], v[204:207], v[192:195], v[32:35]
    v_mfma_f32_16x16x32_bf16 v[72:75], v[208:211], v[196:199], v[72:75]
    ds_read_b128 v[148:151], v1 offset:32768
    v_mfma_f32_16x16x32_bf16 v[108:111], v[196:199], v[212:215], v[108:111]
    ds_read_b128 v[152:155], v1 offset:34816
    v_mfma_f32_16x16x32_bf16 v[36:39], v[204:207], v[196:199], v[36:39]
    v_mfma_f32_16x16x32_bf16 v[76:79], v[208:211], v[200:203], v[76:79]
    v_mfma_f32_16x16x32_bf16 v[112:115], v[200:203], v[212:215], v[112:115]
    v_mfma_f32_16x16x32_bf16 v[40:43], v[204:207], v[200:203], v[40:43]
    ds_read_b64_tr_b16 v[208:209], v4 offset:28672
    s_waitcnt lgkmcnt(13)
    v_mfma_f32_16x16x32_bf16 v[44:47], v[160:163], v[120:123], v[44:47]
    ds_read_b64_tr_b16 v[210:211], v4 offset:29696
    s_waitcnt lgkmcnt(12)
    v_mfma_f32_16x16x32_bf16 v[80:83], v[120:123], v[164:167], v[80:83]
    ds_read_b128 v[168:171], v2 offset:18432
    s_waitcnt lgkmcnt(11)
    v_mfma_f32_16x16x32_bf16 v[116:119], v[156:159], v[8:11], v[116:119]
    s_waitcnt lgkmcnt(10)
    v_mfma_f32_16x16x32_bf16 v[48:51], v[160:163], v[124:127], v[48:51]
    ds_read_b64_tr_b16 v[212:213], v5 offset:28672
    v_mfma_f32_16x16x32_bf16 v[84:87], v[124:127], v[164:167], v[84:87]
    ds_read_b64_tr_b16 v[214:215], v5 offset:29696
    v_mfma_f32_16x16x32_bf16 v[12:15], v[156:159], v[124:127], v[12:15]
    ds_read_b64_tr_b16 v[204:205], v3 offset:28672
    s_waitcnt lgkmcnt(12)
    v_mfma_f32_16x16x32_bf16 v[52:55], v[160:163], v[128:131], v[52:55]
    v_mfma_f32_16x16x32_bf16 v[88:91], v[128:131], v[164:167], v[88:91]
    ds_read_b64_tr_b16 v[206:207], v3 offset:29696
    v_mfma_f32_16x16x32_bf16 v[16:19], v[156:159], v[128:131], v[16:19]
    ds_read_b128 v[172:175], v2 offset:20480
    s_waitcnt lgkmcnt(13)
    v_mfma_f32_16x16x32_bf16 v[56:59], v[160:163], v[132:135], v[56:59]
    ds_read_b128 v[176:179], v2 offset:22528
    v_mfma_f32_16x16x32_bf16 v[92:95], v[132:135], v[164:167], v[92:95]
    v_mfma_f32_16x16x32_bf16 v[20:23], v[156:159], v[132:135], v[20:23]
    ds_read_b128 v[180:183], v2 offset:24576
    s_waitcnt lgkmcnt(14)
    v_mfma_f32_16x16x32_bf16 v[60:63], v[160:163], v[136:139], v[60:63]
    ds_read_b128 v[184:187], v2 offset:26624
    v_mfma_f32_16x16x32_bf16 v[96:99], v[136:139], v[164:167], v[96:99]
    ds_read_b128 v[188:191], v2 offset:28672
    v_mfma_f32_16x16x32_bf16 v[24:27], v[156:159], v[136:139], v[24:27]
    s_waitcnt lgkmcnt(15)
    v_mfma_f32_16x16x32_bf16 v[64:67], v[160:163], v[140:143], v[64:67]
    ds_read_b128 v[192:195], v2 offset:30720
    v_mfma_f32_16x16x32_bf16 v[100:103], v[140:143], v[164:167], v[100:103]
    ds_read_b128 v[196:199], v2 offset:32768
    v_mfma_f32_16x16x32_bf16 v[28:31], v[156:159], v[140:143], v[28:31]
    ds_read_b128 v[200:203], v2 offset:34816
    s_waitcnt lgkmcnt(15)
    v_mfma_f32_16x16x32_bf16 v[68:71], v[160:163], v[144:147], v[68:71]
    v_mfma_f32_16x16x32_bf16 v[104:107], v[144:147], v[164:167], v[104:107]
    v_mfma_f32_16x16x32_bf16 v[32:35], v[156:159], v[144:147], v[32:35]
    v_mfma_f32_16x16x32_bf16 v[72:75], v[160:163], v[148:151], v[72:75]
    v_mfma_f32_16x16x32_bf16 v[108:111], v[148:151], v[164:167], v[108:111]
    v_mfma_f32_16x16x32_bf16 v[36:39], v[156:159], v[148:151], v[36:39]
    v_mfma_f32_16x16x32_bf16 v[76:79], v[160:163], v[152:155], v[76:79]
    v_mfma_f32_16x16x32_bf16 v[112:115], v[152:155], v[164:167], v[112:115]
    v_mfma_f32_16x16x32_bf16 v[40:43], v[156:159], v[152:155], v[40:43]
    s_waitcnt lgkmcnt(12)
    v_mfma_f32_16x16x32_bf16 v[44:47], v[208:211], v[168:171], v[44:47]
    s_waitcnt lgkmcnt(10)
    v_mfma_f32_16x16x32_bf16 v[80:83], v[168:171], v[212:215], v[80:83]
    s_waitcnt lgkmcnt(8)
    v_mfma_f32_16x16x32_bf16 v[116:119], v[204:207], v[8:11], v[116:119]
    s_waitcnt lgkmcnt(7)
    v_mfma_f32_16x16x32_bf16 v[48:51], v[208:211], v[172:175], v[48:51]
    v_mfma_f32_16x16x32_bf16 v[84:87], v[172:175], v[212:215], v[84:87]
    v_mfma_f32_16x16x32_bf16 v[12:15], v[204:207], v[172:175], v[12:15]
    s_waitcnt lgkmcnt(6)
    v_mfma_f32_16x16x32_bf16 v[52:55], v[208:211], v[176:179], v[52:55]
    v_mfma_f32_16x16x32_bf16 v[88:91], v[176:179], v[212:215], v[88:91]
    v_mfma_f32_16x16x32_bf16 v[16:19], v[204:207], v[176:179], v[16:19]
    s_waitcnt lgkmcnt(5)
    v_mfma_f32_16x16x32_bf16 v[56:59], v[208:211], v[180:183], v[56:59]
    v_mfma_f32_16x16x32_bf16 v[92:95], v[180:183], v[212:215], v[92:95]
    v_mfma_f32_16x16x32_bf16 v[20:23], v[204:207], v[180:183], v[20:23]
    s_waitcnt lgkmcnt(0)
    s_barrier
    ds_read_b32 v120, v240 offset:0
    ds_read_b32 v121, v240 offset:64
    ds_read_b32 v122, v240 offset:128
    v_mfma_f32_16x16x32_bf16 v[60:63], v[208:211], v[184:187], v[60:63]
    ds_read_b32 v123, v240 offset:192
    ds_read_b32 v124, v240 offset:256
    v_mfma_f32_16x16x32_bf16 v[96:99], v[184:187], v[212:215], v[96:99]
    ds_read_b32 v125, v240 offset:320
    ds_read_b32 v126, v240 offset:384
    v_mfma_f32_16x16x32_bf16 v[24:27], v[204:207], v[184:187], v[24:27]
    ds_read_b32 v127, v240 offset:448
    ds_read_b32 v128, v240 offset:512
    v_mov_b32_dpp v162, v44 row_newbcast:0 row_mask:0xf bank_mask:0xf
    v_mfma_f32_16x16x32_bf16 v[64:67], v[208:211], v[188:191], v[64:67]
    ds_read_b32 v129, v240 offset:576
    ds_read_b32 v130, v240 offset:640
    ds_read_b32 v131, v240 offset:704
    v_mov_b32_dpp v163, v45 row_newbcast:0 row_mask:0xf bank_mask:0xf
    v_mfma_f32_16x16x32_bf16 v[100:103], v[188:191], v[212:215], v[100:103]
    ds_read_b32 v132, v240 offset:768
    ds_read_b32 v133, v240 offset:832
    v_mov_b32_dpp v164, v46 row_newbcast:0 row_mask:0xf bank_mask:0xf
    v_mfma_f32_16x16x32_bf16 v[28:31], v[204:207], v[188:191], v[28:31]
    ds_read_b32 v134, v240 offset:896
    ds_read_b32 v135, v240 offset:960
    v_mov_b32_dpp v165, v47 row_newbcast:0 row_mask:0xf bank_mask:0xf
    v_mfma_f32_16x16x32_bf16 v[68:71], v[208:211], v[192:195], v[68:71]
    ds_read_b32 v136, v240 offset:1024
    ds_read_b32 v137, v240 offset:1088
    v_mov_b32 v166, v80
    v_mfma_f32_16x16x32_bf16 v[104:107], v[192:195], v[212:215], v[104:107]
    ds_read_b128 v[138:141], v241 offset:0
    ds_read_b128 v[142:145], v241 offset:64
    v_mov_b32 v167, v80
    v_mfma_f32_16x16x32_bf16 v[32:35], v[204:207], v[192:195], v[32:35]
    ds_read_b128 v[146:149], v241 offset:128
    ds_read_b128 v[150:153], v241 offset:192
    ds_read_b128 v[154:157], v241 offset:256
    v_mfma_f32_16x16x32_bf16 v[72:75], v[208:211], v[196:199], v[72:75]
    ds_read_b128 v[158:161], v241 offset:320
    ds_read_b128 v[216:219], v241 offset:384
    v_permlane16_swap_b32 v166, v167
    v_mfma_f32_16x16x32_bf16 v[108:111], v[196:199], v[212:215], v[108:111]
    ds_read_b128 v[220:223], v241 offset:448
    ds_read_b128 v[224:227], v241 offset:512
    v_mov_b32 v167, v166
    v_mfma_f32_16x16x32_bf16 v[36:39], v[204:207], v[196:199], v[36:39]
    ds_read_b128 v[228:231], v241 offset:576
    ds_read_b128 v[232:235], v241 offset:640
    v_permlane32_swap_b32 v166, v167
    v_mfma_f32_16x16x32_bf16 v[76:79], v[208:211], v[200:203], v[76:79]
    ds_read_b128 v[236:239], v241 offset:704
    v_mfma_f32_16x16x32_bf16 v[112:115], v[200:203], v[212:215], v[112:115]
    v_mfma_f32_16x16x32_bf16 v[40:43], v[204:207], v[200:203], v[40:43]
    s_waitcnt lgkmcnt(15)
    v_pk_mul_f32 v[4:5], v[120:121], v[162:163] op_sel:[1,0] op_sel_hi:[1,1]
    v_pk_mul_f32 v[2:3], v[120:121], v[164:165] op_sel:[1,0] op_sel_hi:[1,1]
    v_pk_fma_f32 v[44:45], v[44:45], v[120:121], v[4:5] op_sel_hi:[1,0,1]
    v_pk_fma_f32 v[46:47], v[46:47], v[120:121], v[2:3] op_sel_hi:[1,0,1]
    v_cvt_pk_bf16_f32 v168, v44, v45
    v_cvt_pk_bf16_f32 v169, v46, v47
    v_pk_mul_f32 v[4:5], v[122:123], v[162:163] op_sel:[1,0] op_sel_hi:[1,1]
    v_pk_mul_f32 v[2:3], v[122:123], v[164:165] op_sel:[1,0] op_sel_hi:[1,1]
    v_pk_fma_f32 v[48:49], v[48:49], v[122:123], v[4:5] op_sel_hi:[1,0,1]
    v_pk_fma_f32 v[50:51], v[50:51], v[122:123], v[2:3] op_sel_hi:[1,0,1]
    v_cvt_pk_bf16_f32 v170, v48, v49
    v_cvt_pk_bf16_f32 v171, v50, v51
    v_pk_mul_f32 v[4:5], v[124:125], v[162:163] op_sel:[1,0] op_sel_hi:[1,1]
    v_pk_mul_f32 v[2:3], v[124:125], v[164:165] op_sel:[1,0] op_sel_hi:[1,1]
    v_pk_fma_f32 v[52:53], v[52:53], v[124:125], v[4:5] op_sel_hi:[1,0,1]
    v_pk_fma_f32 v[54:55], v[54:55], v[124:125], v[2:3] op_sel_hi:[1,0,1]
    v_cvt_pk_bf16_f32 v172, v52, v53
    v_cvt_pk_bf16_f32 v173, v54, v55
    v_pk_mul_f32 v[4:5], v[126:127], v[162:163] op_sel:[1,0] op_sel_hi:[1,1]
    v_pk_mul_f32 v[2:3], v[126:127], v[164:165] op_sel:[1,0] op_sel_hi:[1,1]
    v_pk_fma_f32 v[56:57], v[56:57], v[126:127], v[4:5] op_sel_hi:[1,0,1]
    v_pk_fma_f32 v[58:59], v[58:59], v[126:127], v[2:3] op_sel_hi:[1,0,1]
    v_cvt_pk_bf16_f32 v174, v56, v57
    v_cvt_pk_bf16_f32 v175, v58, v59
    v_pk_mul_f32 v[4:5], v[128:129], v[162:163] op_sel:[1,0] op_sel_hi:[1,1]
    v_pk_mul_f32 v[2:3], v[128:129], v[164:165] op_sel:[1,0] op_sel_hi:[1,1]
    v_pk_fma_f32 v[60:61], v[60:61], v[128:129], v[4:5] op_sel_hi:[1,0,1]
    v_pk_fma_f32 v[62:63], v[62:63], v[128:129], v[2:3] op_sel_hi:[1,0,1]
    v_cvt_pk_bf16_f32 v176, v60, v61
    v_cvt_pk_bf16_f32 v177, v62, v63
    v_pk_mul_f32 v[4:5], v[130:131], v[162:163] op_sel:[1,0] op_sel_hi:[1,1]
    v_pk_mul_f32 v[2:3], v[130:131], v[164:165] op_sel:[1,0] op_sel_hi:[1,1]
    v_pk_fma_f32 v[64:65], v[64:65], v[130:131], v[4:5] op_sel_hi:[1,0,1]
    v_pk_fma_f32 v[66:67], v[66:67], v[130:131], v[2:3] op_sel_hi:[1,0,1]
    v_cvt_pk_bf16_f32 v178, v64, v65
    v_cvt_pk_bf16_f32 v179, v66, v67
    v_pk_mul_f32 v[4:5], v[132:133], v[162:163] op_sel:[1,0] op_sel_hi:[1,1]
    v_pk_mul_f32 v[2:3], v[132:133], v[164:165] op_sel:[1,0] op_sel_hi:[1,1]
    v_pk_fma_f32 v[68:69], v[68:69], v[132:133], v[4:5] op_sel_hi:[1,0,1]
    v_pk_fma_f32 v[70:71], v[70:71], v[132:133], v[2:3] op_sel_hi:[1,0,1]
    v_cvt_pk_bf16_f32 v180, v68, v69
    v_cvt_pk_bf16_f32 v181, v70, v71
    s_waitcnt lgkmcnt(14)
    s_nop 0
    v_pk_mul_f32 v[4:5], v[134:135], v[162:163] op_sel:[1,0] op_sel_hi:[1,1]
    v_pk_mul_f32 v[2:3], v[134:135], v[164:165] op_sel:[1,0] op_sel_hi:[1,1]
    v_pk_fma_f32 v[72:73], v[72:73], v[134:135], v[4:5] op_sel_hi:[1,0,1]
    v_pk_fma_f32 v[74:75], v[74:75], v[134:135], v[2:3] op_sel_hi:[1,0,1]
    v_cvt_pk_bf16_f32 v182, v72, v73
    v_cvt_pk_bf16_f32 v183, v74, v75
    s_waitcnt lgkmcnt(12)
    s_nop 0
    v_pk_mul_f32 v[4:5], v[136:137], v[162:163] op_sel:[1,0] op_sel_hi:[1,1]
    v_pk_mul_f32 v[2:3], v[136:137], v[164:165] op_sel:[1,0] op_sel_hi:[1,1]
    v_pk_fma_f32 v[76:77], v[76:77], v[136:137], v[4:5] op_sel_hi:[1,0,1]
    v_pk_fma_f32 v[78:79], v[78:79], v[136:137], v[2:3] op_sel_hi:[1,0,1]
    v_cvt_pk_bf16_f32 v184, v76, v77
    v_cvt_pk_bf16_f32 v185, v78, v79
    v_pk_mul_f32 v[122:123], v[122:123], v[242:243]
    v_pk_mul_f32 v[124:125], v[124:125], v[242:243]
    v_pk_mul_f32 v[126:127], v[126:127], v[242:243]
    v_pk_mul_f32 v[128:129], v[128:129], v[242:243]
    v_pk_mul_f32 v[130:131], v[130:131], v[242:243]
    v_pk_mul_f32 v[132:133], v[132:133], v[242:243]
    v_pk_mul_f32 v[134:135], v[134:135], v[242:243]
    v_pk_mul_f32 v[136:137], v[136:137], v[242:243]
    v_pk_mul_f32 v[4:5], v[122:123], v[116:117] op_sel:[1,0] op_sel_hi:[1,1]
    v_pk_mul_f32 v[2:3], v[122:123], v[118:119] op_sel:[1,0] op_sel_hi:[1,1]
    v_pk_fma_f32 v[12:13], v[12:13], v[122:123], v[4:5] op_sel_hi:[1,0,1]
    v_pk_fma_f32 v[14:15], v[14:15], v[122:123], v[2:3] op_sel_hi:[1,0,1]
    v_cvt_pk_bf16_f32 v186, v12, v13
    v_cvt_pk_bf16_f32 v187, v14, v15
    v_pk_mul_f32 v[4:5], v[124:125], v[116:117] op_sel:[1,0] op_sel_hi:[1,1]
    v_pk_mul_f32 v[2:3], v[124:125], v[118:119] op_sel:[1,0] op_sel_hi:[1,1]
    v_pk_fma_f32 v[16:17], v[16:17], v[124:125], v[4:5] op_sel_hi:[1,0,1]
    v_pk_fma_f32 v[18:19], v[18:19], v[124:125], v[2:3] op_sel_hi:[1,0,1]
    v_cvt_pk_bf16_f32 v188, v16, v17
    v_cvt_pk_bf16_f32 v189, v18, v19
    v_pk_mul_f32 v[4:5], v[126:127], v[116:117] op_sel:[1,0] op_sel_hi:[1,1]
    v_pk_mul_f32 v[2:3], v[126:127], v[118:119] op_sel:[1,0] op_sel_hi:[1,1]
    v_pk_fma_f32 v[20:21], v[20:21], v[126:127], v[4:5] op_sel_hi:[1,0,1]
    v_pk_fma_f32 v[22:23], v[22:23], v[126:127], v[2:3] op_sel_hi:[1,0,1]
    v_cvt_pk_bf16_f32 v190, v20, v21
    v_cvt_pk_bf16_f32 v191, v22, v23
    v_pk_mul_f32 v[4:5], v[128:129], v[116:117] op_sel:[1,0] op_sel_hi:[1,1]
    v_pk_mul_f32 v[2:3], v[128:129], v[118:119] op_sel:[1,0] op_sel_hi:[1,1]
    v_pk_fma_f32 v[24:25], v[24:25], v[128:129], v[4:5] op_sel_hi:[1,0,1]
    v_pk_fma_f32 v[26:27], v[26:27], v[128:129], v[2:3] op_sel_hi:[1,0,1]
    v_cvt_pk_bf16_f32 v192, v24, v25
    v_cvt_pk_bf16_f32 v193, v26, v27
    v_pk_mul_f32 v[4:5], v[130:131], v[116:117] op_sel:[1,0] op_sel_hi:[1,1]
    v_pk_mul_f32 v[2:3], v[130:131], v[118:119] op_sel:[1,0] op_sel_hi:[1,1]
    v_pk_fma_f32 v[28:29], v[28:29], v[130:131], v[4:5] op_sel_hi:[1,0,1]
    v_pk_fma_f32 v[30:31], v[30:31], v[130:131], v[2:3] op_sel_hi:[1,0,1]
    v_cvt_pk_bf16_f32 v194, v28, v29
    v_cvt_pk_bf16_f32 v195, v30, v31
    v_pk_mul_f32 v[4:5], v[132:133], v[116:117] op_sel:[1,0] op_sel_hi:[1,1]
    v_pk_mul_f32 v[2:3], v[132:133], v[118:119] op_sel:[1,0] op_sel_hi:[1,1]
    v_pk_fma_f32 v[32:33], v[32:33], v[132:133], v[4:5] op_sel_hi:[1,0,1]
    v_pk_fma_f32 v[34:35], v[34:35], v[132:133], v[2:3] op_sel_hi:[1,0,1]
    v_cvt_pk_bf16_f32 v196, v32, v33
    v_cvt_pk_bf16_f32 v197, v34, v35
    v_pk_mul_f32 v[4:5], v[134:135], v[116:117] op_sel:[1,0] op_sel_hi:[1,1]
    v_pk_mul_f32 v[2:3], v[134:135], v[118:119] op_sel:[1,0] op_sel_hi:[1,1]
    v_pk_fma_f32 v[36:37], v[36:37], v[134:135], v[4:5] op_sel_hi:[1,0,1]
    v_pk_fma_f32 v[38:39], v[38:39], v[134:135], v[2:3] op_sel_hi:[1,0,1]
    v_cvt_pk_bf16_f32 v198, v36, v37
    v_cvt_pk_bf16_f32 v199, v38, v39
    v_pk_mul_f32 v[4:5], v[136:137], v[116:117] op_sel:[1,0] op_sel_hi:[1,1]
    v_pk_mul_f32 v[2:3], v[136:137], v[118:119] op_sel:[1,0] op_sel_hi:[1,1]
    v_pk_fma_f32 v[40:41], v[40:41], v[136:137], v[4:5] op_sel_hi:[1,0,1]
    v_pk_fma_f32 v[42:43], v[42:43], v[136:137], v[2:3] op_sel_hi:[1,0,1]
    v_cvt_pk_bf16_f32 v200, v40, v41
    v_cvt_pk_bf16_f32 v201, v42, v43
    v_mfma_f32_16x16x16_bf16 v[12:15], v[168:169], v[186:187], v[252:255]
    v_mfma_f32_16x16x16_bf16 v[16:19], v[170:171], v[186:187], v[244:247]
    v_mfma_f32_16x16x16_bf16 v[20:23], v[170:171], v[188:189], v[248:251]
    v_mfma_f32_16x16x16_bf16 v[24:27], v[172:173], v[188:189], v[244:247]
    v_mfma_f32_16x16x16_bf16 v[28:31], v[172:173], v[190:191], v[248:251]
    v_mfma_f32_16x16x16_bf16 v[32:35], v[174:175], v[190:191], v[244:247]
    v_mfma_f32_16x16x16_bf16 v[36:39], v[174:175], v[192:193], v[248:251]
    v_mfma_f32_16x16x16_bf16 v[40:43], v[176:177], v[192:193], v[244:247]
    v_mfma_f32_16x16x16_bf16 v[44:47], v[176:177], v[194:195], v[248:251]
    v_mfma_f32_16x16x16_bf16 v[48:51], v[178:179], v[194:195], v[244:247]
    v_mfma_f32_16x16x16_bf16 v[52:55], v[178:179], v[196:197], v[248:251]
    v_mfma_f32_16x16x16_bf16 v[56:59], v[180:181], v[196:197], v[244:247]
    v_mfma_f32_16x16x16_bf16 v[60:63], v[180:181], v[198:199], v[248:251]
    v_mfma_f32_16x16x16_bf16 v[64:67], v[182:183], v[198:199], v[244:247]
    v_mfma_f32_16x16x16_bf16 v[68:71], v[182:183], v[200:201], v[248:251]
    v_mfma_f32_16x16x16_bf16 v[72:75], v[184:185], v[200:201], v[244:247]
    s_waitcnt lgkmcnt(10)
    s_nop 0
    v_pk_mul_f32 v[142:143], v[142:143], v[166:167] op_sel_hi:[1,0]
    v_pk_mul_f32 v[144:145], v[144:145], v[166:167] op_sel_hi:[1,0]
    v_pk_fma_f32 v[80:81], v[80:81], v[138:139], v[142:143]
    v_pk_fma_f32 v[82:83], v[82:83], v[140:141], v[144:145]
    v_cvt_pk_bf16_f32 v120, v80, v81
    v_cvt_pk_bf16_f32 v121, v82, v83
    ds_read_b128 v[138:141], v241 offset:768
    ds_read_b128 v[142:145], v241 offset:832
    s_waitcnt lgkmcnt(10)
    s_nop 0
    v_pk_mul_f32 v[150:151], v[150:151], v[166:167] op_sel_hi:[1,0]
    v_pk_mul_f32 v[152:153], v[152:153], v[166:167] op_sel_hi:[1,0]
    v_pk_fma_f32 v[84:85], v[84:85], v[146:147], v[150:151]
    v_pk_fma_f32 v[86:87], v[86:87], v[148:149], v[152:153]
    v_cvt_pk_bf16_f32 v122, v84, v85
    v_cvt_pk_bf16_f32 v123, v86, v87
    ds_read_b128 v[146:149], v241 offset:896
    ds_read_b128 v[150:153], v241 offset:960
    s_waitcnt lgkmcnt(10)
    s_nop 0
    v_pk_mul_f32 v[158:159], v[158:159], v[166:167] op_sel_hi:[1,0]
    v_pk_mul_f32 v[160:161], v[160:161], v[166:167] op_sel_hi:[1,0]
    v_pk_fma_f32 v[88:89], v[88:89], v[154:155], v[158:159]
    v_pk_fma_f32 v[90:91], v[90:91], v[156:157], v[160:161]
    v_cvt_pk_bf16_f32 v124, v88, v89
    v_cvt_pk_bf16_f32 v125, v90, v91
    ds_read_b128 v[154:157], v241 offset:1024
    ds_read_b128 v[158:161], v241 offset:1088
    s_waitcnt lgkmcnt(10)
    s_nop 0
    v_pk_mul_f32 v[220:221], v[220:221], v[166:167] op_sel_hi:[1,0]
    v_pk_mul_f32 v[222:223], v[222:223], v[166:167] op_sel_hi:[1,0]
    v_pk_fma_f32 v[92:93], v[92:93], v[216:217], v[220:221]
    v_pk_fma_f32 v[94:95], v[94:95], v[218:219], v[222:223]
    v_cvt_pk_bf16_f32 v126, v92, v93
    v_cvt_pk_bf16_f32 v127, v94, v95
    s_waitcnt lgkmcnt(8)
    s_nop 0
    v_pk_mul_f32 v[228:229], v[228:229], v[166:167] op_sel_hi:[1,0]
    v_pk_mul_f32 v[230:231], v[230:231], v[166:167] op_sel_hi:[1,0]
    v_pk_fma_f32 v[96:97], v[96:97], v[224:225], v[228:229]
    v_pk_fma_f32 v[98:99], v[98:99], v[226:227], v[230:231]
    v_cvt_pk_bf16_f32 v128, v96, v97
    v_cvt_pk_bf16_f32 v129, v98, v99
    s_waitcnt lgkmcnt(6)
    s_nop 0
    v_pk_mul_f32 v[236:237], v[236:237], v[166:167] op_sel_hi:[1,0]
    v_pk_mul_f32 v[238:239], v[238:239], v[166:167] op_sel_hi:[1,0]
    v_pk_fma_f32 v[100:101], v[100:101], v[232:233], v[236:237]
    v_pk_fma_f32 v[102:103], v[102:103], v[234:235], v[238:239]
    v_cvt_pk_bf16_f32 v130, v100, v101
    v_cvt_pk_bf16_f32 v131, v102, v103
    s_waitcnt lgkmcnt(4)
    s_nop 0
    v_pk_mul_f32 v[142:143], v[142:143], v[166:167] op_sel_hi:[1,0]
    v_pk_mul_f32 v[144:145], v[144:145], v[166:167] op_sel_hi:[1,0]
    v_pk_fma_f32 v[104:105], v[104:105], v[138:139], v[142:143]
    v_pk_fma_f32 v[106:107], v[106:107], v[140:141], v[144:145]
    v_cvt_pk_bf16_f32 v132, v104, v105
    v_cvt_pk_bf16_f32 v133, v106, v107
    s_waitcnt lgkmcnt(2)
    s_nop 0
    v_pk_mul_f32 v[150:151], v[150:151], v[166:167] op_sel_hi:[1,0]
    v_pk_mul_f32 v[152:153], v[152:153], v[166:167] op_sel_hi:[1,0]
    v_pk_fma_f32 v[108:109], v[108:109], v[146:147], v[150:151]
    v_pk_fma_f32 v[110:111], v[110:111], v[148:149], v[152:153]
    v_cvt_pk_bf16_f32 v134, v108, v109
    v_cvt_pk_bf16_f32 v135, v110, v111
    s_waitcnt lgkmcnt(0)
    s_nop 0
    v_pk_mul_f32 v[158:159], v[158:159], v[166:167] op_sel_hi:[1,0]
    v_pk_mul_f32 v[160:161], v[160:161], v[166:167] op_sel_hi:[1,0]
    v_pk_fma_f32 v[112:113], v[112:113], v[154:155], v[158:159]
    v_pk_fma_f32 v[114:115], v[114:115], v[156:157], v[160:161]
    v_cvt_pk_bf16_f32 v136, v112, v113
    v_cvt_pk_bf16_f32 v137, v114, v115
    v_max3_f32 v168, v12, v13, v14
    v_max3_f32 v170, v20, v21, v22
    v_max3_f32 v172, v28, v29, v30
    v_max3_f32 v174, v36, v37, v38
    v_max3_f32 v168, v168, v15, v16
    v_max3_f32 v170, v170, v23, v24
    v_max3_f32 v172, v172, v31, v32
    v_max3_f32 v174, v174, v39, v40
    v_max3_f32 v168, v168, v17, v18
    v_max3_f32 v170, v170, v25, v26
    v_max3_f32 v172, v172, v33, v34
    v_max3_f32 v174, v174, v41, v42
    v_max_f32 v168, v168, v19
    v_max_f32 v170, v170, v27
    v_max_f32 v172, v172, v35
    v_max_f32 v174, v174, v43
    v_mov_b32 v176, v168
    v_mov_b32 v177, v170
    v_mov_b32 v178, v172
    v_mov_b32 v179, v174
    v_permlane32_swap_b32 v168, v176
    v_permlane32_swap_b32 v170, v177
    v_permlane32_swap_b32 v172, v178
    v_permlane32_swap_b32 v174, v179
    v_max_f32 v168, v168, v176
    v_max_f32 v170, v170, v177
    v_max_f32 v172, v172, v178
    v_max_f32 v174, v174, v179
    v_mov_b32 v176, v168
    v_mov_b32 v177, v170
    v_mov_b32 v178, v172
    v_mov_b32 v179, v174
    v_permlane16_swap_b32 v168, v176
    v_permlane16_swap_b32 v170, v177
    v_permlane16_swap_b32 v172, v178
    v_permlane16_swap_b32 v174, v179
    v_max_f32 v168, v168, v176
    v_max_f32 v170, v170, v177
    v_max_f32 v172, v172, v178
    v_max_f32 v174, v174, v179
    v_pk_add_f32 v[12:13], v[12:13], v[168:169] op_sel_hi:[1,0] neg_lo:[0,1] neg_hi:[0,1]
    v_pk_add_f32 v[14:15], v[14:15], v[168:169] op_sel_hi:[1,0] neg_lo:[0,1] neg_hi:[0,1]
    v_pk_add_f32 v[16:17], v[16:17], v[168:169] op_sel_hi:[1,0] neg_lo:[0,1] neg_hi:[0,1]
    v_pk_add_f32 v[18:19], v[18:19], v[168:169] op_sel_hi:[1,0] neg_lo:[0,1] neg_hi:[0,1]
    v_exp_f32 v12, v12
    v_exp_f32 v13, v13
    v_exp_f32 v14, v14
    v_exp_f32 v15, v15
    v_exp_f32 v16, v16
    v_exp_f32 v17, v17
    v_exp_f32 v18, v18
    v_exp_f32 v19, v19
    v_cvt_pk_bf16_f32 v80, v12, v13
    v_cvt_pk_bf16_f32 v81, v14, v15
    v_cvt_pk_bf16_f32 v82, v16, v17
    v_cvt_pk_bf16_f32 v83, v18, v19
    s_nop 1
    v_mfma_f32_16x16x32_bf16 v[180:183], v[8:11], v[80:83], 0
    v_mfma_f32_16x16x32_bf16 v[96:99], v[120:123], v[80:83], 0
    v_pk_add_f32 v[20:21], v[20:21], v[170:171] op_sel_hi:[1,0] neg_lo:[0,1] neg_hi:[0,1]
    v_pk_add_f32 v[22:23], v[22:23], v[170:171] op_sel_hi:[1,0] neg_lo:[0,1] neg_hi:[0,1]
    v_pk_add_f32 v[24:25], v[24:25], v[170:171] op_sel_hi:[1,0] neg_lo:[0,1] neg_hi:[0,1]
    v_pk_add_f32 v[26:27], v[26:27], v[170:171] op_sel_hi:[1,0] neg_lo:[0,1] neg_hi:[0,1]
    v_exp_f32 v20, v20
    v_exp_f32 v21, v21
    v_exp_f32 v22, v22
    v_exp_f32 v23, v23
    v_exp_f32 v24, v24
    v_exp_f32 v25, v25
    v_exp_f32 v26, v26
    v_exp_f32_e64 v27, v27
    v_cvt_pk_bf16_f32 v84, v20, v21
    v_cvt_pk_bf16_f32 v85, v22, v23
    v_cvt_pk_bf16_f32 v86, v24, v25
    v_cvt_pk_bf16_f32 v87, v26, v27
    s_nop 1
    v_mfma_f32_16x16x32_bf16 v[184:187], v[8:11], v[84:87], 0
    v_mfma_f32_16x16x32_bf16 v[100:103], v[122:125], v[84:87], 0
    v_pk_add_f32 v[28:29], v[28:29], v[172:173] op_sel_hi:[1,0] neg_lo:[0,1] neg_hi:[0,1]
    v_pk_add_f32 v[30:31], v[30:31], v[172:173] op_sel_hi:[1,0] neg_lo:[0,1] neg_hi:[0,1]
    v_pk_add_f32 v[32:33], v[32:33], v[172:173] op_sel_hi:[1,0] neg_lo:[0,1] neg_hi:[0,1]
    v_pk_add_f32 v[34:35], v[34:35], v[172:173] op_sel_hi:[1,0] neg_lo:[0,1] neg_hi:[0,1]
    v_exp_f32 v28, v28
    v_exp_f32 v29, v29
    v_exp_f32 v30, v30
    v_exp_f32 v31, v31
    v_exp_f32 v32, v32
    v_exp_f32 v33, v33
    v_exp_f32 v34, v34
    v_exp_f32_e64 v35, v35
    v_cvt_pk_bf16_f32 v88, v28, v29
    v_cvt_pk_bf16_f32 v89, v30, v31
    v_cvt_pk_bf16_f32 v90, v32, v33
    v_cvt_pk_bf16_f32 v91, v34, v35
    s_nop 1
    v_mfma_f32_16x16x32_bf16 v[188:191], v[8:11], v[88:91], 0
    v_mfma_f32_16x16x32_bf16 v[104:107], v[124:127], v[88:91], 0
    v_pk_add_f32 v[36:37], v[36:37], v[174:175] op_sel_hi:[1,0] neg_lo:[0,1] neg_hi:[0,1]
    v_pk_add_f32 v[38:39], v[38:39], v[174:175] op_sel_hi:[1,0] neg_lo:[0,1] neg_hi:[0,1]
    v_pk_add_f32 v[40:41], v[40:41], v[174:175] op_sel_hi:[1,0] neg_lo:[0,1] neg_hi:[0,1]
    v_pk_add_f32 v[42:43], v[42:43], v[174:175] op_sel_hi:[1,0] neg_lo:[0,1] neg_hi:[0,1]
    v_exp_f32 v36, v36
    v_exp_f32 v37, v37
    v_exp_f32 v38, v38
    v_exp_f32 v39, v39
    v_exp_f32 v40, v40
    v_exp_f32 v41, v41
    v_exp_f32 v42, v42
    v_exp_f32_e64 v43, v43
    v_cvt_pk_bf16_f32 v92, v36, v37
    v_cvt_pk_bf16_f32 v93, v38, v39
    v_cvt_pk_bf16_f32 v94, v40, v41
    v_cvt_pk_bf16_f32 v95, v42, v43
    s_nop 1
    v_mfma_f32_16x16x32_bf16 v[192:195], v[8:11], v[92:95], 0
    v_mfma_f32_16x16x32_bf16 v[108:111], v[126:129], v[92:95], 0
    v_rcp_f32 v180, v180
    v_rcp_f32 v184, v184
    v_rcp_f32 v188, v188
    s_nop 3
    v_rcp_f32 v192, v192
    v_pk_mul_f32 v[96:97], v[96:97], v[180:181] op_sel_hi:[1,0]
    v_pk_mul_f32 v[98:99], v[98:99], v[180:181] op_sel_hi:[1,0]
    v_cvt_pk_bf16_f32 v196, v96, v97
    v_cvt_pk_bf16_f32 v197, v98, v99
    v_pk_mul_f32 v[100:101], v[100:101], v[184:185] op_sel_hi:[1,0]
    v_pk_mul_f32 v[102:103], v[102:103], v[184:185] op_sel_hi:[1,0]
    v_cvt_pk_bf16_f32 v198, v100, v101
    v_cvt_pk_bf16_f32 v199, v102, v103
    s_nop 0
    v_permlane16_swap_b32 v196, v198
    v_permlane16_swap_b32 v197, v199
    s_nop 0
    buffer_store_dwordx4 v[196:199], v6, s[24:27], 0 offen sc1
    v_pk_mul_f32 v[104:105], v[104:105], v[188:189] op_sel_hi:[1,0]
    v_pk_mul_f32 v[106:107], v[106:107], v[188:189] op_sel_hi:[1,0]
    v_cvt_pk_bf16_f32 v200, v104, v105
    v_cvt_pk_bf16_f32 v201, v106, v107
    v_pk_mul_f32 v[108:109], v[108:109], v[192:193] op_sel_hi:[1,0]
    v_pk_mul_f32 v[110:111], v[110:111], v[192:193] op_sel_hi:[1,0]
    v_cvt_pk_bf16_f32 v202, v108, v109
    v_cvt_pk_bf16_f32 v203, v110, v111
    s_nop 0
    v_permlane16_swap_b32 v200, v202
    v_permlane16_swap_b32 v201, v203
    s_nop 0
    buffer_store_dwordx4 v[200:203], v6, s[24:27], s53 offen sc1
    v_max3_f32 v168, v44, v45, v46
    v_max3_f32 v170, v52, v53, v54
    v_max3_f32 v172, v60, v61, v62
    v_max3_f32 v174, v68, v69, v70
    v_max3_f32 v168, v168, v47, v48
    v_max3_f32 v170, v170, v55, v56
    v_max3_f32 v172, v172, v63, v64
    v_max3_f32 v174, v174, v71, v72
    v_max3_f32 v168, v168, v49, v50
    v_max3_f32 v170, v170, v57, v58
    v_max3_f32 v172, v172, v65, v66
    v_max3_f32 v174, v174, v73, v74
    v_max_f32 v168, v168, v51
    v_max_f32 v170, v170, v59
    v_max_f32 v172, v172, v67
    v_max_f32 v174, v174, v75
    v_mov_b32 v176, v168
    v_mov_b32 v177, v170
    v_mov_b32 v178, v172
    v_mov_b32 v179, v174
    v_permlane32_swap_b32 v168, v176
    v_permlane32_swap_b32 v170, v177
    v_permlane32_swap_b32 v172, v178
    v_permlane32_swap_b32 v174, v179
    v_max_f32 v168, v168, v176
    v_max_f32 v170, v170, v177
    v_max_f32 v172, v172, v178
    v_max_f32 v174, v174, v179
    v_mov_b32 v176, v168
    v_mov_b32 v177, v170
    v_mov_b32 v178, v172
    v_mov_b32 v179, v174
    v_permlane16_swap_b32 v168, v176
    v_permlane16_swap_b32 v170, v177
    v_permlane16_swap_b32 v172, v178
    v_permlane16_swap_b32 v174, v179
    v_max_f32 v168, v168, v176
    v_max_f32 v170, v170, v177
    v_max_f32 v172, v172, v178
    v_max_f32 v174, v174, v179
    v_pk_add_f32 v[44:45], v[44:45], v[168:169] op_sel_hi:[1,0] neg_lo:[0,1] neg_hi:[0,1]
    v_pk_add_f32 v[46:47], v[46:47], v[168:169] op_sel_hi:[1,0] neg_lo:[0,1] neg_hi:[0,1]
    v_pk_add_f32 v[48:49], v[48:49], v[168:169] op_sel_hi:[1,0] neg_lo:[0,1] neg_hi:[0,1]
    v_pk_add_f32 v[50:51], v[50:51], v[168:169] op_sel_hi:[1,0] neg_lo:[0,1] neg_hi:[0,1]
    v_exp_f32 v44, v44
    v_exp_f32 v45, v45
    v_exp_f32 v46, v46
    v_exp_f32 v47, v47
    v_exp_f32 v48, v48
    v_exp_f32 v49, v49
    v_exp_f32 v50, v50
    v_exp_f32 v51, v51
    v_cvt_pk_bf16_f32 v80, v44, v45
    v_cvt_pk_bf16_f32 v81, v46, v47
    v_cvt_pk_bf16_f32 v82, v48, v49
    v_cvt_pk_bf16_f32 v83, v50, v51
    s_nop 1
    v_mfma_f32_16x16x32_bf16 v[180:183], v[8:11], v[80:83], 0
    v_mfma_f32_16x16x32_bf16 v[96:99], v[128:131], v[80:83], 0
    v_pk_add_f32 v[52:53], v[52:53], v[170:171] op_sel_hi:[1,0] neg_lo:[0,1] neg_hi:[0,1]
    v_pk_add_f32 v[54:55], v[54:55], v[170:171] op_sel_hi:[1,0] neg_lo:[0,1] neg_hi:[0,1]
    v_pk_add_f32 v[56:57], v[56:57], v[170:171] op_sel_hi:[1,0] neg_lo:[0,1] neg_hi:[0,1]
    v_pk_add_f32 v[58:59], v[58:59], v[170:171] op_sel_hi:[1,0] neg_lo:[0,1] neg_hi:[0,1]
    v_exp_f32 v52, v52
    v_exp_f32 v53, v53
    v_exp_f32 v54, v54
    v_exp_f32 v55, v55
    v_exp_f32 v56, v56
    v_exp_f32 v57, v57
    v_exp_f32 v58, v58
    v_exp_f32_e64 v59, v59
    v_cvt_pk_bf16_f32 v84, v52, v53
    v_cvt_pk_bf16_f32 v85, v54, v55
    v_cvt_pk_bf16_f32 v86, v56, v57
    v_cvt_pk_bf16_f32 v87, v58, v59
    s_nop 1
    v_mfma_f32_16x16x32_bf16 v[184:187], v[8:11], v[84:87], 0
    v_mfma_f32_16x16x32_bf16 v[100:103], v[130:133], v[84:87], 0
    v_pk_add_f32 v[60:61], v[60:61], v[172:173] op_sel_hi:[1,0] neg_lo:[0,1] neg_hi:[0,1]
    v_pk_add_f32 v[62:63], v[62:63], v[172:173] op_sel_hi:[1,0] neg_lo:[0,1] neg_hi:[0,1]
    v_pk_add_f32 v[64:65], v[64:65], v[172:173] op_sel_hi:[1,0] neg_lo:[0,1] neg_hi:[0,1]
    v_pk_add_f32 v[66:67], v[66:67], v[172:173] op_sel_hi:[1,0] neg_lo:[0,1] neg_hi:[0,1]
    v_exp_f32 v60, v60
    v_exp_f32 v61, v61
    v_exp_f32 v62, v62
    v_exp_f32 v63, v63
    v_exp_f32 v64, v64
    v_exp_f32 v65, v65
    v_exp_f32 v66, v66
    v_exp_f32_e64 v67, v67
    v_cvt_pk_bf16_f32 v88, v60, v61
    v_cvt_pk_bf16_f32 v89, v62, v63
    v_cvt_pk_bf16_f32 v90, v64, v65
    v_cvt_pk_bf16_f32 v91, v66, v67
    s_nop 1
    v_mfma_f32_16x16x32_bf16 v[188:191], v[8:11], v[88:91], 0
    v_mfma_f32_16x16x32_bf16 v[104:107], v[132:135], v[88:91], 0
    v_pk_add_f32 v[68:69], v[68:69], v[174:175] op_sel_hi:[1,0] neg_lo:[0,1] neg_hi:[0,1]
    v_pk_add_f32 v[70:71], v[70:71], v[174:175] op_sel_hi:[1,0] neg_lo:[0,1] neg_hi:[0,1]
    v_pk_add_f32 v[72:73], v[72:73], v[174:175] op_sel_hi:[1,0] neg_lo:[0,1] neg_hi:[0,1]
    v_pk_add_f32 v[74:75], v[74:75], v[174:175] op_sel_hi:[1,0] neg_lo:[0,1] neg_hi:[0,1]
    v_exp_f32 v68, v68
    v_exp_f32 v69, v69
    v_exp_f32 v70, v70
    v_exp_f32 v71, v71
    v_exp_f32 v72, v72
    v_exp_f32 v73, v73
    v_exp_f32 v74, v74
    v_exp_f32_e64 v75, v75
    v_cvt_pk_bf16_f32 v92, v68, v69
    v_cvt_pk_bf16_f32 v93, v70, v71
    v_cvt_pk_bf16_f32 v94, v72, v73
    v_cvt_pk_bf16_f32 v95, v74, v75
    s_nop 1
    v_mfma_f32_16x16x32_bf16 v[192:195], v[8:11], v[92:95], 0
    v_mfma_f32_16x16x32_bf16 v[108:111], v[134:137], v[92:95], 0
    v_rcp_f32 v180, v180
    v_rcp_f32 v184, v184
    v_rcp_f32 v188, v188
    s_nop 3
    v_rcp_f32 v192, v192
    v_pk_mul_f32 v[96:97], v[96:97], v[180:181] op_sel_hi:[1,0]
    v_pk_mul_f32 v[98:99], v[98:99], v[180:181] op_sel_hi:[1,0]
    v_cvt_pk_bf16_f32 v204, v96, v97
    v_cvt_pk_bf16_f32 v205, v98, v99
    v_pk_mul_f32 v[100:101], v[100:101], v[184:185] op_sel_hi:[1,0]
    v_pk_mul_f32 v[102:103], v[102:103], v[184:185] op_sel_hi:[1,0]
    v_cvt_pk_bf16_f32 v206, v100, v101
    v_cvt_pk_bf16_f32 v207, v102, v103
    s_nop 0
    v_permlane16_swap_b32 v204, v206
    v_permlane16_swap_b32 v205, v207
    s_nop 0
    buffer_store_dwordx4 v[204:207], v6, s[24:27], s54 offen sc1
    v_pk_mul_f32 v[104:105], v[104:105], v[188:189] op_sel_hi:[1,0]
    v_pk_mul_f32 v[106:107], v[106:107], v[188:189] op_sel_hi:[1,0]
    v_cvt_pk_bf16_f32 v208, v104, v105
    v_cvt_pk_bf16_f32 v209, v106, v107
    v_pk_mul_f32 v[108:109], v[108:109], v[192:193] op_sel_hi:[1,0]
    v_pk_mul_f32 v[110:111], v[110:111], v[192:193] op_sel_hi:[1,0]
    v_cvt_pk_bf16_f32 v210, v108, v109
    v_cvt_pk_bf16_f32 v211, v110, v111
    s_nop 0
    v_permlane16_swap_b32 v208, v210
    v_permlane16_swap_b32 v209, v211
    v_mov_b32 v2, s74
    v_mov_b32 v3, 1
    s_mov_b32 s7, 0
    s_waitcnt vmcnt(1)
    s_mov_b64 exec, 1
    buffer_store_dword v3, v2, s[24:27], s7 offen sc1
    s_mov_b64 exec, -1
    buffer_store_dwordx4 v[208:211], v6, s[24:27], s55 offen sc1
    v_lshrrev_b32 v24, 4, v0
    v_bfe_u32 v25, v0, 2, 2
    v_and_b32 v26, 3, v0
    v_and_b32 v27, 1, v24
    v_lshrrev_b32 v28, 1, v26
    v_lshl_add_u32 v27, v27, 1, v28
    v_lshrrev_b32 v28, 1, v25
    v_lshlrev_b32 v28, 2, v28
    v_xor_b32 v27, v27, v28
    v_lshlrev_b32 v27, 4, v27
    v_lshrrev_b32 v24, 1, v24
    v_lshl_add_u32 v27, v24, 10, v27
    v_lshl_add_u32 v27, v25, 7, v27
    v_and_b32 v28, 1, v26
    v_lshl_add_u32 v16, v28, 3, v27
    s_lshl_b32 s7, s3, 11
    v_add_u32 v16, s7, v16
    v_xor_b32 v17, 64, v16
    v_add_u32 v18, 55296, v16
    v_add_u32 v19, 55296, v17
    v_add_u32 v20, 104448, v16
    v_add_u32 v21, 104448, v17
    s_lshl_b32 s7, s3, 2
    s_add_u32 s7, s7, 163648
    v_mov_b32 v22, s7
    s_mov_b32 s73, 0
    s_add_u32 s52, s76, 0
    s_and_b32 s52, s52, 7
    s_lshl_b32 s52, s52, 10
    s_add_u32 s53, s76, 1
    s_and_b32 s53, s53, 7
    s_lshl_b32 s53, s53, 10
    s_add_u32 s54, s76, 2
    s_and_b32 s54, s54, 7
    s_lshl_b32 s54, s54, 10
    s_add_u32 s55, s76, 3
    s_and_b32 s55, s55, 7
    s_lshl_b32 s55, s55, 10
    s_add_u32 s56, s76, 4
    s_and_b32 s56, s56, 7
    s_lshl_b32 s56, s56, 10
    s_add_u32 s57, s76, 5
    s_and_b32 s57, s57, 7
    s_lshl_b32 s57, s57, 10
    s_add_u32 s58, s76, 6
    s_and_b32 s58, s58, 7
    s_lshl_b32 s58, s58, 10
    s_add_u32 s59, s76, 7
    s_and_b32 s59, s59, 7
    s_lshl_b32 s59, s59, 10
    s_mov_b32 s100, s76
    s_sub_u32 s101, s100, 7
    s_min_u32 s100, s101, s100
    s_sub_u32 s101, s100, 7
    s_min_u32 s100, s101, s100
    s_sub_u32 s101, s100, 7
    s_min_u32 s100, s101, s100
    s_sub_u32 s101, s100, 7
    s_min_u32 s100, s101, s100
    s_add_u32 s60, s100, 0
    s_sub_u32 s101, s60, 7
    s_min_u32 s60, s101, s60
    s_add_u32 s60, s60, 8
    s_lshl_b32 s60, s60, 10
    s_add_u32 s61, s100, 1
    s_sub_u32 s101, s61, 7
    s_min_u32 s61, s101, s61
    s_add_u32 s61, s61, 8
    s_lshl_b32 s61, s61, 10
    s_add_u32 s62, s100, 2
    s_sub_u32 s101, s62, 7
    s_min_u32 s62, s101, s62
    s_add_u32 s62, s62, 8
    s_lshl_b32 s62, s62, 10
    s_add_u32 s63, s100, 3
    s_sub_u32 s101, s63, 7
    s_min_u32 s63, s101, s63
    s_add_u32 s63, s63, 8
    s_lshl_b32 s63, s63, 10
    s_add_u32 s64, s100, 4
    s_sub_u32 s101, s64, 7
    s_min_u32 s64, s101, s64
    s_add_u32 s64, s64, 8
    s_lshl_b32 s64, s64, 10
    s_add_u32 s65, s100, 5
    s_sub_u32 s101, s65, 7
    s_min_u32 s65, s101, s65
    s_add_u32 s65, s65, 8
    s_lshl_b32 s65, s65, 10
    s_add_u32 s66, s100, 6
    s_sub_u32 s101, s66, 7
    s_min_u32 s66, s101, s66
    s_add_u32 s66, s66, 8
    s_lshl_b32 s66, s66, 10
    v_mov_b32 v24, s74
    v_mov_b32 v25, 1
    s_mov_b32 s7, 8192
    s_waitcnt vmcnt(0)
    s_mov_b64 exec, 1
    buffer_store_dword v25, v24, s[24:27], s7 offen sc1
    s_mov_b64 exec, -1
    s_lshl_b32 s7, s67, 1
    s_add_u32 s7, s7, s68
    s_lshl_b32 s7, s7, 7
    s_lshl_b32 s70, s48, 2
    s_add_u32 s7, s7, s70
    s_add_u32 s7, s7, 32
    v_add_u32 v3, s7, v0
    s_mov_b32 s50, 0xff
    s_add_u32 s70, s70, 16
    s_lshl_b32 s74, s70, 6
    s_mov_b32 s72, 0
    s_mov_b32 s51, 0
    v_lshlrev_b32 v3, 6, v3
    v_add_u32 v3, 8388608, v3
    s_lshl_b32 s7, s67, 7
    s_lshl_b32 s71, s68, 6
    s_add_u32 s7, s7, s71
    s_lshl_b32 s71, s3, 3
    s_add_u32 s7, s7, s71
    v_lshrrev_b32 v27, 3, v0
    v_and_b32 v26, 7, v0
    s_lshl_b32 s71, s69, 7
    v_lshl_add_u32 v7, v26, 4, s71
    v_add_u32 v6, s7, v27
    v_lshl_add_u32 v6, v6, 10, v7
    buffer_load_dwordx4 v[8:11], v6, s[8:11], 0 offen
    buffer_load_dwordx4 v[12:15], v7, s[36:39], 0 offen
    s_lshl_b32 s7, s67, 2
    s_lshl_b32 s71, s68, 1
    s_add_u32 s7, s7, s71
    s_lshl_b32 s7, s7, 7
    s_mul_i32 s71, s3, 15
    s_add_u32 s7, s7, s71
    s_lshl_b32 s7, s7, 10
    v_lshl_add_u32 v1, v0, 4, s7
    v_add_u32 v2, 0x20000, v1
    v_lshlrev_b32 v26, 1, v26
    v_xor_b32 v26, v26, v27
    v_lshlrev_b32 v26, 4, v26
    v_lshl_add_u32 v26, v27, 8, v26
    s_lshl_b32 s7, s3, 14
    v_add_u32 v4, s7, v26
    v_xor_b32 v5, 16, v4
L_wl_25:
    ds_read_b32 v23, v22
    s_add_u32 s73, s73, 1
    s_waitcnt lgkmcnt(0)
    v_readfirstlane_b32 s7, v23
    s_nop 1
    s_cmp_ge_u32 s7, 1
    s_cbranch_scc1 L_wl_ok_26
    s_sleep 1
    s_cmp_lt_u32 s73, 100000
    s_cbranch_scc1 L_wl_25
L_wl_ok_26:
    ds_read_b64_tr_b16 v[136:137], v16 offset:38912
    ds_read_b64_tr_b16 v[138:139], v16 offset:39424
    ds_read_b64_tr_b16 v[140:141], v17 offset:38912
    ds_read_b64_tr_b16 v[142:143], v17 offset:39424
    ds_read_b64_tr_b16 v[144:145], v16 offset:47104
    ds_read_b64_tr_b16 v[146:147], v16 offset:47616
    ds_read_b64_tr_b16 v[148:149], v17 offset:47104
    ds_read_b64_tr_b16 v[150:151], v17 offset:47616
    ds_read_b64_tr_b16 v[152:153], v20 offset:0
    ds_read_b64_tr_b16 v[154:155], v20 offset:512
    ds_read_b64_tr_b16 v[156:157], v21 offset:0
    ds_read_b64_tr_b16 v[158:159], v21 offset:512
    s_waitcnt lgkmcnt(4)
    ds_read_b64_tr_b16 v[160:161], v20 offset:8192
    ds_read_b64_tr_b16 v[162:163], v20 offset:8704
    ds_read_b64_tr_b16 v[164:165], v21 offset:8192
    ds_read_b64_tr_b16 v[166:167], v21 offset:8704
    ds_read_b64_tr_b16 v[168:169], v20 offset:16384
    ds_read_b64_tr_b16 v[170:171], v20 offset:16896
    ds_read_b64_tr_b16 v[172:173], v21 offset:16384
    ds_read_b64_tr_b16 v[174:175], v21 offset:16896
L_wl_27:
    ds_read_b32 v23, v22
    s_add_u32 s73, s73, 1
    s_waitcnt lgkmcnt(0)
    v_readfirstlane_b32 s7, v23
    s_nop 1
    s_cmp_ge_u32 s7, 2
    s_cbranch_scc1 L_wl_ok_28
    s_sleep 1
    s_cmp_lt_u32 s73, 100000
    s_cbranch_scc1 L_wl_27
L_wl_ok_28:
    ds_read_b64_tr_b16 v[176:177], v16 offset:2048
    ds_read_b64_tr_b16 v[178:179], v16 offset:2560
    ds_read_b64_tr_b16 v[180:181], v17 offset:2048
    ds_read_b64_tr_b16 v[182:183], v17 offset:2560
    ds_read_b64_tr_b16 v[184:185], v16 offset:10240
    ds_read_b64_tr_b16 v[186:187], v16 offset:10752
    ds_read_b64_tr_b16 v[188:189], v17 offset:10240
    ds_read_b64_tr_b16 v[190:191], v17 offset:10752
    ds_read_b64_tr_b16 v[192:193], v18 offset:0
    ds_read_b64_tr_b16 v[194:195], v18 offset:512
    ds_read_b64_tr_b16 v[196:197], v19 offset:0
    ds_read_b64_tr_b16 v[198:199], v19 offset:512
    s_waitcnt lgkmcnt(4)
    ds_read_b64_tr_b16 v[200:201], v18 offset:8192
    ds_read_b64_tr_b16 v[202:203], v18 offset:8704
    ds_read_b64_tr_b16 v[204:205], v19 offset:8192
    ds_read_b64_tr_b16 v[206:207], v19 offset:8704
    ds_read_b64_tr_b16 v[208:209], v18 offset:16384
    ds_read_b64_tr_b16 v[210:211], v18 offset:16896
    ds_read_b64_tr_b16 v[212:213], v19 offset:16384
    ds_read_b64_tr_b16 v[214:215], v19 offset:16896
L_wl_29:
    ds_read_b32 v23, v22
    s_add_u32 s73, s73, 1
    s_waitcnt lgkmcnt(0)
    v_readfirstlane_b32 s7, v23
    s_nop 1
    s_cmp_ge_u32 s7, 3
    s_cbranch_scc1 L_wl_ok_30
    s_sleep 1
    s_cmp_lt_u32 s73, 100000
    s_cbranch_scc1 L_wl_29
L_wl_ok_30:
    ds_read_b64_tr_b16 v[216:217], v16 offset:20480
    ds_read_b64_tr_b16 v[218:219], v16 offset:20992
    ds_read_b64_tr_b16 v[220:221], v17 offset:20480
    ds_read_b64_tr_b16 v[222:223], v17 offset:20992
    ds_read_b64_tr_b16 v[224:225], v16 offset:28672
    ds_read_b64_tr_b16 v[226:227], v16 offset:29184
    ds_read_b64_tr_b16 v[228:229], v17 offset:28672
    ds_read_b64_tr_b16 v[230:231], v17 offset:29184
    ds_read_b64_tr_b16 v[232:233], v18 offset:24576
    ds_read_b64_tr_b16 v[234:235], v18 offset:25088
    ds_read_b64_tr_b16 v[236:237], v19 offset:24576
    ds_read_b64_tr_b16 v[238:239], v19 offset:25088
    s_waitcnt lgkmcnt(4)
    ds_read_b64_tr_b16 v[240:241], v18 offset:32768
    ds_read_b64_tr_b16 v[242:243], v18 offset:33280
    ds_read_b64_tr_b16 v[244:245], v19 offset:32768
    ds_read_b64_tr_b16 v[246:247], v19 offset:33280
    ds_read_b64_tr_b16 v[248:249], v18 offset:40960
    ds_read_b64_tr_b16 v[250:251], v18 offset:41472
    ds_read_b64_tr_b16 v[252:253], v19 offset:40960
    ds_read_b64_tr_b16 v[254:255], v19 offset:41472
    v_mov_b32 v23, 1
    s_waitcnt lgkmcnt(0)
    ds_write_b32 v22, v23 offset:16
    s_setprio 0
    s_branch L_poll
L_last:
    s_endpgm
.section .rodata,"a"
.p2align 6
.amdhsa_kernel parallel_sum__sliding_local_dilated__dense_activation_gelu__prompt_kernel
  .amdhsa_next_free_vgpr 256
  .amdhsa_next_free_sgpr 102
  .amdhsa_accum_offset 256
  .amdhsa_group_segment_fixed_size 0
  .amdhsa_kernarg_size 88
  .amdhsa_user_sgpr_count 2
  .amdhsa_user_sgpr_kernarg_segment_ptr 1
  .amdhsa_system_sgpr_workgroup_id_x 1
.end_amdhsa_kernel
```
